```python
import torch

def _softmax(x, axis=-1):
    return torch.softmax(x, dim=axis)
def _gelu(x):
    return torch.nn.functional.gelu(x, approximate="tanh")
def _silu(x):
    return torch.nn.functional.silu(x)
def _sigmoid(x):
    return torch.sigmoid(x)
def _layernorm(x, axis=-1, eps=1e-5):
    m = x.mean(dim=axis, keepdim=True)
    v = x.var(dim=axis, keepdim=True, unbiased=False)
    return (x - m) / torch.sqrt(v + eps)
def _scatter_add(tgt, idx, src, axis=0):
    return tgt.clone().index_add_(axis, idx, src)
def _segment_sum(src, seg, n):
    out = torch.zeros((n,) + src.shape[1:], dtype=src.dtype)
    return out.index_add_(0, seg, src)
def _pad(x, pw):
    flat = tuple(v for pair in reversed(pw) for v in pair)
    return torch.nn.functional.pad(x, flat)

kernel_name = 'parallel_sum__linear_kernel_hedgehog__dense_activation_squared_relu__prompt'

def setup_inputs():

    _w = (lambda a: (lambda t: t.to(torch.bfloat16) if t.is_floating_point() else t)(torch.as_tensor(a)))
    def _A_setup():
        B, S, D, H = 1, 2048, 640, 32
        Dh = D // H
        return {
            "x": _w((lambda *s: torch.randn(*s, dtype=torch.bfloat16) * 0.05)(B, S, D)),
            "wqkv": _w((lambda *s: torch.randn(*s, dtype=torch.bfloat16) * 0.8)(D, 3 * D)),
            "w_phi": _w((lambda *s: torch.randn(*s, dtype=torch.bfloat16) * 0.8)(H, Dh, Dh) * (Dh ** -0.5)),
            "wo": _w((lambda *s: torch.randn(*s, dtype=torch.bfloat16) * 0.2)(D, D)),
        }
    _A_in = _A_setup()

    def _B_setup():
        B, S, D, F = 1, 2048, 640, 1728
        return {
            "x": _w((lambda *s: torch.randn(*s, dtype=torch.bfloat16) * 0.05)(B, S, D)),
            "w1": _w((lambda *s: torch.randn(*s, dtype=torch.bfloat16) * 0.05)(D, F)),
            "b1": _w((lambda *s: torch.randn(*s, dtype=torch.bfloat16) * 0.8)(F)),
            "w2": _w((lambda *s: torch.randn(*s, dtype=torch.bfloat16) * 0.05)(F, D)),
            "b2": _w((lambda *s: torch.randn(*s, dtype=torch.bfloat16) * 3.2)(D)),
        }
    _B_in = _B_setup()

    return {
        "A_x": _A_in["x"],
        "A_wqkv": _A_in["wqkv"],
        "A_w_phi": _A_in["w_phi"],
        "A_wo": _A_in["wo"],
        "B_x": _B_in["x"],
        "B_w1": _B_in["w1"],
        "B_b1": _B_in["b1"],
        "B_w2": _B_in["w2"],
        "B_b2": _B_in["b2"],
    }

def reference(A_x, A_wqkv, A_w_phi, A_wo, B_x, B_w1, B_b1, B_w2, B_b2):
    def _A_ref(x, wqkv, w_phi, wo):
        B, S, D = x.shape
        H = 32; Dh = D // H
        qkv = (lambda x, *d: x.permute(*d))((x @ wqkv).reshape(B, S, 3, H, Dh), 2, 0, 3, 1, 4)
        q, k, v = qkv[0], qkv[1], qkv[2]
        pq = torch.einsum("bhsd,hdf->bhsf", q, w_phi)
        pk = torch.einsum("bhsd,hdf->bhsf", k, w_phi)
        phi_q = torch.concatenate([_softmax(pq, axis=-1), _softmax(-pq, axis=-1)], axis=-1)
        phi_k = torch.concatenate([_softmax(pk, axis=-1), _softmax(-pk, axis=-1)], axis=-1)
        kv = torch.einsum("bhsf,bhsd->bhfd", phi_k, v)
        z  = torch.einsum("bhsf->bhf", phi_k)
        num = torch.einsum("bhqf,bhfd->bhqd", phi_q, kv)
        den = torch.einsum("bhqf,bhf->bhq", phi_q, z)[..., None] + 1e-6
        o = num / den
        return (lambda x, *d: x.permute(*d))(o, 0, 2, 1, 3).reshape(B, S, D) @ wo

    def _B_ref(x, w1, b1, w2, b2):
        h = torch.einsum("bsd,df->bsf", x, w1) + b1
        zero = torch.zeros_like(h)
        r = torch.where(h > zero, h, zero)
        h = r * r
        out = torch.einsum("bsf,fd->bsd", h, w2) + b2
        return out

    x = A_x
    xn = _layernorm(x, axis=-1)
    return x + _A_ref(xn, A_wqkv, A_w_phi, A_wo) + _B_ref(xn, B_w1, B_b1, B_w2, B_b2)
```

```asm
; @launch kernel=k1_kernel grid=(256,1,1) block=(512,1,1) lds=157696
; @launch kernel=k2_kernel grid=(256,1,1) block=(512,1,1) lds=155840
.amdgcn_target "amdgcn-amd-amdhsa--gfx950"
.text
.globl k1_kernel
.p2align 8
.type k1_kernel,@function
k1_kernel:
    s_cmp_ge_u32 s2, 256
    s_cbranch_scc1 K1_END
    s_load_dwordx4 s[4:7], s[0:1], 0
    s_load_dwordx4 s[8:11], s[0:1], 16
    s_load_dwordx4 s[12:15], s[0:1], 40
    s_load_dwordx2 s[76:77], s[0:1], 56
    s_load_dwordx4 s[40:43], s[0:1], 80
    v_and_b32 v1, 63, v0
    v_lshrrev_b32 v20, 6, v0
    v_and_b32 v2, 31, v0
    v_readfirstlane_b32 s48, v20
    v_bfe_u32 v3, v0, 5, 1
    s_and_b32 s44, s2, 7
    s_lshr_b32 s45, s2, 3
    s_and_b32 s46, s44, 1
    s_lshl_b32 s46, s46, 3
    s_and_b32 s47, s45, 7
    s_add_u32 s49, s46, s47
    s_lshr_b32 s44, s44, 1
    s_lshl_b32 s44, s44, 2
    s_lshr_b32 s45, s45, 3
    s_add_u32 s86, s44, s45
    s_lshr_b32 s50, s86, 1
    s_and_b32 s80, s86, 1
    s_sub_u32 s67, s49, 10
    s_cmp_lt_u32 s49, 10
    s_cselect_b32 s67, s49, s67
    s_lshl_b32 s55, s67, 7
    v_lshrrev_b32 v20, 3, v1
    s_lshl_b32 s44, s48, 3
    v_add_u32 v21, s44, v20
    v_bfe_u32 v22, v21, 1, 3
    v_and_b32 v23, 7, v1
    v_xor_b32 v22, v22, v23
    v_and_b32 v28, 3, v22
    v_lshrrev_b32 v22, 2, v22
    v_lshl_add_u32 v22, v28, 1, v22
    v_mul_u32_u24 v4, 1280, v21
    v_lshl_add_u32 v4, v22, 4, v4
    v_bfe_u32 v24, v1, 4, 1
    v_lshlrev_b32 v24, 2, v24
    v_xor_b32 v24, v24, v23
    s_lshl_b32 s65, s48, 10
    s_add_u32 s66, s65, 59392
    s_mov_b32 s53, 10240
    s_mov_b32 s54, 0
    s_mul_i32 s44, s49, 163840
    s_lshl_b32 s45, s86, 3
    s_add_u32 s45, s45, s48
    s_mul_i32 s45, s45, 1280
    v_lshlrev_b32 v254, 4, v1
    v_add_u32 v28, 1024, v254
    v_cmp_gt_u32 vcc, 16, v1
    v_mov_b32 v27, 0x7f000000
    s_waitcnt lgkmcnt(0)
    s_add_u32 s16, s4, s44
    s_addc_u32 s17, s5, 0
    s_and_b32 s17, s17, 0xffff
    s_mov_b32 s18, 163840
    s_mov_b32 s19, 0x00020000
    v_cndmask_b32 v255, v27, v28, vcc
    s_mov_b64 s[68:69], s[42:43]
    s_mov_b64 s[70:71], s[40:41]
    s_mov_b32 s92, s45
    s_cmp_eq_u32 s2, 70
    s_cselect_b32 s90, 1, 0
    s_cmp_eq_u32 s48, 7
    s_cselect_b32 s90, s90, 0
    s_cmp_eq_u32 s90, 0
    s_cbranch_scc1 K1_NM0
    v_mov_b32 v28, 19660800
    global_load_dword v243, v28, s[68:69] sc1
K1_NM0:
    buffer_load_dwordx4 v[232:235], v254, s[16:19], s92 offen
    buffer_load_dwordx4 v[236:239], v255, s[16:19], s92 offen
    s_add_u32 m0, s65, 10240
    s_add_u32 s40, s55, 81920
    buffer_load_dwordx4 v4, s[16:19], s55 offen lds
    s_add_u32 m0, m0, 8192
    s_nop 0
    buffer_load_dwordx4 v4, s[16:19], s40 offen lds
    s_mov_b64 s[72:73], s[8:9]
    s_mov_b64 s[74:75], s[14:15]
    s_mov_b64 s[78:79], s[10:11]
    s_cmp_eq_u32 s80, 1
    s_cbranch_scc1 K1_B
    s_lshr_b32 s51, s48, 2
    s_and_b32 s52, s48, 3
    s_mov_b32 s20, s6
    s_and_b32 s21, s7, 0xffff
    s_mov_b32 s22, 2457600
    s_mov_b32 s23, 0x00020000
    s_mov_b32 s60, 245760
    s_mov_b32 s24, s6
    s_and_b32 s25, s7, 0xffff
    s_mov_b32 s26, 2457600
    s_mov_b32 s27, 0x00020000
    s_mov_b32 s61, 245760
    s_mov_b32 s28, s6
    s_and_b32 s29, s7, 0xffff
    s_mov_b32 s30, 2457600
    s_mov_b32 s31, 0x00020000
    s_mov_b32 s62, 245760
    s_mov_b32 s32, s6
    s_and_b32 s33, s7, 0xffff
    s_mov_b32 s34, 2457600
    s_mov_b32 s35, 0x00020000
    s_mov_b32 s63, 245760
    s_mul_i32 s40, s50, 160
    s_lshl_b32 s41, s50, 7
    v_mul_u32_u24 v25, 3840, v21
    v_lshl_add_u32 v26, v24, 4, v25
    s_add_u32 s42, s40, 1280
    v_add_u32 v5, s42, v26
    s_add_u32 s42, s40, 2592
    v_add_u32 v7, s42, v26
    v_add_u32 v8, s41, v26
    v_and_b32 v27, 1, v24
    v_lshl_add_u32 v27, v27, 4, v25
    v_mov_b32 v28, 2560
    v_mov_b32 v29, 1408
    v_cmp_gt_u32 vcc, 4, v24
    s_nop 1
    v_cndmask_b32 v28, v28, v29, vcc
    v_add3_u32 v6, v27, v28, s40
    s_mul_i32 s56, s67, s60
    s_mul_i32 s57, s67, s61
    s_mul_i32 s58, s67, s62
    s_mul_i32 s59, s67, s63
    s_add_u32 m0, s66, 0
    s_nop 0
    buffer_load_dwordx4 v5, s[20:23], s56 offen lds
    s_add_u32 m0, s66, 8192
    s_nop 0
    buffer_load_dwordx4 v6, s[24:27], s57 offen lds
    s_add_u32 m0, s66, 16384
    s_nop 0
    buffer_load_dwordx4 v7, s[28:31], s58 offen lds
    s_add_u32 m0, s66, 24576
    s_nop 0
    buffer_load_dwordx4 v8, s[32:35], s59 offen lds
    s_add_u32 s55, s55, 128
    s_add_u32 s56, s56, s60
    s_add_u32 s57, s57, s61
    s_add_u32 s58, s58, s62
    s_add_u32 s59, s59, s63
    s_add_u32 s67, s67, 1
    s_cmp_eq_u32 s67, 10
    s_cselect_b32 s67, 0, s67
    s_cselect_b32 s55, 0, s55
    s_cselect_b32 s56, 0, s56
    s_cselect_b32 s57, 0, s57
    s_cselect_b32 s58, 0, s58
    s_cselect_b32 s59, 0, s59
    s_mul_i32 s40, s50, 3200
    s_add_u32 s36, s72, s40
    s_addc_u32 s37, s73, 0
    s_and_b32 s37, s37, 0xffff
    s_mov_b32 s38, 3200
    s_mov_b32 s39, 0x00020000
    v_bfe_u32 v248, v1, 4, 1
    v_lshlrev_b32 v248, 2, v248
    v_and_b32 v28, 3, v1
    v_add_u32 v248, v248, v28
    v_bfe_u32 v249, v1, 2, 2
    v_bfe_u32 v250, v1, 3, 1
    v_lshlrev_b32 v250, 2, v250
    v_lshl_add_u32 v249, v3, 3, v249
    v_and_b32 v21, 3, v248
    v_lshlrev_b32 v21, 3, v21
    v_cmp_lt_u32 vcc, 3, v248
    s_cmp_eq_u32 s51, 0
    s_mov_b32 s42, 0x3d393c38
    s_cselect_b32 s42, 0x3f3b3e3a, s42
    s_mov_b32 s43, 0x130e0f0a
    s_cselect_b32 s43, 0x9040500, s43
    v_mov_b32 v22, s42
    v_mov_b32 v23, s43
    v_cndmask_b32 v22, v22, v23, vcc
    v_lshrrev_b32 v22, v21, v22
    v_and_b32 v23, 1, v22
    v_bfe_u32 v24, v22, 1, 3
    v_bfe_u32 v25, v22, 4, 2
    v_xor_b32 v24, v24, v250
    v_lshlrev_b32 v24, 4, v24
    v_lshl_add_u32 v24, v23, 3, v24
    v_lshl_add_u32 v24, v25, 13, v24
    v_lshl_add_u32 v24, v249, 7, v24
    v_add_u32 v11, 59392, v24
    s_cmp_eq_u32 s51, 0
    s_mov_b32 s42, 0x120d100b
    s_cselect_b32 s42, 0x8030601, s42
    s_mov_b32 s43, 0x2e292c27
    s_cselect_b32 s43, 0x241f221d, s43
    v_mov_b32 v22, s42
    v_mov_b32 v23, s43
    v_cndmask_b32 v22, v22, v23, vcc
    v_lshrrev_b32 v22, v21, v22
    v_and_b32 v23, 1, v22
    v_bfe_u32 v24, v22, 1, 3
    v_bfe_u32 v25, v22, 4, 2
    v_xor_b32 v24, v24, v250
    v_lshlrev_b32 v24, 4, v24
    v_lshl_add_u32 v24, v23, 3, v24
    v_lshl_add_u32 v24, v25, 13, v24
    v_lshl_add_u32 v24, v249, 7, v24
    v_add_u32 v12, 59392, v24
    s_cmp_eq_u32 s51, 0
    s_mov_b32 s42, 0x2b26110c
    s_cselect_b32 s42, 0x211c0702, s42
    s_mov_b32 s43, 0x2f2a2d28
    s_cselect_b32 s43, 0x2520231e, s43
    v_mov_b32 v22, s42
    v_mov_b32 v23, s43
    v_cndmask_b32 v22, v22, v23, vcc
    v_lshrrev_b32 v22, v21, v22
    v_and_b32 v23, 1, v22
    v_bfe_u32 v24, v22, 1, 3
    v_bfe_u32 v25, v22, 4, 2
    v_xor_b32 v24, v24, v250
    v_lshlrev_b32 v24, 4, v24
    v_lshl_add_u32 v24, v23, 3, v24
    v_lshl_add_u32 v24, v25, 13, v24
    v_lshl_add_u32 v24, v249, 7, v24
    v_add_u32 v13, 59392, v24
    s_cmp_eq_u32 s51, 0
    s_mov_b32 s42, 0x3d393c38
    s_cselect_b32 s42, 0x33313230, s42
    s_mov_b32 s43, 0x130e0f0a
    s_cselect_b32 s43, 0x37353634, s43
    v_mov_b32 v22, s42
    v_mov_b32 v23, s43
    v_cndmask_b32 v22, v22, v23, vcc
    v_lshrrev_b32 v22, v21, v22
    v_and_b32 v23, 1, v22
    v_bfe_u32 v24, v22, 1, 3
    v_bfe_u32 v25, v22, 4, 2
    v_xor_b32 v24, v24, v250
    v_lshlrev_b32 v24, 4, v24
    v_lshl_add_u32 v24, v23, 3, v24
    v_lshl_add_u32 v24, v25, 13, v24
    v_lshl_add_u32 v24, v249, 7, v24
    v_add_u32 v14, 59392, v24
    v_bfe_u32 v21, v2, 1, 3
    v_lshlrev_b32 v22, 2, v3
    v_xor_b32 v21, v21, v22
    s_lshl_b32 s40, s52, 5
    v_add_u32 v22, s40, v2
    v_lshlrev_b32 v22, 7, v22
    v_lshl_add_u32 v9, v21, 4, v22
    s_cmp_lt_u32 s49, 10
    s_cselect_b32 s87, s52, 99
    s_cselect_b32 s88, 1, 0
    s_cselect_b32 s89, 1, 0
    s_cmp_lt_u32 s48, 4
    s_cselect_b32 s89, s89, 0
    v_mov_b32 v103, 0
    v_lshlrev_b32 v21, 2, v0
    v_mov_b32 v22, 0
    v_cmp_gt_u32 vcc, 320, v0
    s_and_saveexec_b64 s[46:47], vcc
    ds_write_b32 v21, v22 offset:4224
    s_mov_b64 exec, s[46:47]
    s_add_u32 m0, s65, 26624
    s_add_u32 s40, s55, 81920
    buffer_load_dwordx4 v4, s[16:19], s55 offen lds
    s_add_u32 m0, m0, 8192
    s_nop 0
    buffer_load_dwordx4 v4, s[16:19], s40 offen lds
    s_add_u32 m0, s66, 32768
    s_nop 0
    buffer_load_dwordx4 v5, s[20:23], s56 offen lds
    s_add_u32 m0, s66, 40960
    s_nop 0
    buffer_load_dwordx4 v6, s[24:27], s57 offen lds
    s_add_u32 m0, s66, 49152
    s_nop 0
    buffer_load_dwordx4 v7, s[28:31], s58 offen lds
    s_add_u32 m0, s66, 57344
    s_nop 0
    buffer_load_dwordx4 v8, s[32:35], s59 offen lds
    s_add_u32 s55, s55, 128
    s_add_u32 s56, s56, s60
    s_add_u32 s57, s57, s61
    s_add_u32 s58, s58, s62
    s_add_u32 s59, s59, s63
    s_add_u32 s67, s67, 1
    s_cmp_eq_u32 s67, 10
    s_cselect_b32 s67, 0, s67
    s_cselect_b32 s55, 0, s55
    s_cselect_b32 s56, 0, s56
    s_cselect_b32 s57, 0, s57
    s_cselect_b32 s58, 0, s58
    s_cselect_b32 s59, 0, s59
    v_mov_b32 v252, 0x3f803f80
    v_mov_b32 v253, 0x3f803f80
    v_mov_b32 v254, 0x3f803f80
    v_mov_b32 v255, 0x3f803f80
    s_waitcnt vmcnt(12)
    v_mov_b32 v24, 0x3f803f80
    v_mov_b32 v22, 0
    v_mov_b32 v23, 0
    v_dot2_f32_bf16 v22, v232, v24, v22
    v_dot2_f32_bf16 v23, v232, v232, v23
    v_dot2_f32_bf16 v22, v233, v24, v22
    v_dot2_f32_bf16 v23, v233, v233, v23
    v_dot2_f32_bf16 v22, v234, v24, v22
    v_dot2_f32_bf16 v23, v234, v234, v23
    v_dot2_f32_bf16 v22, v235, v24, v22
    v_dot2_f32_bf16 v23, v235, v235, v23
    v_dot2_f32_bf16 v22, v236, v24, v22
    v_dot2_f32_bf16 v23, v236, v236, v23
    v_dot2_f32_bf16 v22, v237, v24, v22
    v_dot2_f32_bf16 v23, v237, v237, v23
    v_dot2_f32_bf16 v22, v238, v24, v22
    v_dot2_f32_bf16 v23, v238, v238, v23
    v_dot2_f32_bf16 v22, v239, v24, v22
    v_dot2_f32_bf16 v23, v239, v239, v23
    s_nop 1
    v_add_f32_dpp v22, v22, v22 row_shr:1 row_mask:0xf bank_mask:0xf
    v_add_f32_dpp v23, v23, v23 row_shr:1 row_mask:0xf bank_mask:0xf
    s_nop 1
    v_add_f32_dpp v22, v22, v22 row_shr:2 row_mask:0xf bank_mask:0xf
    v_add_f32_dpp v23, v23, v23 row_shr:2 row_mask:0xf bank_mask:0xf
    s_nop 1
    v_add_f32_dpp v22, v22, v22 row_shr:4 row_mask:0xf bank_mask:0xf
    v_add_f32_dpp v23, v23, v23 row_shr:4 row_mask:0xf bank_mask:0xf
    s_nop 1
    v_add_f32_dpp v22, v22, v22 row_shr:8 row_mask:0xf bank_mask:0xf
    v_add_f32_dpp v23, v23, v23 row_shr:8 row_mask:0xf bank_mask:0xf
    s_nop 1
    v_add_f32_dpp v22, v22, v22 row_bcast:15 row_mask:0xa bank_mask:0xf
    v_add_f32_dpp v23, v23, v23 row_bcast:15 row_mask:0xa bank_mask:0xf
    s_nop 1
    v_add_f32_dpp v22, v22, v22 row_bcast:31 row_mask:0xc bank_mask:0xf
    v_add_f32_dpp v23, v23, v23 row_bcast:31 row_mask:0xc bank_mask:0xf
    v_mul_f32 v240, 0xbacccccd, v22
    v_mul_f32 v23, 0x3acccccd, v23
    v_fma_f32 v23, -v240, v240, v23
    v_max_f32 v23, 0, v23
    v_add_f32 v23, 0x3727c5ac, v23
    v_rsq_f32 v241, v23
    s_lshl_b32 s40, s49, 7
    s_lshl_b32 s41, s86, 3
    s_add_u32 s40, s40, s41
    s_add_u32 s40, s40, s48
    s_lshl_b32 s40, s40, 4
    s_add_u32 s92, s40, 19136512
    s_waitcnt vmcnt(6)
    s_cmp_eq_u32 s90, 0
    s_cbranch_scc1 K1_nm_1
    v_add_u32 v243, 1, v243
    v_max_u32 v243, 1, v243
    v_mov_b32 v27, 0
    v_mov_b32 v28, 19660800
    s_mov_b64 exec, 1
    global_store_dword v27, v243, s[70:71] sc0 sc1
    global_store_dword v28, v243, s[68:69] sc0 sc1
    s_mov_b64 exec, -1
K1_nm_1:
    s_cmp_lg_u32 s51, 0
    s_cbranch_scc1 K1A_H1
    s_waitcnt lgkmcnt(0)
    s_barrier
    s_mov_b32 s81, 43008
    s_mov_b32 s82, 65536
    v_add_u32 v15, s54, v11
    v_add_u32 v16, s54, v12
    v_add_u32 v17, s54, v13
    v_add_u32 v18, s54, v14
    v_xad_u32 v20, v9, 0, s53
    ds_read_b128 v[30:33], v20
    ds_read_b64_tr_b16 v[54:55], v15 offset:0
    ds_read_b64_tr_b16 v[56:57], v15 offset:512
    ds_read_b64_tr_b16 v[58:59], v16 offset:0
    ds_read_b64_tr_b16 v[60:61], v16 offset:512
    ds_read_b64_tr_b16 v[62:63], v17 offset:0
    ds_read_b64_tr_b16 v[64:65], v17 offset:512
    ds_read_b64_tr_b16 v[66:67], v18 offset:0
    ds_read_b64_tr_b16 v[68:69], v18 offset:512
    v_xad_u32 v20, v9, 16, s53
    ds_read_b128 v[38:41], v20
    ds_read_b64_tr_b16 v[70:71], v15 offset:2048
    ds_read_b64_tr_b16 v[72:73], v15 offset:2560
    ds_read_b64_tr_b16 v[74:75], v16 offset:2048
    ds_read_b64_tr_b16 v[76:77], v16 offset:2560
    ds_read_b64_tr_b16 v[78:79], v17 offset:2048
    ds_read_b64_tr_b16 v[80:81], v17 offset:2560
    ds_read_b64_tr_b16 v[82:83], v18 offset:2048
    ds_read_b64_tr_b16 v[84:85], v18 offset:2560
    s_waitcnt lgkmcnt(9)
    v_mfma_f32_32x32x16_bf16 v[104:119], v[54:57], v[30:33], 0
    v_xad_u32 v20, v9, 32, s53
    ds_read_b128 v[46:49], v20
    ds_read_b64_tr_b16 v[86:87], v15 offset:4096
    ds_read_b64_tr_b16 v[88:89], v15 offset:4608
    ds_read_b64_tr_b16 v[90:91], v16 offset:4096
    s_add_u32 m0, s65, s81
    s_add_u32 s40, s55, 81920
    buffer_load_dwordx4 v4, s[16:19], s55 offen lds
    v_mfma_f32_32x32x16_bf16 v[120:135], v[58:61], v[30:33], 0
    ds_read_b64_tr_b16 v[92:93], v16 offset:4608
    ds_read_b64_tr_b16 v[94:95], v17 offset:4096
    ds_read_b64_tr_b16 v[96:97], v17 offset:4608
    ds_read_b64_tr_b16 v[98:99], v18 offset:4096
    ds_read_b64_tr_b16 v[100:101], v18 offset:4608
    s_add_u32 m0, s65, s81
    s_add_u32 m0, m0, 8192
    s_add_u32 s40, s55, 81920
    buffer_load_dwordx4 v4, s[16:19], s40 offen lds
    v_mfma_f32_32x32x16_bf16 v[136:151], v[62:65], v[30:33], 0
    s_add_u32 s41, s66, s82
    s_add_u32 m0, s41, 0
    s_nop 0
    buffer_load_dwordx4 v5, s[20:23], s56 offen lds
    v_mfma_f32_32x32x16_bf16 v[152:167], v[66:69], v[30:33], 0
    s_add_u32 s41, s66, s82
    s_add_u32 m0, s41, 8192
    s_nop 0
    buffer_load_dwordx4 v6, s[24:27], s57 offen lds
    s_cmp_lg_u32 s87, 0
    s_cbranch_scc1 K1A0_cs_2e
    v_mfma_f32_32x32x16_bf16 v[168:183], v[252:255], v[54:57], 0
    v_mfma_f32_32x32x16_bf16 v[184:199], v[252:255], v[58:61], 0
    v_mfma_f32_32x32x16_bf16 v[200:215], v[252:255], v[62:65], 0
    v_mfma_f32_32x32x16_bf16 v[216:231], v[252:255], v[66:69], 0
K1A0_cs_2e:
    s_waitcnt lgkmcnt(9)
    v_mfma_f32_32x32x16_bf16 v[104:119], v[70:73], v[38:41], v[104:119]
    v_xad_u32 v20, v9, 48, s53
    ds_read_b128 v[30:33], v20
    ds_read_b64_tr_b16 v[54:55], v15 offset:6144
    ds_read_b64_tr_b16 v[56:57], v15 offset:6656
    ds_read_b64_tr_b16 v[58:59], v16 offset:6144
    s_add_u32 s41, s66, s82
    s_add_u32 m0, s41, 16384
    s_nop 0
    buffer_load_dwordx4 v7, s[28:31], s58 offen lds
    v_mfma_f32_32x32x16_bf16 v[120:135], v[74:77], v[38:41], v[120:135]
    ds_read_b64_tr_b16 v[60:61], v16 offset:6656
    ds_read_b64_tr_b16 v[62:63], v17 offset:6144
    ds_read_b64_tr_b16 v[64:65], v17 offset:6656
    ds_read_b64_tr_b16 v[66:67], v18 offset:6144
    ds_read_b64_tr_b16 v[68:69], v18 offset:6656
    s_add_u32 s41, s66, s82
    s_add_u32 m0, s41, 24576
    s_nop 0
    buffer_load_dwordx4 v8, s[32:35], s59 offen lds
    s_add_u32 s55, s55, 128
    s_add_u32 s56, s56, s60
    s_add_u32 s57, s57, s61
    s_add_u32 s58, s58, s62
    s_add_u32 s59, s59, s63
    s_add_u32 s67, s67, 1
    s_cmp_eq_u32 s67, 10
    s_cselect_b32 s67, 0, s67
    s_cselect_b32 s55, 0, s55
    s_cselect_b32 s56, 0, s56
    s_cselect_b32 s57, 0, s57
    s_cselect_b32 s58, 0, s58
    s_cselect_b32 s59, 0, s59
    v_mfma_f32_32x32x16_bf16 v[136:151], v[78:81], v[38:41], v[136:151]
    v_lshlrev_b32 v28, 4, v0
    buffer_load_dwordx4 v[244:247], v28, s[36:39], 0 offen
    v_mfma_f32_32x32x16_bf16 v[152:167], v[82:85], v[38:41], v[152:167]
    s_cmp_lg_u32 s87, 1
    s_cbranch_scc1 K1A0_cs_3e
    v_mfma_f32_32x32x16_bf16 v[168:183], v[252:255], v[70:73], 0
    v_mfma_f32_32x32x16_bf16 v[184:199], v[252:255], v[74:77], 0
    v_mfma_f32_32x32x16_bf16 v[200:215], v[252:255], v[78:81], 0
    v_mfma_f32_32x32x16_bf16 v[216:231], v[252:255], v[82:85], 0
K1A0_cs_3e:
    s_waitcnt lgkmcnt(0)
    s_waitcnt vmcnt(7)
    s_barrier
    s_mov_b32 s81, s53
    s_mov_b32 s82, s54
    s_add_u32 s53, s53, 16384
    s_add_u32 s54, s54, 32768
    s_cmp_eq_u32 s53, 59392
    s_cselect_b32 s53, 10240, s53
    s_cselect_b32 s54, 0, s54
    v_add_u32 v15, s54, v11
    v_add_u32 v16, s54, v12
    v_add_u32 v17, s54, v13
    v_add_u32 v18, s54, v14
    v_mfma_f32_32x32x16_bf16 v[104:119], v[86:89], v[46:49], v[104:119]
    v_xad_u32 v20, v9, 0, s53
    ds_read_b128 v[38:41], v20
    ds_read_b64_tr_b16 v[70:71], v15 offset:0
    ds_read_b64_tr_b16 v[72:73], v15 offset:512
    ds_read_b64_tr_b16 v[74:75], v16 offset:0
    v_mfma_f32_32x32x16_bf16 v[120:135], v[90:93], v[46:49], v[120:135]
    ds_read_b64_tr_b16 v[76:77], v16 offset:512
    ds_read_b64_tr_b16 v[78:79], v17 offset:0
    ds_read_b64_tr_b16 v[80:81], v17 offset:512
    ds_read_b64_tr_b16 v[82:83], v18 offset:0
    ds_read_b64_tr_b16 v[84:85], v18 offset:512
    v_mfma_f32_32x32x16_bf16 v[136:151], v[94:97], v[46:49], v[136:151]
    s_add_u32 m0, s65, s81
    s_add_u32 s40, s55, 81920
    buffer_load_dwordx4 v4, s[16:19], s55 offen lds
    v_mfma_f32_32x32x16_bf16 v[152:167], v[98:101], v[46:49], v[152:167]
    s_add_u32 m0, s65, s81
    s_add_u32 m0, m0, 8192
    s_add_u32 s40, s55, 81920
    buffer_load_dwordx4 v4, s[16:19], s40 offen lds
    s_cmp_lg_u32 s87, 2
    s_cbranch_scc1 K1A0_cs_4e
    v_mfma_f32_32x32x16_bf16 v[168:183], v[252:255], v[86:89], 0
    v_mfma_f32_32x32x16_bf16 v[184:199], v[252:255], v[90:93], 0
    v_mfma_f32_32x32x16_bf16 v[200:215], v[252:255], v[94:97], 0
    v_mfma_f32_32x32x16_bf16 v[216:231], v[252:255], v[98:101], 0
K1A0_cs_4e:
    s_waitcnt lgkmcnt(9)
    v_mfma_f32_32x32x16_bf16 v[104:119], v[54:57], v[30:33], v[104:119]
    v_xad_u32 v20, v9, 16, s53
    ds_read_b128 v[46:49], v20
    ds_read_b64_tr_b16 v[86:87], v15 offset:2048
    ds_read_b64_tr_b16 v[88:89], v15 offset:2560
    ds_read_b64_tr_b16 v[90:91], v16 offset:2048
    v_mfma_f32_32x32x16_bf16 v[120:135], v[58:61], v[30:33], v[120:135]
    ds_read_b64_tr_b16 v[92:93], v16 offset:2560
    ds_read_b64_tr_b16 v[94:95], v17 offset:2048
    ds_read_b64_tr_b16 v[96:97], v17 offset:2560
    ds_read_b64_tr_b16 v[98:99], v18 offset:2048
    ds_read_b64_tr_b16 v[100:101], v18 offset:2560
    v_mfma_f32_32x32x16_bf16 v[136:151], v[62:65], v[30:33], v[136:151]
    s_add_u32 s41, s66, s82
    s_add_u32 m0, s41, 0
    s_nop 0
    buffer_load_dwordx4 v5, s[20:23], s56 offen lds
    v_mfma_f32_32x32x16_bf16 v[152:167], v[66:69], v[30:33], v[152:167]
    s_add_u32 s41, s66, s82
    s_add_u32 m0, s41, 8192
    s_nop 0
    buffer_load_dwordx4 v6, s[24:27], s57 offen lds
    s_cmp_lg_u32 s87, 3
    s_cbranch_scc1 K1A0_cs_5e
    v_mfma_f32_32x32x16_bf16 v[168:183], v[252:255], v[54:57], 0
    v_mfma_f32_32x32x16_bf16 v[184:199], v[252:255], v[58:61], 0
    v_mfma_f32_32x32x16_bf16 v[200:215], v[252:255], v[62:65], 0
    v_mfma_f32_32x32x16_bf16 v[216:231], v[252:255], v[66:69], 0
K1A0_cs_5e:
    s_waitcnt lgkmcnt(9)
    v_mfma_f32_32x32x16_bf16 v[104:119], v[70:73], v[38:41], v[104:119]
    v_xad_u32 v20, v9, 32, s53
    ds_read_b128 v[30:33], v20
    ds_read_b64_tr_b16 v[54:55], v15 offset:4096
    ds_read_b64_tr_b16 v[56:57], v15 offset:4608
    ds_read_b64_tr_b16 v[58:59], v16 offset:4096
    v_mfma_f32_32x32x16_bf16 v[120:135], v[74:77], v[38:41], v[120:135]
    ds_read_b64_tr_b16 v[60:61], v16 offset:4608
    ds_read_b64_tr_b16 v[62:63], v17 offset:4096
    ds_read_b64_tr_b16 v[64:65], v17 offset:4608
    ds_read_b64_tr_b16 v[66:67], v18 offset:4096
    ds_read_b64_tr_b16 v[68:69], v18 offset:4608
    v_mfma_f32_32x32x16_bf16 v[136:151], v[78:81], v[38:41], v[136:151]
    s_add_u32 s41, s66, s82
    s_add_u32 m0, s41, 16384
    s_nop 0
    buffer_load_dwordx4 v7, s[28:31], s58 offen lds
    v_mfma_f32_32x32x16_bf16 v[152:167], v[82:85], v[38:41], v[152:167]
    s_add_u32 s41, s66, s82
    s_add_u32 m0, s41, 24576
    s_nop 0
    buffer_load_dwordx4 v8, s[32:35], s59 offen lds
    s_add_u32 s55, s55, 128
    s_add_u32 s56, s56, s60
    s_add_u32 s57, s57, s61
    s_add_u32 s58, s58, s62
    s_add_u32 s59, s59, s63
    s_add_u32 s67, s67, 1
    s_cmp_eq_u32 s67, 10
    s_cselect_b32 s67, 0, s67
    s_cselect_b32 s55, 0, s55
    s_cselect_b32 s56, 0, s56
    s_cselect_b32 s57, 0, s57
    s_cselect_b32 s58, 0, s58
    s_cselect_b32 s59, 0, s59
    s_cmp_lg_u32 s88, 1
    s_cbranch_scc1 K1A0_cw_6e
    s_mul_i32 s40, s51, 512
    s_lshl_b32 s41, s52, 10
    s_add_u32 s40, s40, s41
    v_lshlrev_b32 v28, 7, v3
    v_lshl_add_u32 v28, v2, 2, v28
    v_add_u32 v28, s40, v28
    v_cmp_eq_u32 vcc, 1, v3
    s_nop 1
    v_cndmask_b32 v29, v168, v184, vcc
    ds_write_b32 v28, v29 offset:6144
    v_cndmask_b32 v29, v200, v216, vcc
    ds_write_b32 v28, v29 offset:6400
K1A0_cw_6e:
    s_waitcnt lgkmcnt(9)
    v_mfma_f32_32x32x16_bf16 v[104:119], v[86:89], v[46:49], v[104:119]
    v_xad_u32 v20, v9, 48, s53
    ds_read_b128 v[38:41], v20
    ds_read_b64_tr_b16 v[70:71], v15 offset:6144
    ds_read_b64_tr_b16 v[72:73], v15 offset:6656
    ds_read_b64_tr_b16 v[74:75], v16 offset:6144
    v_mfma_f32_32x32x16_bf16 v[120:135], v[90:93], v[46:49], v[120:135]
    ds_read_b64_tr_b16 v[76:77], v16 offset:6656
    ds_read_b64_tr_b16 v[78:79], v17 offset:6144
    ds_read_b64_tr_b16 v[80:81], v17 offset:6656
    ds_read_b64_tr_b16 v[82:83], v18 offset:6144
    ds_read_b64_tr_b16 v[84:85], v18 offset:6656
    v_mfma_f32_32x32x16_bf16 v[136:151], v[94:97], v[46:49], v[136:151]
    global_load_dword v243, v103, s[70:71] sc1
    v_mfma_f32_32x32x16_bf16 v[152:167], v[98:101], v[46:49], v[152:167]
    s_waitcnt lgkmcnt(0)
    s_waitcnt vmcnt(8)
    s_barrier
    s_mov_b32 s81, s53
    s_mov_b32 s82, s54
    s_add_u32 s53, s53, 16384
    s_add_u32 s54, s54, 32768
    s_cmp_eq_u32 s53, 59392
    s_cselect_b32 s53, 10240, s53
    s_cselect_b32 s54, 0, s54
    v_add_u32 v15, s54, v11
    v_add_u32 v16, s54, v12
    v_add_u32 v17, s54, v13
    v_add_u32 v18, s54, v14
    v_mfma_f32_32x32x16_bf16 v[104:119], v[54:57], v[30:33], v[104:119]
    v_xad_u32 v20, v9, 0, s53
    ds_read_b128 v[46:49], v20
    ds_read_b64_tr_b16 v[86:87], v15 offset:0
    ds_read_b64_tr_b16 v[88:89], v15 offset:512
    ds_read_b64_tr_b16 v[90:91], v16 offset:0
    v_mfma_f32_32x32x16_bf16 v[120:135], v[58:61], v[30:33], v[120:135]
    ds_read_b64_tr_b16 v[92:93], v16 offset:512
    ds_read_b64_tr_b16 v[94:95], v17 offset:0
    ds_read_b64_tr_b16 v[96:97], v17 offset:512
    ds_read_b64_tr_b16 v[98:99], v18 offset:0
    ds_read_b64_tr_b16 v[100:101], v18 offset:512
    v_mfma_f32_32x32x16_bf16 v[136:151], v[62:65], v[30:33], v[136:151]
    s_add_u32 m0, s65, s81
    s_add_u32 s40, s55, 81920
    buffer_load_dwordx4 v4, s[16:19], s55 offen lds
    v_mfma_f32_32x32x16_bf16 v[152:167], v[66:69], v[30:33], v[152:167]
    s_add_u32 m0, s65, s81
    s_add_u32 m0, m0, 8192
    s_add_u32 s40, s55, 81920
    buffer_load_dwordx4 v4, s[16:19], s40 offen lds
    s_waitcnt lgkmcnt(9)
    v_mfma_f32_32x32x16_bf16 v[104:119], v[70:73], v[38:41], v[104:119]
    v_xad_u32 v20, v9, 16, s53
    ds_read_b128 v[30:33], v20
    ds_read_b64_tr_b16 v[54:55], v15 offset:2048
    ds_read_b64_tr_b16 v[56:57], v15 offset:2560
    ds_read_b64_tr_b16 v[58:59], v16 offset:2048
    v_mfma_f32_32x32x16_bf16 v[120:135], v[74:77], v[38:41], v[120:135]
    ds_read_b64_tr_b16 v[60:61], v16 offset:2560
    ds_read_b64_tr_b16 v[62:63], v17 offset:2048
    ds_read_b64_tr_b16 v[64:65], v17 offset:2560
    ds_read_b64_tr_b16 v[66:67], v18 offset:2048
    ds_read_b64_tr_b16 v[68:69], v18 offset:2560
    v_mfma_f32_32x32x16_bf16 v[136:151], v[78:81], v[38:41], v[136:151]
    s_add_u32 s41, s66, s82
    s_add_u32 m0, s41, 0
    s_nop 0
    buffer_load_dwordx4 v5, s[20:23], s56 offen lds
    v_mfma_f32_32x32x16_bf16 v[152:167], v[82:85], v[38:41], v[152:167]
    s_add_u32 s41, s66, s82
    s_add_u32 m0, s41, 8192
    s_nop 0
    buffer_load_dwordx4 v6, s[24:27], s57 offen lds
    s_waitcnt lgkmcnt(9)
    v_mfma_f32_32x32x16_bf16 v[104:119], v[86:89], v[46:49], v[104:119]
    v_xad_u32 v20, v9, 32, s53
    ds_read_b128 v[38:41], v20
    ds_read_b64_tr_b16 v[70:71], v15 offset:4096
    ds_read_b64_tr_b16 v[72:73], v15 offset:4608
    ds_read_b64_tr_b16 v[74:75], v16 offset:4096
    v_mfma_f32_32x32x16_bf16 v[120:135], v[90:93], v[46:49], v[120:135]
    ds_read_b64_tr_b16 v[76:77], v16 offset:4608
    ds_read_b64_tr_b16 v[78:79], v17 offset:4096
    ds_read_b64_tr_b16 v[80:81], v17 offset:4608
    ds_read_b64_tr_b16 v[82:83], v18 offset:4096
    ds_read_b64_tr_b16 v[84:85], v18 offset:4608
    v_mfma_f32_32x32x16_bf16 v[136:151], v[94:97], v[46:49], v[136:151]
    s_add_u32 s41, s66, s82
    s_add_u32 m0, s41, 16384
    s_nop 0
    buffer_load_dwordx4 v7, s[28:31], s58 offen lds
    v_mfma_f32_32x32x16_bf16 v[152:167], v[98:101], v[46:49], v[152:167]
    s_add_u32 s41, s66, s82
    s_add_u32 m0, s41, 24576
    s_nop 0
    buffer_load_dwordx4 v8, s[32:35], s59 offen lds
    s_add_u32 s55, s55, 128
    s_add_u32 s56, s56, s60
    s_add_u32 s57, s57, s61
    s_add_u32 s58, s58, s62
    s_add_u32 s59, s59, s63
    s_add_u32 s67, s67, 1
    s_cmp_eq_u32 s67, 10
    s_cselect_b32 s67, 0, s67
    s_cselect_b32 s55, 0, s55
    s_cselect_b32 s56, 0, s56
    s_cselect_b32 s57, 0, s57
    s_cselect_b32 s58, 0, s58
    s_cselect_b32 s59, 0, s59
    s_waitcnt lgkmcnt(9)
    v_mfma_f32_32x32x16_bf16 v[104:119], v[54:57], v[30:33], v[104:119]
    v_xad_u32 v20, v9, 48, s53
    ds_read_b128 v[46:49], v20
    ds_read_b64_tr_b16 v[86:87], v15 offset:6144
    ds_read_b64_tr_b16 v[88:89], v15 offset:6656
    ds_read_b64_tr_b16 v[90:91], v16 offset:6144
    v_mfma_f32_32x32x16_bf16 v[120:135], v[58:61], v[30:33], v[120:135]
    ds_read_b64_tr_b16 v[92:93], v16 offset:6656
    ds_read_b64_tr_b16 v[94:95], v17 offset:6144
    ds_read_b64_tr_b16 v[96:97], v17 offset:6656
    ds_read_b64_tr_b16 v[98:99], v18 offset:6144
    ds_read_b64_tr_b16 v[100:101], v18 offset:6656
    v_mfma_f32_32x32x16_bf16 v[136:151], v[62:65], v[30:33], v[136:151]
    buffer_load_dword v102, v103, s[16:19], 0 offen
    v_mfma_f32_32x32x16_bf16 v[152:167], v[66:69], v[30:33], v[152:167]
    s_waitcnt lgkmcnt(0)
    s_waitcnt vmcnt(8)
    s_barrier
    s_mov_b32 s81, s53
    s_mov_b32 s82, s54
    s_add_u32 s53, s53, 16384
    s_add_u32 s54, s54, 32768
    s_cmp_eq_u32 s53, 59392
    s_cselect_b32 s53, 10240, s53
    s_cselect_b32 s54, 0, s54
    v_add_u32 v15, s54, v11
    v_add_u32 v16, s54, v12
    v_add_u32 v17, s54, v13
    v_add_u32 v18, s54, v14
    v_mfma_f32_32x32x16_bf16 v[104:119], v[70:73], v[38:41], v[104:119]
    v_xad_u32 v20, v9, 0, s53
    ds_read_b128 v[30:33], v20
    ds_read_b64_tr_b16 v[54:55], v15 offset:0
    ds_read_b64_tr_b16 v[56:57], v15 offset:512
    ds_read_b64_tr_b16 v[58:59], v16 offset:0
    v_mfma_f32_32x32x16_bf16 v[120:135], v[74:77], v[38:41], v[120:135]
    ds_read_b64_tr_b16 v[60:61], v16 offset:512
    ds_read_b64_tr_b16 v[62:63], v17 offset:0
    ds_read_b64_tr_b16 v[64:65], v17 offset:512
    ds_read_b64_tr_b16 v[66:67], v18 offset:0
    ds_read_b64_tr_b16 v[68:69], v18 offset:512
    v_mfma_f32_32x32x16_bf16 v[136:151], v[78:81], v[38:41], v[136:151]
    s_add_u32 m0, s65, s81
    s_add_u32 s40, s55, 81920
    buffer_load_dwordx4 v4, s[16:19], s55 offen lds
    v_mfma_f32_32x32x16_bf16 v[152:167], v[82:85], v[38:41], v[152:167]
    s_add_u32 m0, s65, s81
    s_add_u32 m0, m0, 8192
    s_add_u32 s40, s55, 81920
    buffer_load_dwordx4 v4, s[16:19], s40 offen lds
    s_waitcnt lgkmcnt(9)
    v_mfma_f32_32x32x16_bf16 v[104:119], v[86:89], v[46:49], v[104:119]
    v_xad_u32 v20, v9, 16, s53
    ds_read_b128 v[38:41], v20
    ds_read_b64_tr_b16 v[70:71], v15 offset:2048
    ds_read_b64_tr_b16 v[72:73], v15 offset:2560
    ds_read_b64_tr_b16 v[74:75], v16 offset:2048
    v_mfma_f32_32x32x16_bf16 v[120:135], v[90:93], v[46:49], v[120:135]
    ds_read_b64_tr_b16 v[76:77], v16 offset:2560
    ds_read_b64_tr_b16 v[78:79], v17 offset:2048
    ds_read_b64_tr_b16 v[80:81], v17 offset:2560
    ds_read_b64_tr_b16 v[82:83], v18 offset:2048
    ds_read_b64_tr_b16 v[84:85], v18 offset:2560
    v_mfma_f32_32x32x16_bf16 v[136:151], v[94:97], v[46:49], v[136:151]
    s_add_u32 s41, s66, s82
    s_add_u32 m0, s41, 0
    s_nop 0
    buffer_load_dwordx4 v5, s[20:23], s56 offen lds
    v_mfma_f32_32x32x16_bf16 v[152:167], v[98:101], v[46:49], v[152:167]
    s_add_u32 s41, s66, s82
    s_add_u32 m0, s41, 8192
    s_nop 0
    buffer_load_dwordx4 v6, s[24:27], s57 offen lds
    v_lshlrev_b32 v28, 4, v0
    v_cmp_gt_u32 vcc, 200, v0
    s_and_saveexec_b64 s[46:47], vcc
    ds_write_b128 v28, v[244:247] offset:1024
    s_mov_b64 exec, s[46:47]
    s_waitcnt lgkmcnt(9)
    v_mfma_f32_32x32x16_bf16 v[104:119], v[54:57], v[30:33], v[104:119]
    v_xad_u32 v20, v9, 32, s53
    ds_read_b128 v[46:49], v20
    ds_read_b64_tr_b16 v[86:87], v15 offset:4096
    ds_read_b64_tr_b16 v[88:89], v15 offset:4608
    ds_read_b64_tr_b16 v[90:91], v16 offset:4096
    v_mfma_f32_32x32x16_bf16 v[120:135], v[58:61], v[30:33], v[120:135]
    ds_read_b64_tr_b16 v[92:93], v16 offset:4608
    ds_read_b64_tr_b16 v[94:95], v17 offset:4096
    ds_read_b64_tr_b16 v[96:97], v17 offset:4608
    ds_read_b64_tr_b16 v[98:99], v18 offset:4096
    ds_read_b64_tr_b16 v[100:101], v18 offset:4608
    v_mfma_f32_32x32x16_bf16 v[136:151], v[62:65], v[30:33], v[136:151]
    s_add_u32 s41, s66, s82
    s_add_u32 m0, s41, 16384
    s_nop 0
    buffer_load_dwordx4 v7, s[28:31], s58 offen lds
    v_mfma_f32_32x32x16_bf16 v[152:167], v[66:69], v[30:33], v[152:167]
    s_add_u32 s41, s66, s82
    s_add_u32 m0, s41, 24576
    s_nop 0
    buffer_load_dwordx4 v8, s[32:35], s59 offen lds
    s_add_u32 s55, s55, 128
    s_add_u32 s56, s56, s60
    s_add_u32 s57, s57, s61
    s_add_u32 s58, s58, s62
    s_add_u32 s59, s59, s63
    s_add_u32 s67, s67, 1
    s_cmp_eq_u32 s67, 10
    s_cselect_b32 s67, 0, s67
    s_cselect_b32 s55, 0, s55
    s_cselect_b32 s56, 0, s56
    s_cselect_b32 s57, 0, s57
    s_cselect_b32 s58, 0, s58
    s_cselect_b32 s59, 0, s59
    s_waitcnt lgkmcnt(9)
    v_mfma_f32_32x32x16_bf16 v[104:119], v[70:73], v[38:41], v[104:119]
    v_xad_u32 v20, v9, 48, s53
    ds_read_b128 v[30:33], v20
    ds_read_b64_tr_b16 v[54:55], v15 offset:6144
    ds_read_b64_tr_b16 v[56:57], v15 offset:6656
    ds_read_b64_tr_b16 v[58:59], v16 offset:6144
    v_mfma_f32_32x32x16_bf16 v[120:135], v[74:77], v[38:41], v[120:135]
    ds_read_b64_tr_b16 v[60:61], v16 offset:6656
    ds_read_b64_tr_b16 v[62:63], v17 offset:6144
    ds_read_b64_tr_b16 v[64:65], v17 offset:6656
    ds_read_b64_tr_b16 v[66:67], v18 offset:6144
    ds_read_b64_tr_b16 v[68:69], v18 offset:6656
    v_mfma_f32_32x32x16_bf16 v[136:151], v[78:81], v[38:41], v[136:151]
    buffer_load_dword v102, v103, s[16:19], 0 offen
    v_mfma_f32_32x32x16_bf16 v[152:167], v[82:85], v[38:41], v[152:167]
    s_waitcnt lgkmcnt(0)
    s_waitcnt vmcnt(8)
    s_barrier
    v_readfirstlane_b32 s40, v243
    s_cmp_lg_u32 s40, 0
    s_cbranch_scc1 K1A0_nc_7ok
    s_mov_b32 s42, 0
K1A0_nc_7:
    s_sleep 4
    global_load_dword v243, v103, s[70:71] sc1
    s_waitcnt vmcnt(0)
    v_readfirstlane_b32 s40, v243
    s_add_u32 s42, s42, 1
    s_cmp_gt_u32 s42, 4000
    s_cbranch_scc1 K1A0_nc_7ok
    s_cmp_eq_u32 s40, 0
    s_cbranch_scc1 K1A0_nc_7
K1A0_nc_7ok:
    s_mov_b32 s100, s40
    s_mov_b32 s81, s53
    s_mov_b32 s82, s54
    s_add_u32 s53, s53, 16384
    s_add_u32 s54, s54, 32768
    s_cmp_eq_u32 s53, 59392
    s_cselect_b32 s53, 10240, s53
    s_cselect_b32 s54, 0, s54
    v_add_u32 v15, s54, v11
    v_add_u32 v16, s54, v12
    v_add_u32 v17, s54, v13
    v_add_u32 v18, s54, v14
    v_mfma_f32_32x32x16_bf16 v[104:119], v[86:89], v[46:49], v[104:119]
    v_xad_u32 v20, v9, 0, s53
    ds_read_b128 v[38:41], v20
    ds_read_b64_tr_b16 v[70:71], v15 offset:0
    ds_read_b64_tr_b16 v[72:73], v15 offset:512
    ds_read_b64_tr_b16 v[74:75], v16 offset:0
    v_mfma_f32_32x32x16_bf16 v[120:135], v[90:93], v[46:49], v[120:135]
    ds_read_b64_tr_b16 v[76:77], v16 offset:512
    ds_read_b64_tr_b16 v[78:79], v17 offset:0
    ds_read_b64_tr_b16 v[80:81], v17 offset:512
    ds_read_b64_tr_b16 v[82:83], v18 offset:0
    ds_read_b64_tr_b16 v[84:85], v18 offset:512
    v_mfma_f32_32x32x16_bf16 v[136:151], v[94:97], v[46:49], v[136:151]
    s_add_u32 m0, s65, s81
    s_add_u32 s40, s55, 81920
    buffer_load_dwordx4 v4, s[16:19], s55 offen lds
    v_mfma_f32_32x32x16_bf16 v[152:167], v[98:101], v[46:49], v[152:167]
    s_add_u32 m0, s65, s81
    s_add_u32 m0, m0, 8192
    s_add_u32 s40, s55, 81920
    buffer_load_dwordx4 v4, s[16:19], s40 offen lds
    s_waitcnt lgkmcnt(9)
    v_mfma_f32_32x32x16_bf16 v[104:119], v[54:57], v[30:33], v[104:119]
    v_xad_u32 v20, v9, 16, s53
    ds_read_b128 v[46:49], v20
    ds_read_b64_tr_b16 v[86:87], v15 offset:2048
    ds_read_b64_tr_b16 v[88:89], v15 offset:2560
    ds_read_b64_tr_b16 v[90:91], v16 offset:2048
    v_mfma_f32_32x32x16_bf16 v[120:135], v[58:61], v[30:33], v[120:135]
    ds_read_b64_tr_b16 v[92:93], v16 offset:2560
    ds_read_b64_tr_b16 v[94:95], v17 offset:2048
    ds_read_b64_tr_b16 v[96:97], v17 offset:2560
    ds_read_b64_tr_b16 v[98:99], v18 offset:2048
    ds_read_b64_tr_b16 v[100:101], v18 offset:2560
    v_mfma_f32_32x32x16_bf16 v[136:151], v[62:65], v[30:33], v[136:151]
    s_add_u32 s41, s66, s82
    s_add_u32 m0, s41, 0
    s_nop 0
    buffer_load_dwordx4 v5, s[20:23], s56 offen lds
    v_mfma_f32_32x32x16_bf16 v[152:167], v[66:69], v[30:33], v[152:167]
    s_add_u32 s41, s66, s82
    s_add_u32 m0, s41, 8192
    s_nop 0
    buffer_load_dwordx4 v6, s[24:27], s57 offen lds
    s_waitcnt lgkmcnt(9)
    v_mfma_f32_32x32x16_bf16 v[104:119], v[70:73], v[38:41], v[104:119]
    v_xad_u32 v20, v9, 32, s53
    ds_read_b128 v[30:33], v20
    ds_read_b64_tr_b16 v[54:55], v15 offset:4096
    ds_read_b64_tr_b16 v[56:57], v15 offset:4608
    ds_read_b64_tr_b16 v[58:59], v16 offset:4096
    v_mfma_f32_32x32x16_bf16 v[120:135], v[74:77], v[38:41], v[120:135]
    ds_read_b64_tr_b16 v[60:61], v16 offset:4608
    ds_read_b64_tr_b16 v[62:63], v17 offset:4096
    ds_read_b64_tr_b16 v[64:65], v17 offset:4608
    ds_read_b64_tr_b16 v[66:67], v18 offset:4096
    ds_read_b64_tr_b16 v[68:69], v18 offset:4608
    v_mfma_f32_32x32x16_bf16 v[136:151], v[78:81], v[38:41], v[136:151]
    s_add_u32 s41, s66, s82
    s_add_u32 m0, s41, 16384
    s_nop 0
    buffer_load_dwordx4 v7, s[28:31], s58 offen lds
    v_mfma_f32_32x32x16_bf16 v[152:167], v[82:85], v[38:41], v[152:167]
    s_add_u32 s41, s66, s82
    s_add_u32 m0, s41, 24576
    s_nop 0
    buffer_load_dwordx4 v8, s[32:35], s59 offen lds
    s_add_u32 s55, s55, 128
    s_add_u32 s56, s56, s60
    s_add_u32 s57, s57, s61
    s_add_u32 s58, s58, s62
    s_add_u32 s59, s59, s63
    s_add_u32 s67, s67, 1
    s_cmp_eq_u32 s67, 10
    s_cselect_b32 s67, 0, s67
    s_cselect_b32 s55, 0, s55
    s_cselect_b32 s56, 0, s56
    s_cselect_b32 s57, 0, s57
    s_cselect_b32 s58, 0, s58
    s_cselect_b32 s59, 0, s59
    s_waitcnt lgkmcnt(9)
    v_mfma_f32_32x32x16_bf16 v[104:119], v[86:89], v[46:49], v[104:119]
    v_xad_u32 v20, v9, 48, s53
    ds_read_b128 v[38:41], v20
    ds_read_b64_tr_b16 v[70:71], v15 offset:6144
    ds_read_b64_tr_b16 v[72:73], v15 offset:6656
    ds_read_b64_tr_b16 v[74:75], v16 offset:6144
    v_mfma_f32_32x32x16_bf16 v[120:135], v[90:93], v[46:49], v[120:135]
    ds_read_b64_tr_b16 v[76:77], v16 offset:6656
    ds_read_b64_tr_b16 v[78:79], v17 offset:6144
    ds_read_b64_tr_b16 v[80:81], v17 offset:6656
    ds_read_b64_tr_b16 v[82:83], v18 offset:6144
    ds_read_b64_tr_b16 v[84:85], v18 offset:6656
    v_mfma_f32_32x32x16_bf16 v[136:151], v[94:97], v[46:49], v[136:151]
    v_mov_b32 v242, v243
    v_mov_b32 v28, s92
    s_mov_b64 s[46:47], exec
    s_mov_b32 exec_lo, 0
    s_mov_b32 exec_hi, 0x80000000
    global_store_dwordx4 v28, v[240:243], s[68:69] sc0 sc1
    s_mov_b64 exec, s[46:47]
    v_mfma_f32_32x32x16_bf16 v[152:167], v[98:101], v[46:49], v[152:167]
    s_waitcnt lgkmcnt(0)
    s_waitcnt vmcnt(8)
    s_barrier
    s_mov_b32 s81, s53
    s_mov_b32 s82, s54
    s_add_u32 s53, s53, 16384
    s_add_u32 s54, s54, 32768
    s_cmp_eq_u32 s53, 59392
    s_cselect_b32 s53, 10240, s53
    s_cselect_b32 s54, 0, s54
    v_add_u32 v15, s54, v11
    v_add_u32 v16, s54, v12
    v_add_u32 v17, s54, v13
    v_add_u32 v18, s54, v14
    v_mfma_f32_32x32x16_bf16 v[104:119], v[54:57], v[30:33], v[104:119]
    v_xad_u32 v20, v9, 0, s53
    ds_read_b128 v[46:49], v20
    ds_read_b64_tr_b16 v[86:87], v15 offset:0
    ds_read_b64_tr_b16 v[88:89], v15 offset:512
    ds_read_b64_tr_b16 v[90:91], v16 offset:0
    v_mfma_f32_32x32x16_bf16 v[120:135], v[58:61], v[30:33], v[120:135]
    ds_read_b64_tr_b16 v[92:93], v16 offset:512
    ds_read_b64_tr_b16 v[94:95], v17 offset:0
    ds_read_b64_tr_b16 v[96:97], v17 offset:512
    ds_read_b64_tr_b16 v[98:99], v18 offset:0
    ds_read_b64_tr_b16 v[100:101], v18 offset:512
    v_mfma_f32_32x32x16_bf16 v[136:151], v[62:65], v[30:33], v[136:151]
    s_add_u32 m0, s65, s81
    s_add_u32 s40, s55, 81920
    buffer_load_dwordx4 v4, s[16:19], s55 offen lds
    v_mfma_f32_32x32x16_bf16 v[152:167], v[66:69], v[30:33], v[152:167]
    s_add_u32 m0, s65, s81
    s_add_u32 m0, m0, 8192
    s_add_u32 s40, s55, 81920
    buffer_load_dwordx4 v4, s[16:19], s40 offen lds
    s_waitcnt lgkmcnt(9)
    v_mfma_f32_32x32x16_bf16 v[104:119], v[70:73], v[38:41], v[104:119]
    v_xad_u32 v20, v9, 16, s53
    ds_read_b128 v[30:33], v20
    ds_read_b64_tr_b16 v[54:55], v15 offset:2048
    ds_read_b64_tr_b16 v[56:57], v15 offset:2560
    ds_read_b64_tr_b16 v[58:59], v16 offset:2048
    v_mfma_f32_32x32x16_bf16 v[120:135], v[74:77], v[38:41], v[120:135]
    ds_read_b64_tr_b16 v[60:61], v16 offset:2560
    ds_read_b64_tr_b16 v[62:63], v17 offset:2048
    ds_read_b64_tr_b16 v[64:65], v17 offset:2560
    ds_read_b64_tr_b16 v[66:67], v18 offset:2048
    ds_read_b64_tr_b16 v[68:69], v18 offset:2560
    v_mfma_f32_32x32x16_bf16 v[136:151], v[78:81], v[38:41], v[136:151]
    s_add_u32 s41, s66, s82
    s_add_u32 m0, s41, 0
    s_nop 0
    buffer_load_dwordx4 v5, s[20:23], s56 offen lds
    v_mfma_f32_32x32x16_bf16 v[152:167], v[82:85], v[38:41], v[152:167]
    s_add_u32 s41, s66, s82
    s_add_u32 m0, s41, 8192
    s_nop 0
    buffer_load_dwordx4 v6, s[24:27], s57 offen lds
    s_waitcnt lgkmcnt(9)
    v_mfma_f32_32x32x16_bf16 v[104:119], v[86:89], v[46:49], v[104:119]
    v_xad_u32 v20, v9, 32, s53
    ds_read_b128 v[38:41], v20
    ds_read_b64_tr_b16 v[70:71], v15 offset:4096
    ds_read_b64_tr_b16 v[72:73], v15 offset:4608
    ds_read_b64_tr_b16 v[74:75], v16 offset:4096
    v_mfma_f32_32x32x16_bf16 v[120:135], v[90:93], v[46:49], v[120:135]
    ds_read_b64_tr_b16 v[76:77], v16 offset:4608
    ds_read_b64_tr_b16 v[78:79], v17 offset:4096
    ds_read_b64_tr_b16 v[80:81], v17 offset:4608
    ds_read_b64_tr_b16 v[82:83], v18 offset:4096
    ds_read_b64_tr_b16 v[84:85], v18 offset:4608
    v_mfma_f32_32x32x16_bf16 v[136:151], v[94:97], v[46:49], v[136:151]
    s_add_u32 s41, s66, s82
    s_add_u32 m0, s41, 16384
    s_nop 0
    buffer_load_dwordx4 v7, s[28:31], s58 offen lds
    v_mfma_f32_32x32x16_bf16 v[152:167], v[98:101], v[46:49], v[152:167]
    s_add_u32 s41, s66, s82
    s_add_u32 m0, s41, 24576
    s_nop 0
    buffer_load_dwordx4 v8, s[32:35], s59 offen lds
    s_add_u32 s55, s55, 128
    s_add_u32 s56, s56, s60
    s_add_u32 s57, s57, s61
    s_add_u32 s58, s58, s62
    s_add_u32 s59, s59, s63
    s_add_u32 s67, s67, 1
    s_cmp_eq_u32 s67, 10
    s_cselect_b32 s67, 0, s67
    s_cselect_b32 s55, 0, s55
    s_cselect_b32 s56, 0, s56
    s_cselect_b32 s57, 0, s57
    s_cselect_b32 s58, 0, s58
    s_cselect_b32 s59, 0, s59
    s_waitcnt lgkmcnt(9)
    v_mfma_f32_32x32x16_bf16 v[104:119], v[54:57], v[30:33], v[104:119]
    v_xad_u32 v20, v9, 48, s53
    ds_read_b128 v[46:49], v20
    ds_read_b64_tr_b16 v[86:87], v15 offset:6144
    ds_read_b64_tr_b16 v[88:89], v15 offset:6656
    ds_read_b64_tr_b16 v[90:91], v16 offset:6144
    v_mfma_f32_32x32x16_bf16 v[120:135], v[58:61], v[30:33], v[120:135]
    ds_read_b64_tr_b16 v[92:93], v16 offset:6656
    ds_read_b64_tr_b16 v[94:95], v17 offset:6144
    ds_read_b64_tr_b16 v[96:97], v17 offset:6656
    ds_read_b64_tr_b16 v[98:99], v18 offset:6144
    ds_read_b64_tr_b16 v[100:101], v18 offset:6656
    v_mfma_f32_32x32x16_bf16 v[136:151], v[62:65], v[30:33], v[136:151]
    s_cmp_lg_u32 s89, 1
    s_cbranch_scc1 K1A0_c2_8e
    v_lshlrev_b32 v28, 2, v0
    ds_read_b32 v168, v28 offset:6144
    ds_read_b32 v169, v28 offset:7168
    ds_read_b32 v170, v28 offset:8192
    ds_read_b32 v171, v28 offset:9216
    s_mul_i32 s40, s86, 20480
    s_lshl_b32 s41, s49, 11
    s_add_u32 s40, s40, s41
    s_add_u32 s40, s40, 19202048
    v_lshl_add_u32 v28, v0, 3, s40
    s_waitcnt lgkmcnt(0)
    v_add_f32 v168, v168, v169
    v_add_f32 v168, v168, v170
    v_add_f32 v168, v168, v171
    v_mov_b32 v169, v243
    global_store_dwordx2 v28, v[168:169], s[68:69] sc0 sc1
    s_branch K1A0_c2_8x
K1A0_c2_8e:
    buffer_load_dword v102, v103, s[16:19], 0 offen
K1A0_c2_8x:
    v_mfma_f32_32x32x16_bf16 v[152:167], v[66:69], v[30:33], v[152:167]
    s_waitcnt lgkmcnt(0)
    s_waitcnt vmcnt(8)
    s_barrier
    s_mov_b32 s81, s53
    s_mov_b32 s82, s54
    s_add_u32 s53, s53, 16384
    s_add_u32 s54, s54, 32768
    s_cmp_eq_u32 s53, 59392
    s_cselect_b32 s53, 10240, s53
    s_cselect_b32 s54, 0, s54
    v_add_u32 v15, s54, v11
    v_add_u32 v16, s54, v12
    v_add_u32 v17, s54, v13
    v_add_u32 v18, s54, v14
    v_mfma_f32_32x32x16_bf16 v[104:119], v[70:73], v[38:41], v[104:119]
    v_xad_u32 v20, v9, 0, s53
    ds_read_b128 v[30:33], v20
    ds_read_b64_tr_b16 v[54:55], v15 offset:0
    ds_read_b64_tr_b16 v[56:57], v15 offset:512
    ds_read_b64_tr_b16 v[58:59], v16 offset:0
    v_mfma_f32_32x32x16_bf16 v[120:135], v[74:77], v[38:41], v[120:135]
    ds_read_b64_tr_b16 v[60:61], v16 offset:512
    ds_read_b64_tr_b16 v[62:63], v17 offset:0
    ds_read_b64_tr_b16 v[64:65], v17 offset:512
    ds_read_b64_tr_b16 v[66:67], v18 offset:0
    ds_read_b64_tr_b16 v[68:69], v18 offset:512
    v_mfma_f32_32x32x16_bf16 v[136:151], v[78:81], v[38:41], v[136:151]
    s_add_u32 m0, s65, s81
    s_add_u32 s40, s55, 81920
    buffer_load_dwordx4 v4, s[16:19], s55 offen lds
    v_mfma_f32_32x32x16_bf16 v[152:167], v[82:85], v[38:41], v[152:167]
    s_add_u32 m0, s65, s81
    s_add_u32 m0, m0, 8192
    s_add_u32 s40, s55, 81920
    buffer_load_dwordx4 v4, s[16:19], s40 offen lds
    s_waitcnt lgkmcnt(9)
    v_mfma_f32_32x32x16_bf16 v[104:119], v[86:89], v[46:49], v[104:119]
    v_xad_u32 v20, v9, 16, s53
    ds_read_b128 v[38:41], v20
    ds_read_b64_tr_b16 v[70:71], v15 offset:2048
    ds_read_b64_tr_b16 v[72:73], v15 offset:2560
    ds_read_b64_tr_b16 v[74:75], v16 offset:2048
    v_mfma_f32_32x32x16_bf16 v[120:135], v[90:93], v[46:49], v[120:135]
    ds_read_b64_tr_b16 v[76:77], v16 offset:2560
    ds_read_b64_tr_b16 v[78:79], v17 offset:2048
    ds_read_b64_tr_b16 v[80:81], v17 offset:2560
    ds_read_b64_tr_b16 v[82:83], v18 offset:2048
    ds_read_b64_tr_b16 v[84:85], v18 offset:2560
    v_mfma_f32_32x32x16_bf16 v[136:151], v[94:97], v[46:49], v[136:151]
    s_add_u32 s41, s66, s82
    s_add_u32 m0, s41, 0
    s_nop 0
    buffer_load_dwordx4 v5, s[20:23], s56 offen lds
    v_mfma_f32_32x32x16_bf16 v[152:167], v[98:101], v[46:49], v[152:167]
    s_add_u32 s41, s66, s82
    s_add_u32 m0, s41, 8192
    s_nop 0
    buffer_load_dwordx4 v6, s[24:27], s57 offen lds
    v_bfe_u32 v22, v1, 4, 1
    v_lshlrev_b32 v22, 2, v22
    v_and_b32 v23, 3, v1
    v_add_u32 v22, v22, v23
    v_and_b32 v23, 1, v22
    v_lshrrev_b32 v22, 1, v22
    v_bfe_u32 v24, v1, 2, 2
    v_mul_u32_u24 v24, 40, v24
    v_lshl_add_u32 v24, v22, 3, v24
    s_mul_i32 s40, s51, 1600
    v_mul_u32_u24 v25, 800, v23
    v_add3_u32 v24, v24, v25, s40
    v_add_u32 v24, 1024, v24
    v_mov_b32 v25, 4224
    v_cmp_eq_u32 vcc, v23, v3
    s_mul_i32 s40, s51, 512
    v_lshl_add_u32 v255, v3, 4, s40
    v_cndmask_b32 v254, v25, v24, vcc
    v_lshrrev_b32 v22, 7, v9
    s_lshl_b32 s40, s51, 1
    v_add_u32 v23, s40, v3
    v_mul_u32_u24 v251, 192, v22
    v_mad_u32_u24 v251, v23, 48, v251
    v_add_u32 v251, 51200, v251
    v_mul_u32_u24 v252, 320, v22
    v_mul_u32_u24 v24, 80, v23
    v_add_u32 v252, v252, v24
    s_lshl_b32 s40, s49, 2
    s_add_u32 s40, s40, s52
    s_mul_i32 s40, s40, 80
    s_lshl_b32 s41, s50, 3
    s_add_u32 s40, s40, s41
    s_lshl_b32 s40, s40, 9
    v_lshl_add_u32 v253, v2, 4, s40
    s_waitcnt lgkmcnt(9)
    v_mfma_f32_32x32x16_bf16 v[104:119], v[54:57], v[30:33], v[104:119]
    v_xad_u32 v20, v9, 32, s53
    ds_read_b128 v[46:49], v20
    ds_read_b64_tr_b16 v[86:87], v15 offset:4096
    ds_read_b64_tr_b16 v[88:89], v15 offset:4608
    ds_read_b64_tr_b16 v[90:91], v16 offset:4096
    v_mfma_f32_32x32x16_bf16 v[120:135], v[58:61], v[30:33], v[120:135]
    ds_read_b64_tr_b16 v[92:93], v16 offset:4608
    ds_read_b64_tr_b16 v[94:95], v17 offset:4096
    ds_read_b64_tr_b16 v[96:97], v17 offset:4608
    ds_read_b64_tr_b16 v[98:99], v18 offset:4096
    ds_read_b64_tr_b16 v[100:101], v18 offset:4608
    v_mfma_f32_32x32x16_bf16 v[136:151], v[62:65], v[30:33], v[136:151]
    s_add_u32 s41, s66, s82
    s_add_u32 m0, s41, 16384
    s_nop 0
    buffer_load_dwordx4 v7, s[28:31], s58 offen lds
    v_mfma_f32_32x32x16_bf16 v[152:167], v[66:69], v[30:33], v[152:167]
    s_add_u32 s41, s66, s82
    s_add_u32 m0, s41, 24576
    s_nop 0
    buffer_load_dwordx4 v8, s[32:35], s59 offen lds
    s_add_u32 s55, s55, 128
    s_add_u32 s56, s56, s60
    s_add_u32 s57, s57, s61
    s_add_u32 s58, s58, s62
    s_add_u32 s59, s59, s63
    s_add_u32 s67, s67, 1
    s_cmp_eq_u32 s67, 10
    s_cselect_b32 s67, 0, s67
    s_cselect_b32 s55, 0, s55
    s_cselect_b32 s56, 0, s56
    s_cselect_b32 s57, 0, s57
    s_cselect_b32 s58, 0, s58
    s_cselect_b32 s59, 0, s59
    s_waitcnt lgkmcnt(9)
    v_mfma_f32_32x32x16_bf16 v[104:119], v[70:73], v[38:41], v[104:119]
    v_xad_u32 v20, v9, 48, s53
    ds_read_b128 v[30:33], v20
    ds_read_b64_tr_b16 v[54:55], v15 offset:6144
    ds_read_b64_tr_b16 v[56:57], v15 offset:6656
    ds_read_b64_tr_b16 v[58:59], v16 offset:6144
    v_mfma_f32_32x32x16_bf16 v[120:135], v[74:77], v[38:41], v[120:135]
    ds_read_b64_tr_b16 v[60:61], v16 offset:6656
    ds_read_b64_tr_b16 v[62:63], v17 offset:6144
    ds_read_b64_tr_b16 v[64:65], v17 offset:6656
    ds_read_b64_tr_b16 v[66:67], v18 offset:6144
    ds_read_b64_tr_b16 v[68:69], v18 offset:6656
    v_mfma_f32_32x32x16_bf16 v[136:151], v[78:81], v[38:41], v[136:151]
    buffer_load_dword v102, v103, s[16:19], 0 offen
    v_mfma_f32_32x32x16_bf16 v[152:167], v[82:85], v[38:41], v[152:167]
    s_waitcnt lgkmcnt(0)
    s_waitcnt vmcnt(8)
    s_barrier
    s_mov_b32 s81, s53
    s_mov_b32 s82, s54
    s_add_u32 s53, s53, 16384
    s_add_u32 s54, s54, 32768
    s_cmp_eq_u32 s53, 59392
    s_cselect_b32 s53, 10240, s53
    s_cselect_b32 s54, 0, s54
    v_add_u32 v15, s54, v11
    v_add_u32 v16, s54, v12
    v_add_u32 v17, s54, v13
    v_add_u32 v18, s54, v14
    v_mfma_f32_32x32x16_bf16 v[104:119], v[86:89], v[46:49], v[104:119]
    v_xad_u32 v20, v9, 0, s53
    ds_read_b128 v[38:41], v20
    ds_read_b64_tr_b16 v[70:71], v15 offset:0
    ds_read_b64_tr_b16 v[72:73], v15 offset:512
    ds_read_b64_tr_b16 v[74:75], v16 offset:0
    v_mfma_f32_32x32x16_bf16 v[120:135], v[90:93], v[46:49], v[120:135]
    ds_read_b64_tr_b16 v[76:77], v16 offset:512
    ds_read_b64_tr_b16 v[78:79], v17 offset:0
    ds_read_b64_tr_b16 v[80:81], v17 offset:512
    ds_read_b64_tr_b16 v[82:83], v18 offset:0
    ds_read_b64_tr_b16 v[84:85], v18 offset:512
    v_mfma_f32_32x32x16_bf16 v[136:151], v[94:97], v[46:49], v[136:151]
    s_add_u32 m0, s65, s81
    s_add_u32 s40, s55, 81920
    buffer_load_dwordx4 v4, s[16:19], s55 offen lds
    v_mfma_f32_32x32x16_bf16 v[152:167], v[98:101], v[46:49], v[152:167]
    s_add_u32 m0, s65, s81
    s_add_u32 m0, m0, 8192
    s_add_u32 s40, s55, 81920
    buffer_load_dwordx4 v4, s[16:19], s40 offen lds
    s_waitcnt lgkmcnt(9)
    v_mfma_f32_32x32x16_bf16 v[104:119], v[54:57], v[30:33], v[104:119]
    v_xad_u32 v20, v9, 16, s53
    ds_read_b128 v[46:49], v20
    ds_read_b64_tr_b16 v[86:87], v15 offset:2048
    ds_read_b64_tr_b16 v[88:89], v15 offset:2560
    ds_read_b64_tr_b16 v[90:91], v16 offset:2048
    v_mfma_f32_32x32x16_bf16 v[120:135], v[58:61], v[30:33], v[120:135]
    ds_read_b64_tr_b16 v[92:93], v16 offset:2560
    ds_read_b64_tr_b16 v[94:95], v17 offset:2048
    ds_read_b64_tr_b16 v[96:97], v17 offset:2560
    ds_read_b64_tr_b16 v[98:99], v18 offset:2048
    ds_read_b64_tr_b16 v[100:101], v18 offset:2560
    v_mfma_f32_32x32x16_bf16 v[136:151], v[62:65], v[30:33], v[136:151]
    s_add_u32 s41, s66, s82
    s_add_u32 m0, s41, 0
    s_nop 0
    buffer_load_dwordx4 v5, s[20:23], s56 offen lds
    v_mfma_f32_32x32x16_bf16 v[152:167], v[66:69], v[30:33], v[152:167]
    s_add_u32 s41, s66, s82
    s_add_u32 m0, s41, 8192
    s_nop 0
    buffer_load_dwordx4 v6, s[24:27], s57 offen lds
    s_waitcnt lgkmcnt(9)
    v_mfma_f32_32x32x16_bf16 v[104:119], v[70:73], v[38:41], v[104:119]
    v_xad_u32 v20, v9, 32, s53
    ds_read_b128 v[30:33], v20
    ds_read_b64_tr_b16 v[54:55], v15 offset:4096
    ds_read_b64_tr_b16 v[56:57], v15 offset:4608
    ds_read_b64_tr_b16 v[58:59], v16 offset:4096
    v_mfma_f32_32x32x16_bf16 v[120:135], v[74:77], v[38:41], v[120:135]
    ds_read_b64_tr_b16 v[60:61], v16 offset:4608
    ds_read_b64_tr_b16 v[62:63], v17 offset:4096
    ds_read_b64_tr_b16 v[64:65], v17 offset:4608
    ds_read_b64_tr_b16 v[66:67], v18 offset:4096
    ds_read_b64_tr_b16 v[68:69], v18 offset:4608
    v_mfma_f32_32x32x16_bf16 v[136:151], v[78:81], v[38:41], v[136:151]
    s_add_u32 s41, s66, s82
    s_add_u32 m0, s41, 16384
    s_nop 0
    buffer_load_dwordx4 v7, s[28:31], s58 offen lds
    v_mfma_f32_32x32x16_bf16 v[152:167], v[82:85], v[38:41], v[152:167]
    s_add_u32 s41, s66, s82
    s_add_u32 m0, s41, 24576
    s_nop 0
    buffer_load_dwordx4 v8, s[32:35], s59 offen lds
    s_add_u32 s55, s55, 128
    s_add_u32 s56, s56, s60
    s_add_u32 s57, s57, s61
    s_add_u32 s58, s58, s62
    s_add_u32 s59, s59, s63
    s_add_u32 s67, s67, 1
    s_cmp_eq_u32 s67, 10
    s_cselect_b32 s67, 0, s67
    s_cselect_b32 s55, 0, s55
    s_cselect_b32 s56, 0, s56
    s_cselect_b32 s57, 0, s57
    s_cselect_b32 s58, 0, s58
    s_cselect_b32 s59, 0, s59
    s_waitcnt lgkmcnt(9)
    v_mfma_f32_32x32x16_bf16 v[104:119], v[86:89], v[46:49], v[104:119]
    v_xad_u32 v20, v9, 48, s53
    ds_read_b128 v[38:41], v20
    ds_read_b64_tr_b16 v[70:71], v15 offset:6144
    ds_read_b64_tr_b16 v[72:73], v15 offset:6656
    ds_read_b64_tr_b16 v[74:75], v16 offset:6144
    v_mfma_f32_32x32x16_bf16 v[120:135], v[90:93], v[46:49], v[120:135]
    ds_read_b64_tr_b16 v[76:77], v16 offset:6656
    ds_read_b64_tr_b16 v[78:79], v17 offset:6144
    ds_read_b64_tr_b16 v[80:81], v17 offset:6656
    ds_read_b64_tr_b16 v[82:83], v18 offset:6144
    ds_read_b64_tr_b16 v[84:85], v18 offset:6656
    v_mfma_f32_32x32x16_bf16 v[136:151], v[94:97], v[46:49], v[136:151]
    buffer_load_dword v102, v103, s[16:19], 0 offen
    v_mfma_f32_32x32x16_bf16 v[152:167], v[98:101], v[46:49], v[152:167]
    s_waitcnt lgkmcnt(0)
    s_waitcnt vmcnt(8)
    s_barrier
    s_mov_b32 s81, s53
    s_mov_b32 s82, s54
    s_add_u32 s53, s53, 16384
    s_add_u32 s54, s54, 32768
    s_cmp_eq_u32 s53, 59392
    s_cselect_b32 s53, 10240, s53
    s_cselect_b32 s54, 0, s54
    v_add_u32 v15, s54, v11
    v_add_u32 v16, s54, v12
    v_add_u32 v17, s54, v13
    v_add_u32 v18, s54, v14
    v_mfma_f32_32x32x16_bf16 v[104:119], v[54:57], v[30:33], v[104:119]
    v_xad_u32 v20, v9, 0, s53
    ds_read_b128 v[46:49], v20
    ds_read_b64_tr_b16 v[86:87], v15 offset:0
    ds_read_b64_tr_b16 v[88:89], v15 offset:512
    ds_read_b64_tr_b16 v[90:91], v16 offset:0
    v_mfma_f32_32x32x16_bf16 v[120:135], v[58:61], v[30:33], v[120:135]
    ds_read_b64_tr_b16 v[92:93], v16 offset:512
    ds_read_b64_tr_b16 v[94:95], v17 offset:0
    ds_read_b64_tr_b16 v[96:97], v17 offset:512
    ds_read_b64_tr_b16 v[98:99], v18 offset:0
    ds_read_b64_tr_b16 v[100:101], v18 offset:512
    v_mfma_f32_32x32x16_bf16 v[136:151], v[62:65], v[30:33], v[136:151]
    v_mfma_f32_32x32x16_bf16 v[152:167], v[66:69], v[30:33], v[152:167]
    s_waitcnt lgkmcnt(9)
    v_mfma_f32_32x32x16_bf16 v[104:119], v[70:73], v[38:41], v[104:119]
    v_xad_u32 v20, v9, 16, s53
    ds_read_b128 v[30:33], v20
    ds_read_b64_tr_b16 v[54:55], v15 offset:2048
    ds_read_b64_tr_b16 v[56:57], v15 offset:2560
    ds_read_b64_tr_b16 v[58:59], v16 offset:2048
    v_mfma_f32_32x32x16_bf16 v[120:135], v[74:77], v[38:41], v[120:135]
    ds_read_b64_tr_b16 v[60:61], v16 offset:2560
    ds_read_b64_tr_b16 v[62:63], v17 offset:2048
    ds_read_b64_tr_b16 v[64:65], v17 offset:2560
    ds_read_b64_tr_b16 v[66:67], v18 offset:2048
    ds_read_b64_tr_b16 v[68:69], v18 offset:2560
    v_mfma_f32_32x32x16_bf16 v[136:151], v[78:81], v[38:41], v[136:151]
    v_mfma_f32_32x32x16_bf16 v[152:167], v[82:85], v[38:41], v[152:167]
    s_waitcnt lgkmcnt(9)
    v_mfma_f32_32x32x16_bf16 v[104:119], v[86:89], v[46:49], v[104:119]
    v_xad_u32 v20, v9, 32, s53
    ds_read_b128 v[38:41], v20
    ds_read_b64_tr_b16 v[70:71], v15 offset:4096
    ds_read_b64_tr_b16 v[72:73], v15 offset:4608
    ds_read_b64_tr_b16 v[74:75], v16 offset:4096
    v_mfma_f32_32x32x16_bf16 v[120:135], v[90:93], v[46:49], v[120:135]
    ds_read_b64_tr_b16 v[76:77], v16 offset:4608
    ds_read_b64_tr_b16 v[78:79], v17 offset:4096
    ds_read_b64_tr_b16 v[80:81], v17 offset:4608
    ds_read_b64_tr_b16 v[82:83], v18 offset:4096
    ds_read_b64_tr_b16 v[84:85], v18 offset:4608
    v_mfma_f32_32x32x16_bf16 v[136:151], v[94:97], v[46:49], v[136:151]
    v_mfma_f32_32x32x16_bf16 v[152:167], v[98:101], v[46:49], v[152:167]
    s_waitcnt lgkmcnt(9)
    v_mfma_f32_32x32x16_bf16 v[104:119], v[54:57], v[30:33], v[104:119]
    v_xad_u32 v20, v9, 48, s53
    ds_read_b128 v[46:49], v20
    ds_read_b64_tr_b16 v[86:87], v15 offset:6144
    ds_read_b64_tr_b16 v[88:89], v15 offset:6656
    ds_read_b64_tr_b16 v[90:91], v16 offset:6144
    v_mfma_f32_32x32x16_bf16 v[120:135], v[58:61], v[30:33], v[120:135]
    ds_read_b64_tr_b16 v[92:93], v16 offset:6656
    ds_read_b64_tr_b16 v[94:95], v17 offset:6144
    ds_read_b64_tr_b16 v[96:97], v17 offset:6656
    ds_read_b64_tr_b16 v[98:99], v18 offset:6144
    ds_read_b64_tr_b16 v[100:101], v18 offset:6656
    v_mfma_f32_32x32x16_bf16 v[136:151], v[62:65], v[30:33], v[136:151]
    v_mfma_f32_32x32x16_bf16 v[152:167], v[66:69], v[30:33], v[152:167]
    s_waitcnt lgkmcnt(0)
    s_waitcnt vmcnt(1)
    s_barrier
    s_mov_b32 s81, s53
    s_mov_b32 s82, s54
    s_add_u32 s53, s53, 16384
    s_add_u32 s54, s54, 32768
    s_cmp_eq_u32 s53, 59392
    s_cselect_b32 s53, 10240, s53
    s_cselect_b32 s54, 0, s54
    v_add_u32 v15, s54, v11
    v_add_u32 v16, s54, v12
    v_add_u32 v17, s54, v13
    v_add_u32 v18, s54, v14
    v_mfma_f32_32x32x16_bf16 v[104:119], v[70:73], v[38:41], v[104:119]
    v_xad_u32 v20, v9, 0, s53
    ds_read_b128 v[30:33], v20
    ds_read_b64_tr_b16 v[54:55], v15 offset:0
    ds_read_b64_tr_b16 v[56:57], v15 offset:512
    ds_read_b64_tr_b16 v[58:59], v16 offset:0
    v_mfma_f32_32x32x16_bf16 v[120:135], v[74:77], v[38:41], v[120:135]
    ds_read_b64_tr_b16 v[60:61], v16 offset:512
    ds_read_b64_tr_b16 v[62:63], v17 offset:0
    ds_read_b64_tr_b16 v[64:65], v17 offset:512
    ds_read_b64_tr_b16 v[66:67], v18 offset:0
    ds_read_b64_tr_b16 v[68:69], v18 offset:512
    v_mfma_f32_32x32x16_bf16 v[136:151], v[78:81], v[38:41], v[136:151]
    v_mfma_f32_32x32x16_bf16 v[152:167], v[82:85], v[38:41], v[152:167]
    v_lshrrev_b32 v28, 7, v9
    s_lshl_b32 s40, s49, 7
    v_add_u32 v28, s40, v28
    v_lshlrev_b32 v28, 4, v28
    v_add_u32 v28, 19136512, v28
    global_load_dwordx4 v[192:195], v28, s[68:69] sc1
    s_cmp_ge_u32 s48, 4
    s_cbranch_scc1 K1_csl_9
    s_mul_i32 s40, s86, 20480
    s_add_u32 s40, s40, 19202048
    v_lshl_add_u32 v28, v0, 3, s40
    global_load_dwordx2 v[200:201], v28, s[68:69] offset:0 sc1
    global_load_dwordx2 v[202:203], v28, s[68:69] offset:2048 sc1
    v_add_u32 v28, 4096, v28
    global_load_dwordx2 v[204:205], v28, s[68:69] offset:0 sc1
    global_load_dwordx2 v[206:207], v28, s[68:69] offset:2048 sc1
    v_add_u32 v28, 4096, v28
    global_load_dwordx2 v[208:209], v28, s[68:69] offset:0 sc1
    global_load_dwordx2 v[210:211], v28, s[68:69] offset:2048 sc1
    v_add_u32 v28, 4096, v28
    global_load_dwordx2 v[212:213], v28, s[68:69] offset:0 sc1
    global_load_dwordx2 v[214:215], v28, s[68:69] offset:2048 sc1
    v_add_u32 v28, 4096, v28
    global_load_dwordx2 v[216:217], v28, s[68:69] offset:0 sc1
    global_load_dwordx2 v[218:219], v28, s[68:69] offset:2048 sc1
K1_csl_9:
    s_waitcnt lgkmcnt(9)
    v_mfma_f32_32x32x16_bf16 v[104:119], v[86:89], v[46:49], v[104:119]
    v_xad_u32 v20, v9, 16, s53
    ds_read_b128 v[38:41], v20
    ds_read_b64_tr_b16 v[70:71], v15 offset:2048
    ds_read_b64_tr_b16 v[72:73], v15 offset:2560
    ds_read_b64_tr_b16 v[74:75], v16 offset:2048
    v_mfma_f32_32x32x16_bf16 v[120:135], v[90:93], v[46:49], v[120:135]
    ds_read_b64_tr_b16 v[76:77], v16 offset:2560
    ds_read_b64_tr_b16 v[78:79], v17 offset:2048
    ds_read_b64_tr_b16 v[80:81], v17 offset:2560
    ds_read_b64_tr_b16 v[82:83], v18 offset:2048
    ds_read_b64_tr_b16 v[84:85], v18 offset:2560
    v_mfma_f32_32x32x16_bf16 v[136:151], v[94:97], v[46:49], v[136:151]
    v_mfma_f32_32x32x16_bf16 v[152:167], v[98:101], v[46:49], v[152:167]
    s_waitcnt lgkmcnt(9)
    v_mfma_f32_32x32x16_bf16 v[104:119], v[54:57], v[30:33], v[104:119]
    v_xad_u32 v20, v9, 32, s53
    ds_read_b128 v[46:49], v20
    ds_read_b64_tr_b16 v[86:87], v15 offset:4096
    ds_read_b64_tr_b16 v[88:89], v15 offset:4608
    ds_read_b64_tr_b16 v[90:91], v16 offset:4096
    v_mfma_f32_32x32x16_bf16 v[120:135], v[58:61], v[30:33], v[120:135]
    ds_read_b64_tr_b16 v[92:93], v16 offset:4608
    ds_read_b64_tr_b16 v[94:95], v17 offset:4096
    ds_read_b64_tr_b16 v[96:97], v17 offset:4608
    ds_read_b64_tr_b16 v[98:99], v18 offset:4096
    ds_read_b64_tr_b16 v[100:101], v18 offset:4608
    v_mfma_f32_32x32x16_bf16 v[136:151], v[62:65], v[30:33], v[136:151]
    v_mfma_f32_32x32x16_bf16 v[152:167], v[66:69], v[30:33], v[152:167]
    s_waitcnt lgkmcnt(9)
    v_mfma_f32_32x32x16_bf16 v[104:119], v[70:73], v[38:41], v[104:119]
    v_xad_u32 v20, v9, 48, s53
    ds_read_b128 v[30:33], v20
    ds_read_b64_tr_b16 v[54:55], v15 offset:6144
    ds_read_b64_tr_b16 v[56:57], v15 offset:6656
    ds_read_b64_tr_b16 v[58:59], v16 offset:6144
    v_mfma_f32_32x32x16_bf16 v[120:135], v[74:77], v[38:41], v[120:135]
    ds_read_b64_tr_b16 v[60:61], v16 offset:6656
    ds_read_b64_tr_b16 v[62:63], v17 offset:6144
    ds_read_b64_tr_b16 v[64:65], v17 offset:6656
    ds_read_b64_tr_b16 v[66:67], v18 offset:6144
    ds_read_b64_tr_b16 v[68:69], v18 offset:6656
    v_mfma_f32_32x32x16_bf16 v[136:151], v[78:81], v[38:41], v[136:151]
    v_mfma_f32_32x32x16_bf16 v[152:167], v[82:85], v[38:41], v[152:167]
    s_mov_b32 s42, 0
K1_gr_10:
    s_waitcnt vmcnt(0)
    v_cmp_ne_u32 vcc, v194, v243
    s_cmp_ge_u32 s48, 4
    s_cbranch_scc1 K1_grc_11
    v_cmp_ne_u32 s[40:41], v201, v243
    s_or_b64 vcc, vcc, s[40:41]
    v_cmp_ne_u32 s[40:41], v203, v243
    s_or_b64 vcc, vcc, s[40:41]
    v_cmp_ne_u32 s[40:41], v205, v243
    s_or_b64 vcc, vcc, s[40:41]
    v_cmp_ne_u32 s[40:41], v207, v243
    s_or_b64 vcc, vcc, s[40:41]
    v_cmp_ne_u32 s[40:41], v209, v243
    s_or_b64 vcc, vcc, s[40:41]
    v_cmp_ne_u32 s[40:41], v211, v243
    s_or_b64 vcc, vcc, s[40:41]
    v_cmp_ne_u32 s[40:41], v213, v243
    s_or_b64 vcc, vcc, s[40:41]
    v_cmp_ne_u32 s[40:41], v215, v243
    s_or_b64 vcc, vcc, s[40:41]
    v_cmp_ne_u32 s[40:41], v217, v243
    s_or_b64 vcc, vcc, s[40:41]
    v_cmp_ne_u32 s[40:41], v219, v243
    s_or_b64 vcc, vcc, s[40:41]
K1_grc_11:
    s_add_u32 s42, s42, 1
    s_cmp_gt_u32 s42, 4000
    s_cbranch_scc1 K1_gr_10ok
    s_cbranch_vccz K1_gr_10ok
    s_sleep 4
    v_lshrrev_b32 v28, 7, v9
    s_lshl_b32 s40, s49, 7
    v_add_u32 v28, s40, v28
    v_lshlrev_b32 v28, 4, v28
    v_add_u32 v28, 19136512, v28
    global_load_dwordx4 v[192:195], v28, s[68:69] sc1
    s_cmp_ge_u32 s48, 4
    s_cbranch_scc1 K1_csl_12
    s_mul_i32 s40, s86, 20480
    s_add_u32 s40, s40, 19202048
    v_lshl_add_u32 v28, v0, 3, s40
    global_load_dwordx2 v[200:201], v28, s[68:69] offset:0 sc1
    global_load_dwordx2 v[202:203], v28, s[68:69] offset:2048 sc1
    v_add_u32 v28, 4096, v28
    global_load_dwordx2 v[204:205], v28, s[68:69] offset:0 sc1
    global_load_dwordx2 v[206:207], v28, s[68:69] offset:2048 sc1
    v_add_u32 v28, 4096, v28
    global_load_dwordx2 v[208:209], v28, s[68:69] offset:0 sc1
    global_load_dwordx2 v[210:211], v28, s[68:69] offset:2048 sc1
    v_add_u32 v28, 4096, v28
    global_load_dwordx2 v[212:213], v28, s[68:69] offset:0 sc1
    global_load_dwordx2 v[214:215], v28, s[68:69] offset:2048 sc1
    v_add_u32 v28, 4096, v28
    global_load_dwordx2 v[216:217], v28, s[68:69] offset:0 sc1
    global_load_dwordx2 v[218:219], v28, s[68:69] offset:2048 sc1
K1_csl_12:
    s_branch K1_gr_10
K1_gr_10ok:
    v_mov_b32 v248, v192
    v_mov_b32 v249, v193
    s_cmp_ge_u32 s48, 4
    s_cbranch_scc1 K1_cs2_13
    v_add_f32 v200, v200, v202
    v_add_f32 v200, v200, v204
    v_add_f32 v200, v200, v206
    v_add_f32 v200, v200, v208
    v_add_f32 v200, v200, v210
    v_add_f32 v200, v200, v212
    v_add_f32 v200, v200, v214
    v_add_f32 v200, v200, v216
    v_add_f32 v200, v200, v218
    v_lshlrev_b32 v28, 2, v0
    ds_write_b32 v28, v200 offset:0
K1_cs2_13:
    s_waitcnt lgkmcnt(0)
    s_barrier
    ds_read_b128 v[168:171], v255 offset:0
    ds_read_b128 v[172:175], v255 offset:32
    ds_read_b128 v[176:179], v255 offset:64
    ds_read_b128 v[180:183], v255 offset:96
    ds_read_b128 v[184:187], v255 offset:128
    ds_read_b128 v[188:191], v255 offset:160
    ds_read_b128 v[192:195], v255 offset:192
    ds_read_b128 v[196:199], v255 offset:224
    ds_read_b128 v[200:203], v255 offset:256
    ds_read_b128 v[204:207], v255 offset:288
    ds_read_b128 v[208:211], v255 offset:320
    ds_read_b128 v[212:215], v255 offset:352
    ds_read_b64_tr_b16 v[216:217], v254 offset:0
    ds_read_b64_tr_b16 v[218:219], v254 offset:160
    ds_read_b64_tr_b16 v[220:221], v254 offset:320
    ds_read_b64_tr_b16 v[222:223], v254 offset:480
    ds_read_b64_tr_b16 v[224:225], v254 offset:640
    ds_read_b64_tr_b16 v[226:227], v254 offset:800
    ds_read_b64_tr_b16 v[228:229], v254 offset:32
    ds_read_b64_tr_b16 v[230:231], v254 offset:192
    ds_read_b64_tr_b16 v[232:233], v254 offset:352
    ds_read_b64_tr_b16 v[234:235], v254 offset:512
    ds_read_b64_tr_b16 v[236:237], v254 offset:672
    ds_read_b64_tr_b16 v[238:239], v254 offset:832
    v_mfma_f32_32x32x16_bf16 v[104:119], v[86:89], v[46:49], v[104:119]
    v_mfma_f32_32x32x16_bf16 v[120:135], v[90:93], v[46:49], v[120:135]
    v_mfma_f32_32x32x16_bf16 v[136:151], v[94:97], v[46:49], v[136:151]
    v_mfma_f32_32x32x16_bf16 v[152:167], v[98:101], v[46:49], v[152:167]
    s_waitcnt lgkmcnt(0)
    v_mfma_f32_32x32x16_bf16 v[104:119], v[54:57], v[30:33], v[104:119]
    v_mfma_f32_32x32x16_bf16 v[120:135], v[58:61], v[30:33], v[120:135]
    v_mfma_f32_32x32x16_bf16 v[136:151], v[62:65], v[30:33], v[136:151]
    v_mfma_f32_32x32x16_bf16 v[152:167], v[66:69], v[30:33], v[152:167]
    s_branch K1A0_EXIT
K1A0_EXIT:
    s_branch K1A_EPI
K1A_H1:
    s_waitcnt lgkmcnt(0)
    s_barrier
    s_mov_b32 s81, 43008
    s_mov_b32 s82, 65536
    v_add_u32 v15, s54, v11
    v_add_u32 v16, s54, v12
    v_add_u32 v17, s54, v13
    v_xad_u32 v20, v9, 0, s53
    ds_read_b128 v[30:33], v20
    ds_read_b64_tr_b16 v[54:55], v15 offset:0
    ds_read_b64_tr_b16 v[56:57], v15 offset:512
    ds_read_b64_tr_b16 v[58:59], v16 offset:0
    ds_read_b64_tr_b16 v[60:61], v16 offset:512
    ds_read_b64_tr_b16 v[62:63], v17 offset:0
    ds_read_b64_tr_b16 v[64:65], v17 offset:512
    v_xad_u32 v20, v9, 16, s53
    ds_read_b128 v[38:41], v20
    ds_read_b64_tr_b16 v[70:71], v15 offset:2048
    ds_read_b64_tr_b16 v[72:73], v15 offset:2560
    ds_read_b64_tr_b16 v[74:75], v16 offset:2048
    ds_read_b64_tr_b16 v[76:77], v16 offset:2560
    ds_read_b64_tr_b16 v[78:79], v17 offset:2048
    ds_read_b64_tr_b16 v[80:81], v17 offset:2560
    s_waitcnt lgkmcnt(7)
    v_mfma_f32_32x32x16_bf16 v[104:119], v[54:57], v[30:33], 0
    v_xad_u32 v20, v9, 32, s53
    ds_read_b128 v[46:49], v20
    ds_read_b64_tr_b16 v[86:87], v15 offset:4096
    ds_read_b64_tr_b16 v[88:89], v15 offset:4608
    s_add_u32 m0, s65, s81
    s_add_u32 s40, s55, 81920
    buffer_load_dwordx4 v4, s[16:19], s55 offen lds
    s_add_u32 m0, s65, s81
    s_add_u32 m0, m0, 8192
    s_add_u32 s40, s55, 81920
    buffer_load_dwordx4 v4, s[16:19], s40 offen lds
    v_mfma_f32_32x32x16_bf16 v[120:135], v[58:61], v[30:33], 0
    ds_read_b64_tr_b16 v[90:91], v16 offset:4096
    ds_read_b64_tr_b16 v[92:93], v16 offset:4608
    ds_read_b64_tr_b16 v[94:95], v17 offset:4096
    ds_read_b64_tr_b16 v[96:97], v17 offset:4608
    s_add_u32 s41, s66, s82
    s_add_u32 m0, s41, 0
    s_nop 0
    buffer_load_dwordx4 v5, s[20:23], s56 offen lds
    s_add_u32 s41, s66, s82
    s_add_u32 m0, s41, 8192
    s_nop 0
    buffer_load_dwordx4 v6, s[24:27], s57 offen lds
    v_mfma_f32_32x32x16_bf16 v[136:151], v[62:65], v[30:33], 0
    s_add_u32 s41, s66, s82
    s_add_u32 m0, s41, 16384
    s_nop 0
    buffer_load_dwordx4 v7, s[28:31], s58 offen lds
    s_add_u32 s41, s66, s82
    s_add_u32 m0, s41, 24576
    s_nop 0
    buffer_load_dwordx4 v8, s[32:35], s59 offen lds
    s_add_u32 s55, s55, 128
    s_add_u32 s56, s56, s60
    s_add_u32 s57, s57, s61
    s_add_u32 s58, s58, s62
    s_add_u32 s59, s59, s63
    s_add_u32 s67, s67, 1
    s_cmp_eq_u32 s67, 10
    s_cselect_b32 s67, 0, s67
    s_cselect_b32 s55, 0, s55
    s_cselect_b32 s56, 0, s56
    s_cselect_b32 s57, 0, s57
    s_cselect_b32 s58, 0, s58
    s_cselect_b32 s59, 0, s59
    s_cmp_lg_u32 s87, 0
    s_cbranch_scc1 K1A1_cs_14e
    v_mfma_f32_32x32x16_bf16 v[168:183], v[252:255], v[54:57], 0
    v_mfma_f32_32x32x16_bf16 v[184:199], v[252:255], v[58:61], 0
    v_mfma_f32_32x32x16_bf16 v[200:215], v[252:255], v[62:65], 0
K1A1_cs_14e:
    s_waitcnt lgkmcnt(7)
    v_mfma_f32_32x32x16_bf16 v[104:119], v[70:73], v[38:41], v[104:119]
    v_xad_u32 v20, v9, 48, s53
    ds_read_b128 v[30:33], v20
    ds_read_b64_tr_b16 v[54:55], v15 offset:6144
    ds_read_b64_tr_b16 v[56:57], v15 offset:6656
    v_lshlrev_b32 v28, 4, v0
    buffer_load_dwordx4 v[244:247], v28, s[36:39], 0 offen
    v_mfma_f32_32x32x16_bf16 v[120:135], v[74:77], v[38:41], v[120:135]
    ds_read_b64_tr_b16 v[58:59], v16 offset:6144
    ds_read_b64_tr_b16 v[60:61], v16 offset:6656
    ds_read_b64_tr_b16 v[62:63], v17 offset:6144
    ds_read_b64_tr_b16 v[64:65], v17 offset:6656
    v_mfma_f32_32x32x16_bf16 v[136:151], v[78:81], v[38:41], v[136:151]
    s_cmp_lg_u32 s87, 1
    s_cbranch_scc1 K1A1_cs_15e
    v_mfma_f32_32x32x16_bf16 v[168:183], v[252:255], v[70:73], 0
    v_mfma_f32_32x32x16_bf16 v[184:199], v[252:255], v[74:77], 0
    v_mfma_f32_32x32x16_bf16 v[200:215], v[252:255], v[78:81], 0
K1A1_cs_15e:
    s_waitcnt lgkmcnt(0)
    s_waitcnt vmcnt(7)
    s_barrier
    s_mov_b32 s81, s53
    s_mov_b32 s82, s54
    s_add_u32 s53, s53, 16384
    s_add_u32 s54, s54, 32768
    s_cmp_eq_u32 s53, 59392
    s_cselect_b32 s53, 10240, s53
    s_cselect_b32 s54, 0, s54
    v_add_u32 v15, s54, v11
    v_add_u32 v16, s54, v12
    v_add_u32 v17, s54, v13
    v_mfma_f32_32x32x16_bf16 v[104:119], v[86:89], v[46:49], v[104:119]
    v_xad_u32 v20, v9, 0, s53
    ds_read_b128 v[38:41], v20
    ds_read_b64_tr_b16 v[70:71], v15 offset:0
    ds_read_b64_tr_b16 v[72:73], v15 offset:512
    v_mfma_f32_32x32x16_bf16 v[120:135], v[90:93], v[46:49], v[120:135]
    ds_read_b64_tr_b16 v[74:75], v16 offset:0
    ds_read_b64_tr_b16 v[76:77], v16 offset:512
    ds_read_b64_tr_b16 v[78:79], v17 offset:0
    ds_read_b64_tr_b16 v[80:81], v17 offset:512
    s_add_u32 m0, s65, s81
    s_add_u32 s40, s55, 81920
    buffer_load_dwordx4 v4, s[16:19], s55 offen lds
    v_mfma_f32_32x32x16_bf16 v[136:151], v[94:97], v[46:49], v[136:151]
    s_add_u32 m0, s65, s81
    s_add_u32 m0, m0, 8192
    s_add_u32 s40, s55, 81920
    buffer_load_dwordx4 v4, s[16:19], s40 offen lds
    s_cmp_lg_u32 s87, 2
    s_cbranch_scc1 K1A1_cs_16e
    v_mfma_f32_32x32x16_bf16 v[168:183], v[252:255], v[86:89], 0
    v_mfma_f32_32x32x16_bf16 v[184:199], v[252:255], v[90:93], 0
    v_mfma_f32_32x32x16_bf16 v[200:215], v[252:255], v[94:97], 0
K1A1_cs_16e:
    s_waitcnt lgkmcnt(7)
    v_mfma_f32_32x32x16_bf16 v[104:119], v[54:57], v[30:33], v[104:119]
    v_xad_u32 v20, v9, 16, s53
    ds_read_b128 v[46:49], v20
    ds_read_b64_tr_b16 v[86:87], v15 offset:2048
    ds_read_b64_tr_b16 v[88:89], v15 offset:2560
    v_mfma_f32_32x32x16_bf16 v[120:135], v[58:61], v[30:33], v[120:135]
    ds_read_b64_tr_b16 v[90:91], v16 offset:2048
    ds_read_b64_tr_b16 v[92:93], v16 offset:2560
    ds_read_b64_tr_b16 v[94:95], v17 offset:2048
    ds_read_b64_tr_b16 v[96:97], v17 offset:2560
    s_add_u32 s41, s66, s82
    s_add_u32 m0, s41, 0
    s_nop 0
    buffer_load_dwordx4 v5, s[20:23], s56 offen lds
    v_mfma_f32_32x32x16_bf16 v[136:151], v[62:65], v[30:33], v[136:151]
    s_add_u32 s41, s66, s82
    s_add_u32 m0, s41, 8192
    s_nop 0
    buffer_load_dwordx4 v6, s[24:27], s57 offen lds
    s_cmp_lg_u32 s87, 3
    s_cbranch_scc1 K1A1_cs_17e
    v_mfma_f32_32x32x16_bf16 v[168:183], v[252:255], v[54:57], 0
    v_mfma_f32_32x32x16_bf16 v[184:199], v[252:255], v[58:61], 0
    v_mfma_f32_32x32x16_bf16 v[200:215], v[252:255], v[62:65], 0
K1A1_cs_17e:
    s_waitcnt lgkmcnt(7)
    v_mfma_f32_32x32x16_bf16 v[104:119], v[70:73], v[38:41], v[104:119]
    v_xad_u32 v20, v9, 32, s53
    ds_read_b128 v[30:33], v20
    ds_read_b64_tr_b16 v[54:55], v15 offset:4096
    ds_read_b64_tr_b16 v[56:57], v15 offset:4608
    v_mfma_f32_32x32x16_bf16 v[120:135], v[74:77], v[38:41], v[120:135]
    ds_read_b64_tr_b16 v[58:59], v16 offset:4096
    ds_read_b64_tr_b16 v[60:61], v16 offset:4608
    ds_read_b64_tr_b16 v[62:63], v17 offset:4096
    ds_read_b64_tr_b16 v[64:65], v17 offset:4608
    s_add_u32 s41, s66, s82
    s_add_u32 m0, s41, 16384
    s_nop 0
    buffer_load_dwordx4 v7, s[28:31], s58 offen lds
    v_mfma_f32_32x32x16_bf16 v[136:151], v[78:81], v[38:41], v[136:151]
    s_add_u32 s41, s66, s82
    s_add_u32 m0, s41, 24576
    s_nop 0
    buffer_load_dwordx4 v8, s[32:35], s59 offen lds
    s_add_u32 s55, s55, 128
    s_add_u32 s56, s56, s60
    s_add_u32 s57, s57, s61
    s_add_u32 s58, s58, s62
    s_add_u32 s59, s59, s63
    s_add_u32 s67, s67, 1
    s_cmp_eq_u32 s67, 10
    s_cselect_b32 s67, 0, s67
    s_cselect_b32 s55, 0, s55
    s_cselect_b32 s56, 0, s56
    s_cselect_b32 s57, 0, s57
    s_cselect_b32 s58, 0, s58
    s_cselect_b32 s59, 0, s59
    s_cmp_lg_u32 s88, 1
    s_cbranch_scc1 K1A1_cw_18e
    s_mul_i32 s40, s51, 512
    s_lshl_b32 s41, s52, 10
    s_add_u32 s40, s40, s41
    v_lshlrev_b32 v28, 7, v3
    v_lshl_add_u32 v28, v2, 2, v28
    v_add_u32 v28, s40, v28
    v_cmp_eq_u32 vcc, 1, v3
    s_nop 1
    v_cndmask_b32 v29, v168, v184, vcc
    ds_write_b32 v28, v29 offset:6144
    v_cndmask_b32 v29, v200, v200, vcc
    ds_write_b32 v28, v29 offset:6400
K1A1_cw_18e:
    s_waitcnt lgkmcnt(7)
    v_mfma_f32_32x32x16_bf16 v[104:119], v[86:89], v[46:49], v[104:119]
    v_xad_u32 v20, v9, 48, s53
    ds_read_b128 v[38:41], v20
    ds_read_b64_tr_b16 v[70:71], v15 offset:6144
    ds_read_b64_tr_b16 v[72:73], v15 offset:6656
    v_mfma_f32_32x32x16_bf16 v[120:135], v[90:93], v[46:49], v[120:135]
    ds_read_b64_tr_b16 v[74:75], v16 offset:6144
    ds_read_b64_tr_b16 v[76:77], v16 offset:6656
    ds_read_b64_tr_b16 v[78:79], v17 offset:6144
    ds_read_b64_tr_b16 v[80:81], v17 offset:6656
    global_load_dword v243, v103, s[70:71] sc1
    v_mfma_f32_32x32x16_bf16 v[136:151], v[94:97], v[46:49], v[136:151]
    s_waitcnt lgkmcnt(0)
    s_waitcnt vmcnt(8)
    s_barrier
    s_mov_b32 s81, s53
    s_mov_b32 s82, s54
    s_add_u32 s53, s53, 16384
    s_add_u32 s54, s54, 32768
    s_cmp_eq_u32 s53, 59392
    s_cselect_b32 s53, 10240, s53
    s_cselect_b32 s54, 0, s54
    v_add_u32 v15, s54, v11
    v_add_u32 v16, s54, v12
    v_add_u32 v17, s54, v13
    v_mfma_f32_32x32x16_bf16 v[104:119], v[54:57], v[30:33], v[104:119]
    v_xad_u32 v20, v9, 0, s53
    ds_read_b128 v[46:49], v20
    ds_read_b64_tr_b16 v[86:87], v15 offset:0
    ds_read_b64_tr_b16 v[88:89], v15 offset:512
    v_mfma_f32_32x32x16_bf16 v[120:135], v[58:61], v[30:33], v[120:135]
    ds_read_b64_tr_b16 v[90:91], v16 offset:0
    ds_read_b64_tr_b16 v[92:93], v16 offset:512
    ds_read_b64_tr_b16 v[94:95], v17 offset:0
    ds_read_b64_tr_b16 v[96:97], v17 offset:512
    s_add_u32 m0, s65, s81
    s_add_u32 s40, s55, 81920
    buffer_load_dwordx4 v4, s[16:19], s55 offen lds
    v_mfma_f32_32x32x16_bf16 v[136:151], v[62:65], v[30:33], v[136:151]
    s_add_u32 m0, s65, s81
    s_add_u32 m0, m0, 8192
    s_add_u32 s40, s55, 81920
    buffer_load_dwordx4 v4, s[16:19], s40 offen lds
    s_waitcnt lgkmcnt(7)
    v_mfma_f32_32x32x16_bf16 v[104:119], v[70:73], v[38:41], v[104:119]
    v_xad_u32 v20, v9, 16, s53
    ds_read_b128 v[30:33], v20
    ds_read_b64_tr_b16 v[54:55], v15 offset:2048
    ds_read_b64_tr_b16 v[56:57], v15 offset:2560
    v_mfma_f32_32x32x16_bf16 v[120:135], v[74:77], v[38:41], v[120:135]
    ds_read_b64_tr_b16 v[58:59], v16 offset:2048
    ds_read_b64_tr_b16 v[60:61], v16 offset:2560
    ds_read_b64_tr_b16 v[62:63], v17 offset:2048
    ds_read_b64_tr_b16 v[64:65], v17 offset:2560
    s_add_u32 s41, s66, s82
    s_add_u32 m0, s41, 0
    s_nop 0
    buffer_load_dwordx4 v5, s[20:23], s56 offen lds
    v_mfma_f32_32x32x16_bf16 v[136:151], v[78:81], v[38:41], v[136:151]
    s_add_u32 s41, s66, s82
    s_add_u32 m0, s41, 8192
    s_nop 0
    buffer_load_dwordx4 v6, s[24:27], s57 offen lds
    s_waitcnt lgkmcnt(7)
    v_mfma_f32_32x32x16_bf16 v[104:119], v[86:89], v[46:49], v[104:119]
    v_xad_u32 v20, v9, 32, s53
    ds_read_b128 v[38:41], v20
    ds_read_b64_tr_b16 v[70:71], v15 offset:4096
    ds_read_b64_tr_b16 v[72:73], v15 offset:4608
    v_mfma_f32_32x32x16_bf16 v[120:135], v[90:93], v[46:49], v[120:135]
    ds_read_b64_tr_b16 v[74:75], v16 offset:4096
    ds_read_b64_tr_b16 v[76:77], v16 offset:4608
    ds_read_b64_tr_b16 v[78:79], v17 offset:4096
    ds_read_b64_tr_b16 v[80:81], v17 offset:4608
    s_add_u32 s41, s66, s82
    s_add_u32 m0, s41, 16384
    s_nop 0
    buffer_load_dwordx4 v7, s[28:31], s58 offen lds
    v_mfma_f32_32x32x16_bf16 v[136:151], v[94:97], v[46:49], v[136:151]
    s_add_u32 s41, s66, s82
    s_add_u32 m0, s41, 24576
    s_nop 0
    buffer_load_dwordx4 v8, s[32:35], s59 offen lds
    s_add_u32 s55, s55, 128
    s_add_u32 s56, s56, s60
    s_add_u32 s57, s57, s61
    s_add_u32 s58, s58, s62
    s_add_u32 s59, s59, s63
    s_add_u32 s67, s67, 1
    s_cmp_eq_u32 s67, 10
    s_cselect_b32 s67, 0, s67
    s_cselect_b32 s55, 0, s55
    s_cselect_b32 s56, 0, s56
    s_cselect_b32 s57, 0, s57
    s_cselect_b32 s58, 0, s58
    s_cselect_b32 s59, 0, s59
    s_waitcnt lgkmcnt(7)
    v_mfma_f32_32x32x16_bf16 v[104:119], v[54:57], v[30:33], v[104:119]
    v_xad_u32 v20, v9, 48, s53
    ds_read_b128 v[46:49], v20
    ds_read_b64_tr_b16 v[86:87], v15 offset:6144
    ds_read_b64_tr_b16 v[88:89], v15 offset:6656
    v_mfma_f32_32x32x16_bf16 v[120:135], v[58:61], v[30:33], v[120:135]
    ds_read_b64_tr_b16 v[90:91], v16 offset:6144
    ds_read_b64_tr_b16 v[92:93], v16 offset:6656
    ds_read_b64_tr_b16 v[94:95], v17 offset:6144
    ds_read_b64_tr_b16 v[96:97], v17 offset:6656
    buffer_load_dword v102, v103, s[16:19], 0 offen
    v_mfma_f32_32x32x16_bf16 v[136:151], v[62:65], v[30:33], v[136:151]
    s_waitcnt lgkmcnt(0)
    s_waitcnt vmcnt(8)
    s_barrier
    s_mov_b32 s81, s53
    s_mov_b32 s82, s54
    s_add_u32 s53, s53, 16384
    s_add_u32 s54, s54, 32768
    s_cmp_eq_u32 s53, 59392
    s_cselect_b32 s53, 10240, s53
    s_cselect_b32 s54, 0, s54
    v_add_u32 v15, s54, v11
    v_add_u32 v16, s54, v12
    v_add_u32 v17, s54, v13
    v_mfma_f32_32x32x16_bf16 v[104:119], v[70:73], v[38:41], v[104:119]
    v_xad_u32 v20, v9, 0, s53
    ds_read_b128 v[30:33], v20
    ds_read_b64_tr_b16 v[54:55], v15 offset:0
    ds_read_b64_tr_b16 v[56:57], v15 offset:512
    v_mfma_f32_32x32x16_bf16 v[120:135], v[74:77], v[38:41], v[120:135]
    ds_read_b64_tr_b16 v[58:59], v16 offset:0
    ds_read_b64_tr_b16 v[60:61], v16 offset:512
    ds_read_b64_tr_b16 v[62:63], v17 offset:0
    ds_read_b64_tr_b16 v[64:65], v17 offset:512
    s_add_u32 m0, s65, s81
    s_add_u32 s40, s55, 81920
    buffer_load_dwordx4 v4, s[16:19], s55 offen lds
    v_mfma_f32_32x32x16_bf16 v[136:151], v[78:81], v[38:41], v[136:151]
    s_add_u32 m0, s65, s81
    s_add_u32 m0, m0, 8192
    s_add_u32 s40, s55, 81920
    buffer_load_dwordx4 v4, s[16:19], s40 offen lds
    s_waitcnt lgkmcnt(7)
    v_mfma_f32_32x32x16_bf16 v[104:119], v[86:89], v[46:49], v[104:119]
    v_xad_u32 v20, v9, 16, s53
    ds_read_b128 v[38:41], v20
    ds_read_b64_tr_b16 v[70:71], v15 offset:2048
    ds_read_b64_tr_b16 v[72:73], v15 offset:2560
    v_mfma_f32_32x32x16_bf16 v[120:135], v[90:93], v[46:49], v[120:135]
    ds_read_b64_tr_b16 v[74:75], v16 offset:2048
    ds_read_b64_tr_b16 v[76:77], v16 offset:2560
    ds_read_b64_tr_b16 v[78:79], v17 offset:2048
    ds_read_b64_tr_b16 v[80:81], v17 offset:2560
    s_add_u32 s41, s66, s82
    s_add_u32 m0, s41, 0
    s_nop 0
    buffer_load_dwordx4 v5, s[20:23], s56 offen lds
    v_mfma_f32_32x32x16_bf16 v[136:151], v[94:97], v[46:49], v[136:151]
    s_add_u32 s41, s66, s82
    s_add_u32 m0, s41, 8192
    s_nop 0
    buffer_load_dwordx4 v6, s[24:27], s57 offen lds
    v_lshlrev_b32 v28, 4, v0
    v_cmp_gt_u32 vcc, 200, v0
    s_and_saveexec_b64 s[46:47], vcc
    ds_write_b128 v28, v[244:247] offset:1024
    s_mov_b64 exec, s[46:47]
    s_waitcnt lgkmcnt(7)
    v_mfma_f32_32x32x16_bf16 v[104:119], v[54:57], v[30:33], v[104:119]
    v_xad_u32 v20, v9, 32, s53
    ds_read_b128 v[46:49], v20
    ds_read_b64_tr_b16 v[86:87], v15 offset:4096
    ds_read_b64_tr_b16 v[88:89], v15 offset:4608
    v_mfma_f32_32x32x16_bf16 v[120:135], v[58:61], v[30:33], v[120:135]
    ds_read_b64_tr_b16 v[90:91], v16 offset:4096
    ds_read_b64_tr_b16 v[92:93], v16 offset:4608
    ds_read_b64_tr_b16 v[94:95], v17 offset:4096
    ds_read_b64_tr_b16 v[96:97], v17 offset:4608
    s_add_u32 s41, s66, s82
    s_add_u32 m0, s41, 16384
    s_nop 0
    buffer_load_dwordx4 v7, s[28:31], s58 offen lds
    v_mfma_f32_32x32x16_bf16 v[136:151], v[62:65], v[30:33], v[136:151]
    s_add_u32 s41, s66, s82
    s_add_u32 m0, s41, 24576
    s_nop 0
    buffer_load_dwordx4 v8, s[32:35], s59 offen lds
    s_add_u32 s55, s55, 128
    s_add_u32 s56, s56, s60
    s_add_u32 s57, s57, s61
    s_add_u32 s58, s58, s62
    s_add_u32 s59, s59, s63
    s_add_u32 s67, s67, 1
    s_cmp_eq_u32 s67, 10
    s_cselect_b32 s67, 0, s67
    s_cselect_b32 s55, 0, s55
    s_cselect_b32 s56, 0, s56
    s_cselect_b32 s57, 0, s57
    s_cselect_b32 s58, 0, s58
    s_cselect_b32 s59, 0, s59
    s_waitcnt lgkmcnt(7)
    v_mfma_f32_32x32x16_bf16 v[104:119], v[70:73], v[38:41], v[104:119]
    v_xad_u32 v20, v9, 48, s53
    ds_read_b128 v[30:33], v20
    ds_read_b64_tr_b16 v[54:55], v15 offset:6144
    ds_read_b64_tr_b16 v[56:57], v15 offset:6656
    v_mfma_f32_32x32x16_bf16 v[120:135], v[74:77], v[38:41], v[120:135]
    ds_read_b64_tr_b16 v[58:59], v16 offset:6144
    ds_read_b64_tr_b16 v[60:61], v16 offset:6656
    ds_read_b64_tr_b16 v[62:63], v17 offset:6144
    ds_read_b64_tr_b16 v[64:65], v17 offset:6656
    buffer_load_dword v102, v103, s[16:19], 0 offen
    v_mfma_f32_32x32x16_bf16 v[136:151], v[78:81], v[38:41], v[136:151]
    s_waitcnt lgkmcnt(0)
    s_waitcnt vmcnt(8)
    s_barrier
    v_readfirstlane_b32 s40, v243
    s_cmp_lg_u32 s40, 0
    s_cbranch_scc1 K1A1_nc_19ok
    s_mov_b32 s42, 0
K1A1_nc_19:
    s_sleep 4
    global_load_dword v243, v103, s[70:71] sc1
    s_waitcnt vmcnt(0)
    v_readfirstlane_b32 s40, v243
    s_add_u32 s42, s42, 1
    s_cmp_gt_u32 s42, 4000
    s_cbranch_scc1 K1A1_nc_19ok
    s_cmp_eq_u32 s40, 0
    s_cbranch_scc1 K1A1_nc_19
K1A1_nc_19ok:
    s_mov_b32 s100, s40
    s_mov_b32 s81, s53
    s_mov_b32 s82, s54
    s_add_u32 s53, s53, 16384
    s_add_u32 s54, s54, 32768
    s_cmp_eq_u32 s53, 59392
    s_cselect_b32 s53, 10240, s53
    s_cselect_b32 s54, 0, s54
    v_add_u32 v15, s54, v11
    v_add_u32 v16, s54, v12
    v_add_u32 v17, s54, v13
    v_mfma_f32_32x32x16_bf16 v[104:119], v[86:89], v[46:49], v[104:119]
    v_xad_u32 v20, v9, 0, s53
    ds_read_b128 v[38:41], v20
    ds_read_b64_tr_b16 v[70:71], v15 offset:0
    ds_read_b64_tr_b16 v[72:73], v15 offset:512
    v_mfma_f32_32x32x16_bf16 v[120:135], v[90:93], v[46:49], v[120:135]
    ds_read_b64_tr_b16 v[74:75], v16 offset:0
    ds_read_b64_tr_b16 v[76:77], v16 offset:512
    ds_read_b64_tr_b16 v[78:79], v17 offset:0
    ds_read_b64_tr_b16 v[80:81], v17 offset:512
    s_add_u32 m0, s65, s81
    s_add_u32 s40, s55, 81920
    buffer_load_dwordx4 v4, s[16:19], s55 offen lds
    v_mfma_f32_32x32x16_bf16 v[136:151], v[94:97], v[46:49], v[136:151]
    s_add_u32 m0, s65, s81
    s_add_u32 m0, m0, 8192
    s_add_u32 s40, s55, 81920
    buffer_load_dwordx4 v4, s[16:19], s40 offen lds
    s_waitcnt lgkmcnt(7)
    v_mfma_f32_32x32x16_bf16 v[104:119], v[54:57], v[30:33], v[104:119]
    v_xad_u32 v20, v9, 16, s53
    ds_read_b128 v[46:49], v20
    ds_read_b64_tr_b16 v[86:87], v15 offset:2048
    ds_read_b64_tr_b16 v[88:89], v15 offset:2560
    v_mfma_f32_32x32x16_bf16 v[120:135], v[58:61], v[30:33], v[120:135]
    ds_read_b64_tr_b16 v[90:91], v16 offset:2048
    ds_read_b64_tr_b16 v[92:93], v16 offset:2560
    ds_read_b64_tr_b16 v[94:95], v17 offset:2048
    ds_read_b64_tr_b16 v[96:97], v17 offset:2560
    s_add_u32 s41, s66, s82
    s_add_u32 m0, s41, 0
    s_nop 0
    buffer_load_dwordx4 v5, s[20:23], s56 offen lds
    v_mfma_f32_32x32x16_bf16 v[136:151], v[62:65], v[30:33], v[136:151]
    s_add_u32 s41, s66, s82
    s_add_u32 m0, s41, 8192
    s_nop 0
    buffer_load_dwordx4 v6, s[24:27], s57 offen lds
    s_waitcnt lgkmcnt(7)
    v_mfma_f32_32x32x16_bf16 v[104:119], v[70:73], v[38:41], v[104:119]
    v_xad_u32 v20, v9, 32, s53
    ds_read_b128 v[30:33], v20
    ds_read_b64_tr_b16 v[54:55], v15 offset:4096
    ds_read_b64_tr_b16 v[56:57], v15 offset:4608
    v_mfma_f32_32x32x16_bf16 v[120:135], v[74:77], v[38:41], v[120:135]
    ds_read_b64_tr_b16 v[58:59], v16 offset:4096
    ds_read_b64_tr_b16 v[60:61], v16 offset:4608
    ds_read_b64_tr_b16 v[62:63], v17 offset:4096
    ds_read_b64_tr_b16 v[64:65], v17 offset:4608
    s_add_u32 s41, s66, s82
    s_add_u32 m0, s41, 16384
    s_nop 0
    buffer_load_dwordx4 v7, s[28:31], s58 offen lds
    v_mfma_f32_32x32x16_bf16 v[136:151], v[78:81], v[38:41], v[136:151]
    s_add_u32 s41, s66, s82
    s_add_u32 m0, s41, 24576
    s_nop 0
    buffer_load_dwordx4 v8, s[32:35], s59 offen lds
    s_add_u32 s55, s55, 128
    s_add_u32 s56, s56, s60
    s_add_u32 s57, s57, s61
    s_add_u32 s58, s58, s62
    s_add_u32 s59, s59, s63
    s_add_u32 s67, s67, 1
    s_cmp_eq_u32 s67, 10
    s_cselect_b32 s67, 0, s67
    s_cselect_b32 s55, 0, s55
    s_cselect_b32 s56, 0, s56
    s_cselect_b32 s57, 0, s57
    s_cselect_b32 s58, 0, s58
    s_cselect_b32 s59, 0, s59
    s_waitcnt lgkmcnt(7)
    v_mfma_f32_32x32x16_bf16 v[104:119], v[86:89], v[46:49], v[104:119]
    v_xad_u32 v20, v9, 48, s53
    ds_read_b128 v[38:41], v20
    ds_read_b64_tr_b16 v[70:71], v15 offset:6144
    ds_read_b64_tr_b16 v[72:73], v15 offset:6656
    v_mfma_f32_32x32x16_bf16 v[120:135], v[90:93], v[46:49], v[120:135]
    ds_read_b64_tr_b16 v[74:75], v16 offset:6144
    ds_read_b64_tr_b16 v[76:77], v16 offset:6656
    ds_read_b64_tr_b16 v[78:79], v17 offset:6144
    ds_read_b64_tr_b16 v[80:81], v17 offset:6656
    v_mov_b32 v242, v243
    v_mov_b32 v28, s92
    s_mov_b64 s[46:47], exec
    s_mov_b32 exec_lo, 0
    s_mov_b32 exec_hi, 0x80000000
    global_store_dwordx4 v28, v[240:243], s[68:69] sc0 sc1
    s_mov_b64 exec, s[46:47]
    v_mfma_f32_32x32x16_bf16 v[136:151], v[94:97], v[46:49], v[136:151]
    s_waitcnt lgkmcnt(0)
    s_waitcnt vmcnt(8)
    s_barrier
    s_mov_b32 s81, s53
    s_mov_b32 s82, s54
    s_add_u32 s53, s53, 16384
    s_add_u32 s54, s54, 32768
    s_cmp_eq_u32 s53, 59392
    s_cselect_b32 s53, 10240, s53
    s_cselect_b32 s54, 0, s54
    v_add_u32 v15, s54, v11
    v_add_u32 v16, s54, v12
    v_add_u32 v17, s54, v13
    v_mfma_f32_32x32x16_bf16 v[104:119], v[54:57], v[30:33], v[104:119]
    v_xad_u32 v20, v9, 0, s53
    ds_read_b128 v[46:49], v20
    ds_read_b64_tr_b16 v[86:87], v15 offset:0
    ds_read_b64_tr_b16 v[88:89], v15 offset:512
    v_mfma_f32_32x32x16_bf16 v[120:135], v[58:61], v[30:33], v[120:135]
    ds_read_b64_tr_b16 v[90:91], v16 offset:0
    ds_read_b64_tr_b16 v[92:93], v16 offset:512
    ds_read_b64_tr_b16 v[94:95], v17 offset:0
    ds_read_b64_tr_b16 v[96:97], v17 offset:512
    s_add_u32 m0, s65, s81
    s_add_u32 s40, s55, 81920
    buffer_load_dwordx4 v4, s[16:19], s55 offen lds
    v_mfma_f32_32x32x16_bf16 v[136:151], v[62:65], v[30:33], v[136:151]
    s_add_u32 m0, s65, s81
    s_add_u32 m0, m0, 8192
    s_add_u32 s40, s55, 81920
    buffer_load_dwordx4 v4, s[16:19], s40 offen lds
    s_waitcnt lgkmcnt(7)
    v_mfma_f32_32x32x16_bf16 v[104:119], v[70:73], v[38:41], v[104:119]
    v_xad_u32 v20, v9, 16, s53
    ds_read_b128 v[30:33], v20
    ds_read_b64_tr_b16 v[54:55], v15 offset:2048
    ds_read_b64_tr_b16 v[56:57], v15 offset:2560
    v_mfma_f32_32x32x16_bf16 v[120:135], v[74:77], v[38:41], v[120:135]
    ds_read_b64_tr_b16 v[58:59], v16 offset:2048
    ds_read_b64_tr_b16 v[60:61], v16 offset:2560
    ds_read_b64_tr_b16 v[62:63], v17 offset:2048
    ds_read_b64_tr_b16 v[64:65], v17 offset:2560
    s_add_u32 s41, s66, s82
    s_add_u32 m0, s41, 0
    s_nop 0
    buffer_load_dwordx4 v5, s[20:23], s56 offen lds
    v_mfma_f32_32x32x16_bf16 v[136:151], v[78:81], v[38:41], v[136:151]
    s_add_u32 s41, s66, s82
    s_add_u32 m0, s41, 8192
    s_nop 0
    buffer_load_dwordx4 v6, s[24:27], s57 offen lds
    s_waitcnt lgkmcnt(7)
    v_mfma_f32_32x32x16_bf16 v[104:119], v[86:89], v[46:49], v[104:119]
    v_xad_u32 v20, v9, 32, s53
    ds_read_b128 v[38:41], v20
    ds_read_b64_tr_b16 v[70:71], v15 offset:4096
    ds_read_b64_tr_b16 v[72:73], v15 offset:4608
    v_mfma_f32_32x32x16_bf16 v[120:135], v[90:93], v[46:49], v[120:135]
    ds_read_b64_tr_b16 v[74:75], v16 offset:4096
    ds_read_b64_tr_b16 v[76:77], v16 offset:4608
    ds_read_b64_tr_b16 v[78:79], v17 offset:4096
    ds_read_b64_tr_b16 v[80:81], v17 offset:4608
    s_add_u32 s41, s66, s82
    s_add_u32 m0, s41, 16384
    s_nop 0
    buffer_load_dwordx4 v7, s[28:31], s58 offen lds
    v_mfma_f32_32x32x16_bf16 v[136:151], v[94:97], v[46:49], v[136:151]
    s_add_u32 s41, s66, s82
    s_add_u32 m0, s41, 24576
    s_nop 0
    buffer_load_dwordx4 v8, s[32:35], s59 offen lds
    s_add_u32 s55, s55, 128
    s_add_u32 s56, s56, s60
    s_add_u32 s57, s57, s61
    s_add_u32 s58, s58, s62
    s_add_u32 s59, s59, s63
    s_add_u32 s67, s67, 1
    s_cmp_eq_u32 s67, 10
    s_cselect_b32 s67, 0, s67
    s_cselect_b32 s55, 0, s55
    s_cselect_b32 s56, 0, s56
    s_cselect_b32 s57, 0, s57
    s_cselect_b32 s58, 0, s58
    s_cselect_b32 s59, 0, s59
    s_waitcnt lgkmcnt(7)
    v_mfma_f32_32x32x16_bf16 v[104:119], v[54:57], v[30:33], v[104:119]
    v_xad_u32 v20, v9, 48, s53
    ds_read_b128 v[46:49], v20
    ds_read_b64_tr_b16 v[86:87], v15 offset:6144
    ds_read_b64_tr_b16 v[88:89], v15 offset:6656
    v_mfma_f32_32x32x16_bf16 v[120:135], v[58:61], v[30:33], v[120:135]
    ds_read_b64_tr_b16 v[90:91], v16 offset:6144
    ds_read_b64_tr_b16 v[92:93], v16 offset:6656
    ds_read_b64_tr_b16 v[94:95], v17 offset:6144
    ds_read_b64_tr_b16 v[96:97], v17 offset:6656
    s_cmp_lg_u32 s89, 1
    s_cbranch_scc1 K1A1_c2_20e
    v_lshlrev_b32 v28, 2, v0
    ds_read_b32 v168, v28 offset:6144
    ds_read_b32 v169, v28 offset:7168
    ds_read_b32 v170, v28 offset:8192
    ds_read_b32 v171, v28 offset:9216
    s_mul_i32 s40, s86, 20480
    s_lshl_b32 s41, s49, 11
    s_add_u32 s40, s40, s41
    s_add_u32 s40, s40, 19202048
    v_lshl_add_u32 v28, v0, 3, s40
    s_waitcnt lgkmcnt(0)
    v_add_f32 v168, v168, v169
    v_add_f32 v168, v168, v170
    v_add_f32 v168, v168, v171
    v_mov_b32 v169, v243
    global_store_dwordx2 v28, v[168:169], s[68:69] sc0 sc1
    s_branch K1A1_c2_20x
K1A1_c2_20e:
    buffer_load_dword v102, v103, s[16:19], 0 offen
K1A1_c2_20x:
    v_mfma_f32_32x32x16_bf16 v[136:151], v[62:65], v[30:33], v[136:151]
    s_waitcnt lgkmcnt(0)
    s_waitcnt vmcnt(8)
    s_barrier
    s_mov_b32 s81, s53
    s_mov_b32 s82, s54
    s_add_u32 s53, s53, 16384
    s_add_u32 s54, s54, 32768
    s_cmp_eq_u32 s53, 59392
    s_cselect_b32 s53, 10240, s53
    s_cselect_b32 s54, 0, s54
    v_add_u32 v15, s54, v11
    v_add_u32 v16, s54, v12
    v_add_u32 v17, s54, v13
    v_mfma_f32_32x32x16_bf16 v[104:119], v[70:73], v[38:41], v[104:119]
    v_xad_u32 v20, v9, 0, s53
    ds_read_b128 v[30:33], v20
    ds_read_b64_tr_b16 v[54:55], v15 offset:0
    ds_read_b64_tr_b16 v[56:57], v15 offset:512
    v_mfma_f32_32x32x16_bf16 v[120:135], v[74:77], v[38:41], v[120:135]
    ds_read_b64_tr_b16 v[58:59], v16 offset:0
    ds_read_b64_tr_b16 v[60:61], v16 offset:512
    ds_read_b64_tr_b16 v[62:63], v17 offset:0
    ds_read_b64_tr_b16 v[64:65], v17 offset:512
    s_add_u32 m0, s65, s81
    s_add_u32 s40, s55, 81920
    buffer_load_dwordx4 v4, s[16:19], s55 offen lds
    v_mfma_f32_32x32x16_bf16 v[136:151], v[78:81], v[38:41], v[136:151]
    s_add_u32 m0, s65, s81
    s_add_u32 m0, m0, 8192
    s_add_u32 s40, s55, 81920
    buffer_load_dwordx4 v4, s[16:19], s40 offen lds
    s_waitcnt lgkmcnt(7)
    v_mfma_f32_32x32x16_bf16 v[104:119], v[86:89], v[46:49], v[104:119]
    v_xad_u32 v20, v9, 16, s53
    ds_read_b128 v[38:41], v20
    ds_read_b64_tr_b16 v[70:71], v15 offset:2048
    ds_read_b64_tr_b16 v[72:73], v15 offset:2560
    v_mfma_f32_32x32x16_bf16 v[120:135], v[90:93], v[46:49], v[120:135]
    ds_read_b64_tr_b16 v[74:75], v16 offset:2048
    ds_read_b64_tr_b16 v[76:77], v16 offset:2560
    ds_read_b64_tr_b16 v[78:79], v17 offset:2048
    ds_read_b64_tr_b16 v[80:81], v17 offset:2560
    s_add_u32 s41, s66, s82
    s_add_u32 m0, s41, 0
    s_nop 0
    buffer_load_dwordx4 v5, s[20:23], s56 offen lds
    v_mfma_f32_32x32x16_bf16 v[136:151], v[94:97], v[46:49], v[136:151]
    s_add_u32 s41, s66, s82
    s_add_u32 m0, s41, 8192
    s_nop 0
    buffer_load_dwordx4 v6, s[24:27], s57 offen lds
    v_bfe_u32 v22, v1, 4, 1
    v_lshlrev_b32 v22, 2, v22
    v_and_b32 v23, 3, v1
    v_add_u32 v22, v22, v23
    v_and_b32 v23, 1, v22
    v_lshrrev_b32 v22, 1, v22
    v_bfe_u32 v24, v1, 2, 2
    v_mul_u32_u24 v24, 40, v24
    v_lshl_add_u32 v24, v22, 3, v24
    s_mul_i32 s40, s51, 1600
    v_mul_u32_u24 v25, 800, v23
    v_add3_u32 v24, v24, v25, s40
    v_add_u32 v24, 1024, v24
    v_mov_b32 v25, 4224
    v_cmp_eq_u32 vcc, v23, v3
    s_mul_i32 s40, s51, 512
    v_lshl_add_u32 v255, v3, 4, s40
    v_cndmask_b32 v254, v25, v24, vcc
    v_lshrrev_b32 v22, 7, v9
    s_lshl_b32 s40, s51, 1
    v_add_u32 v23, s40, v3
    v_mul_u32_u24 v251, 192, v22
    v_mad_u32_u24 v251, v23, 48, v251
    v_add_u32 v251, 51200, v251
    v_mul_u32_u24 v252, 320, v22
    v_mul_u32_u24 v24, 80, v23
    v_add_u32 v252, v252, v24
    s_lshl_b32 s40, s49, 2
    s_add_u32 s40, s40, s52
    s_mul_i32 s40, s40, 80
    s_lshl_b32 s41, s50, 3
    s_add_u32 s40, s40, s41
    s_lshl_b32 s40, s40, 9
    v_lshl_add_u32 v253, v2, 4, s40
    s_waitcnt lgkmcnt(7)
    v_mfma_f32_32x32x16_bf16 v[104:119], v[54:57], v[30:33], v[104:119]
    v_xad_u32 v20, v9, 32, s53
    ds_read_b128 v[46:49], v20
    ds_read_b64_tr_b16 v[86:87], v15 offset:4096
    ds_read_b64_tr_b16 v[88:89], v15 offset:4608
    v_mfma_f32_32x32x16_bf16 v[120:135], v[58:61], v[30:33], v[120:135]
    ds_read_b64_tr_b16 v[90:91], v16 offset:4096
    ds_read_b64_tr_b16 v[92:93], v16 offset:4608
    ds_read_b64_tr_b16 v[94:95], v17 offset:4096
    ds_read_b64_tr_b16 v[96:97], v17 offset:4608
    s_add_u32 s41, s66, s82
    s_add_u32 m0, s41, 16384
    s_nop 0
    buffer_load_dwordx4 v7, s[28:31], s58 offen lds
    v_mfma_f32_32x32x16_bf16 v[136:151], v[62:65], v[30:33], v[136:151]
    s_add_u32 s41, s66, s82
    s_add_u32 m0, s41, 24576
    s_nop 0
    buffer_load_dwordx4 v8, s[32:35], s59 offen lds
    s_add_u32 s55, s55, 128
    s_add_u32 s56, s56, s60
    s_add_u32 s57, s57, s61
    s_add_u32 s58, s58, s62
    s_add_u32 s59, s59, s63
    s_add_u32 s67, s67, 1
    s_cmp_eq_u32 s67, 10
    s_cselect_b32 s67, 0, s67
    s_cselect_b32 s55, 0, s55
    s_cselect_b32 s56, 0, s56
    s_cselect_b32 s57, 0, s57
    s_cselect_b32 s58, 0, s58
    s_cselect_b32 s59, 0, s59
    s_waitcnt lgkmcnt(7)
    v_mfma_f32_32x32x16_bf16 v[104:119], v[70:73], v[38:41], v[104:119]
    v_xad_u32 v20, v9, 48, s53
    ds_read_b128 v[30:33], v20
    ds_read_b64_tr_b16 v[54:55], v15 offset:6144
    ds_read_b64_tr_b16 v[56:57], v15 offset:6656
    v_mfma_f32_32x32x16_bf16 v[120:135], v[74:77], v[38:41], v[120:135]
    ds_read_b64_tr_b16 v[58:59], v16 offset:6144
    ds_read_b64_tr_b16 v[60:61], v16 offset:6656
    ds_read_b64_tr_b16 v[62:63], v17 offset:6144
    ds_read_b64_tr_b16 v[64:65], v17 offset:6656
    buffer_load_dword v102, v103, s[16:19], 0 offen
    v_mfma_f32_32x32x16_bf16 v[136:151], v[78:81], v[38:41], v[136:151]
    s_waitcnt lgkmcnt(0)
    s_waitcnt vmcnt(8)
    s_barrier
    s_mov_b32 s81, s53
    s_mov_b32 s82, s54
    s_add_u32 s53, s53, 16384
    s_add_u32 s54, s54, 32768
    s_cmp_eq_u32 s53, 59392
    s_cselect_b32 s53, 10240, s53
    s_cselect_b32 s54, 0, s54
    v_add_u32 v15, s54, v11
    v_add_u32 v16, s54, v12
    v_add_u32 v17, s54, v13
    v_mfma_f32_32x32x16_bf16 v[104:119], v[86:89], v[46:49], v[104:119]
    v_xad_u32 v20, v9, 0, s53
    ds_read_b128 v[38:41], v20
    ds_read_b64_tr_b16 v[70:71], v15 offset:0
    ds_read_b64_tr_b16 v[72:73], v15 offset:512
    v_mfma_f32_32x32x16_bf16 v[120:135], v[90:93], v[46:49], v[120:135]
    ds_read_b64_tr_b16 v[74:75], v16 offset:0
    ds_read_b64_tr_b16 v[76:77], v16 offset:512
    ds_read_b64_tr_b16 v[78:79], v17 offset:0
    ds_read_b64_tr_b16 v[80:81], v17 offset:512
    s_add_u32 m0, s65, s81
    s_add_u32 s40, s55, 81920
    buffer_load_dwordx4 v4, s[16:19], s55 offen lds
    v_mfma_f32_32x32x16_bf16 v[136:151], v[94:97], v[46:49], v[136:151]
    s_add_u32 m0, s65, s81
    s_add_u32 m0, m0, 8192
    s_add_u32 s40, s55, 81920
    buffer_load_dwordx4 v4, s[16:19], s40 offen lds
    s_waitcnt lgkmcnt(7)
    v_mfma_f32_32x32x16_bf16 v[104:119], v[54:57], v[30:33], v[104:119]
    v_xad_u32 v20, v9, 16, s53
    ds_read_b128 v[46:49], v20
    ds_read_b64_tr_b16 v[86:87], v15 offset:2048
    ds_read_b64_tr_b16 v[88:89], v15 offset:2560
    v_mfma_f32_32x32x16_bf16 v[120:135], v[58:61], v[30:33], v[120:135]
    ds_read_b64_tr_b16 v[90:91], v16 offset:2048
    ds_read_b64_tr_b16 v[92:93], v16 offset:2560
    ds_read_b64_tr_b16 v[94:95], v17 offset:2048
    ds_read_b64_tr_b16 v[96:97], v17 offset:2560
    s_add_u32 s41, s66, s82
    s_add_u32 m0, s41, 0
    s_nop 0
    buffer_load_dwordx4 v5, s[20:23], s56 offen lds
    v_mfma_f32_32x32x16_bf16 v[136:151], v[62:65], v[30:33], v[136:151]
    s_add_u32 s41, s66, s82
    s_add_u32 m0, s41, 8192
    s_nop 0
    buffer_load_dwordx4 v6, s[24:27], s57 offen lds
    s_waitcnt lgkmcnt(7)
    v_mfma_f32_32x32x16_bf16 v[104:119], v[70:73], v[38:41], v[104:119]
    v_xad_u32 v20, v9, 32, s53
    ds_read_b128 v[30:33], v20
    ds_read_b64_tr_b16 v[54:55], v15 offset:4096
    ds_read_b64_tr_b16 v[56:57], v15 offset:4608
    v_mfma_f32_32x32x16_bf16 v[120:135], v[74:77], v[38:41], v[120:135]
    ds_read_b64_tr_b16 v[58:59], v16 offset:4096
    ds_read_b64_tr_b16 v[60:61], v16 offset:4608
    ds_read_b64_tr_b16 v[62:63], v17 offset:4096
    ds_read_b64_tr_b16 v[64:65], v17 offset:4608
    s_add_u32 s41, s66, s82
    s_add_u32 m0, s41, 16384
    s_nop 0
    buffer_load_dwordx4 v7, s[28:31], s58 offen lds
    v_mfma_f32_32x32x16_bf16 v[136:151], v[78:81], v[38:41], v[136:151]
    s_add_u32 s41, s66, s82
    s_add_u32 m0, s41, 24576
    s_nop 0
    buffer_load_dwordx4 v8, s[32:35], s59 offen lds
    s_add_u32 s55, s55, 128
    s_add_u32 s56, s56, s60
    s_add_u32 s57, s57, s61
    s_add_u32 s58, s58, s62
    s_add_u32 s59, s59, s63
    s_add_u32 s67, s67, 1
    s_cmp_eq_u32 s67, 10
    s_cselect_b32 s67, 0, s67
    s_cselect_b32 s55, 0, s55
    s_cselect_b32 s56, 0, s56
    s_cselect_b32 s57, 0, s57
    s_cselect_b32 s58, 0, s58
    s_cselect_b32 s59, 0, s59
    s_waitcnt lgkmcnt(7)
    v_mfma_f32_32x32x16_bf16 v[104:119], v[86:89], v[46:49], v[104:119]
    v_xad_u32 v20, v9, 48, s53
    ds_read_b128 v[38:41], v20
    ds_read_b64_tr_b16 v[70:71], v15 offset:6144
    ds_read_b64_tr_b16 v[72:73], v15 offset:6656
    v_mfma_f32_32x32x16_bf16 v[120:135], v[90:93], v[46:49], v[120:135]
    ds_read_b64_tr_b16 v[74:75], v16 offset:6144
    ds_read_b64_tr_b16 v[76:77], v16 offset:6656
    ds_read_b64_tr_b16 v[78:79], v17 offset:6144
    ds_read_b64_tr_b16 v[80:81], v17 offset:6656
    buffer_load_dword v102, v103, s[16:19], 0 offen
    v_mfma_f32_32x32x16_bf16 v[136:151], v[94:97], v[46:49], v[136:151]
    s_waitcnt lgkmcnt(0)
    s_waitcnt vmcnt(8)
    s_barrier
    s_mov_b32 s81, s53
    s_mov_b32 s82, s54
    s_add_u32 s53, s53, 16384
    s_add_u32 s54, s54, 32768
    s_cmp_eq_u32 s53, 59392
    s_cselect_b32 s53, 10240, s53
    s_cselect_b32 s54, 0, s54
    v_add_u32 v15, s54, v11
    v_add_u32 v16, s54, v12
    v_add_u32 v17, s54, v13
    v_mfma_f32_32x32x16_bf16 v[104:119], v[54:57], v[30:33], v[104:119]
    v_xad_u32 v20, v9, 0, s53
    ds_read_b128 v[46:49], v20
    ds_read_b64_tr_b16 v[86:87], v15 offset:0
    ds_read_b64_tr_b16 v[88:89], v15 offset:512
    v_mfma_f32_32x32x16_bf16 v[120:135], v[58:61], v[30:33], v[120:135]
    ds_read_b64_tr_b16 v[90:91], v16 offset:0
    ds_read_b64_tr_b16 v[92:93], v16 offset:512
    ds_read_b64_tr_b16 v[94:95], v17 offset:0
    ds_read_b64_tr_b16 v[96:97], v17 offset:512
    v_mfma_f32_32x32x16_bf16 v[136:151], v[62:65], v[30:33], v[136:151]
    s_waitcnt lgkmcnt(7)
    v_mfma_f32_32x32x16_bf16 v[104:119], v[70:73], v[38:41], v[104:119]
    v_xad_u32 v20, v9, 16, s53
    ds_read_b128 v[30:33], v20
    ds_read_b64_tr_b16 v[54:55], v15 offset:2048
    ds_read_b64_tr_b16 v[56:57], v15 offset:2560
    v_mfma_f32_32x32x16_bf16 v[120:135], v[74:77], v[38:41], v[120:135]
    ds_read_b64_tr_b16 v[58:59], v16 offset:2048
    ds_read_b64_tr_b16 v[60:61], v16 offset:2560
    ds_read_b64_tr_b16 v[62:63], v17 offset:2048
    ds_read_b64_tr_b16 v[64:65], v17 offset:2560
    v_mfma_f32_32x32x16_bf16 v[136:151], v[78:81], v[38:41], v[136:151]
    s_waitcnt lgkmcnt(7)
    v_mfma_f32_32x32x16_bf16 v[104:119], v[86:89], v[46:49], v[104:119]
    v_xad_u32 v20, v9, 32, s53
    ds_read_b128 v[38:41], v20
    ds_read_b64_tr_b16 v[70:71], v15 offset:4096
    ds_read_b64_tr_b16 v[72:73], v15 offset:4608
    v_mfma_f32_32x32x16_bf16 v[120:135], v[90:93], v[46:49], v[120:135]
    ds_read_b64_tr_b16 v[74:75], v16 offset:4096
    ds_read_b64_tr_b16 v[76:77], v16 offset:4608
    ds_read_b64_tr_b16 v[78:79], v17 offset:4096
    ds_read_b64_tr_b16 v[80:81], v17 offset:4608
    v_mfma_f32_32x32x16_bf16 v[136:151], v[94:97], v[46:49], v[136:151]
    s_waitcnt lgkmcnt(7)
    v_mfma_f32_32x32x16_bf16 v[104:119], v[54:57], v[30:33], v[104:119]
    v_xad_u32 v20, v9, 48, s53
    ds_read_b128 v[46:49], v20
    ds_read_b64_tr_b16 v[86:87], v15 offset:6144
    ds_read_b64_tr_b16 v[88:89], v15 offset:6656
    v_mfma_f32_32x32x16_bf16 v[120:135], v[58:61], v[30:33], v[120:135]
    ds_read_b64_tr_b16 v[90:91], v16 offset:6144
    ds_read_b64_tr_b16 v[92:93], v16 offset:6656
    ds_read_b64_tr_b16 v[94:95], v17 offset:6144
    ds_read_b64_tr_b16 v[96:97], v17 offset:6656
    v_mfma_f32_32x32x16_bf16 v[136:151], v[62:65], v[30:33], v[136:151]
    s_waitcnt lgkmcnt(0)
    s_waitcnt vmcnt(1)
    s_barrier
    s_mov_b32 s81, s53
    s_mov_b32 s82, s54
    s_add_u32 s53, s53, 16384
    s_add_u32 s54, s54, 32768
    s_cmp_eq_u32 s53, 59392
    s_cselect_b32 s53, 10240, s53
    s_cselect_b32 s54, 0, s54
    v_add_u32 v15, s54, v11
    v_add_u32 v16, s54, v12
    v_add_u32 v17, s54, v13
    v_mfma_f32_32x32x16_bf16 v[104:119], v[70:73], v[38:41], v[104:119]
    v_xad_u32 v20, v9, 0, s53
    ds_read_b128 v[30:33], v20
    ds_read_b64_tr_b16 v[54:55], v15 offset:0
    ds_read_b64_tr_b16 v[56:57], v15 offset:512
    v_mfma_f32_32x32x16_bf16 v[120:135], v[74:77], v[38:41], v[120:135]
    ds_read_b64_tr_b16 v[58:59], v16 offset:0
    ds_read_b64_tr_b16 v[60:61], v16 offset:512
    ds_read_b64_tr_b16 v[62:63], v17 offset:0
    ds_read_b64_tr_b16 v[64:65], v17 offset:512
    v_mfma_f32_32x32x16_bf16 v[136:151], v[78:81], v[38:41], v[136:151]
    v_lshrrev_b32 v28, 7, v9
    s_lshl_b32 s40, s49, 7
    v_add_u32 v28, s40, v28
    v_lshlrev_b32 v28, 4, v28
    v_add_u32 v28, 19136512, v28
    global_load_dwordx4 v[192:195], v28, s[68:69] sc1
    s_cmp_ge_u32 s48, 4
    s_cbranch_scc1 K1_csl_21
    s_mul_i32 s40, s86, 20480
    s_add_u32 s40, s40, 19202048
    v_lshl_add_u32 v28, v0, 3, s40
    global_load_dwordx2 v[200:201], v28, s[68:69] offset:0 sc1
    global_load_dwordx2 v[202:203], v28, s[68:69] offset:2048 sc1
    v_add_u32 v28, 4096, v28
    global_load_dwordx2 v[204:205], v28, s[68:69] offset:0 sc1
    global_load_dwordx2 v[206:207], v28, s[68:69] offset:2048 sc1
    v_add_u32 v28, 4096, v28
    global_load_dwordx2 v[208:209], v28, s[68:69] offset:0 sc1
    global_load_dwordx2 v[210:211], v28, s[68:69] offset:2048 sc1
    v_add_u32 v28, 4096, v28
    global_load_dwordx2 v[212:213], v28, s[68:69] offset:0 sc1
    global_load_dwordx2 v[214:215], v28, s[68:69] offset:2048 sc1
    v_add_u32 v28, 4096, v28
    global_load_dwordx2 v[216:217], v28, s[68:69] offset:0 sc1
    global_load_dwordx2 v[218:219], v28, s[68:69] offset:2048 sc1
K1_csl_21:
    s_waitcnt lgkmcnt(7)
    v_mfma_f32_32x32x16_bf16 v[104:119], v[86:89], v[46:49], v[104:119]
    v_xad_u32 v20, v9, 16, s53
    ds_read_b128 v[38:41], v20
    ds_read_b64_tr_b16 v[70:71], v15 offset:2048
    ds_read_b64_tr_b16 v[72:73], v15 offset:2560
    v_mfma_f32_32x32x16_bf16 v[120:135], v[90:93], v[46:49], v[120:135]
    ds_read_b64_tr_b16 v[74:75], v16 offset:2048
    ds_read_b64_tr_b16 v[76:77], v16 offset:2560
    ds_read_b64_tr_b16 v[78:79], v17 offset:2048
    ds_read_b64_tr_b16 v[80:81], v17 offset:2560
    v_mfma_f32_32x32x16_bf16 v[136:151], v[94:97], v[46:49], v[136:151]
    s_waitcnt lgkmcnt(7)
    v_mfma_f32_32x32x16_bf16 v[104:119], v[54:57], v[30:33], v[104:119]
    v_xad_u32 v20, v9, 32, s53
    ds_read_b128 v[46:49], v20
    ds_read_b64_tr_b16 v[86:87], v15 offset:4096
    ds_read_b64_tr_b16 v[88:89], v15 offset:4608
    v_mfma_f32_32x32x16_bf16 v[120:135], v[58:61], v[30:33], v[120:135]
    ds_read_b64_tr_b16 v[90:91], v16 offset:4096
    ds_read_b64_tr_b16 v[92:93], v16 offset:4608
    ds_read_b64_tr_b16 v[94:95], v17 offset:4096
    ds_read_b64_tr_b16 v[96:97], v17 offset:4608
    v_mfma_f32_32x32x16_bf16 v[136:151], v[62:65], v[30:33], v[136:151]
    s_waitcnt lgkmcnt(7)
    v_mfma_f32_32x32x16_bf16 v[104:119], v[70:73], v[38:41], v[104:119]
    v_xad_u32 v20, v9, 48, s53
    ds_read_b128 v[30:33], v20
    ds_read_b64_tr_b16 v[54:55], v15 offset:6144
    ds_read_b64_tr_b16 v[56:57], v15 offset:6656
    v_mfma_f32_32x32x16_bf16 v[120:135], v[74:77], v[38:41], v[120:135]
    ds_read_b64_tr_b16 v[58:59], v16 offset:6144
    ds_read_b64_tr_b16 v[60:61], v16 offset:6656
    ds_read_b64_tr_b16 v[62:63], v17 offset:6144
    ds_read_b64_tr_b16 v[64:65], v17 offset:6656
    v_mfma_f32_32x32x16_bf16 v[136:151], v[78:81], v[38:41], v[136:151]
    s_mov_b32 s42, 0
K1_gr_22:
    s_waitcnt vmcnt(0)
    v_cmp_ne_u32 vcc, v194, v243
    s_cmp_ge_u32 s48, 4
    s_cbranch_scc1 K1_grc_23
    v_cmp_ne_u32 s[40:41], v201, v243
    s_or_b64 vcc, vcc, s[40:41]
    v_cmp_ne_u32 s[40:41], v203, v243
    s_or_b64 vcc, vcc, s[40:41]
    v_cmp_ne_u32 s[40:41], v205, v243
    s_or_b64 vcc, vcc, s[40:41]
    v_cmp_ne_u32 s[40:41], v207, v243
    s_or_b64 vcc, vcc, s[40:41]
    v_cmp_ne_u32 s[40:41], v209, v243
    s_or_b64 vcc, vcc, s[40:41]
    v_cmp_ne_u32 s[40:41], v211, v243
    s_or_b64 vcc, vcc, s[40:41]
    v_cmp_ne_u32 s[40:41], v213, v243
    s_or_b64 vcc, vcc, s[40:41]
    v_cmp_ne_u32 s[40:41], v215, v243
    s_or_b64 vcc, vcc, s[40:41]
    v_cmp_ne_u32 s[40:41], v217, v243
    s_or_b64 vcc, vcc, s[40:41]
    v_cmp_ne_u32 s[40:41], v219, v243
    s_or_b64 vcc, vcc, s[40:41]
K1_grc_23:
    s_add_u32 s42, s42, 1
    s_cmp_gt_u32 s42, 4000
    s_cbranch_scc1 K1_gr_22ok
    s_cbranch_vccz K1_gr_22ok
    s_sleep 4
    v_lshrrev_b32 v28, 7, v9
    s_lshl_b32 s40, s49, 7
    v_add_u32 v28, s40, v28
    v_lshlrev_b32 v28, 4, v28
    v_add_u32 v28, 19136512, v28
    global_load_dwordx4 v[192:195], v28, s[68:69] sc1
    s_cmp_ge_u32 s48, 4
    s_cbranch_scc1 K1_csl_24
    s_mul_i32 s40, s86, 20480
    s_add_u32 s40, s40, 19202048
    v_lshl_add_u32 v28, v0, 3, s40
    global_load_dwordx2 v[200:201], v28, s[68:69] offset:0 sc1
    global_load_dwordx2 v[202:203], v28, s[68:69] offset:2048 sc1
    v_add_u32 v28, 4096, v28
    global_load_dwordx2 v[204:205], v28, s[68:69] offset:0 sc1
    global_load_dwordx2 v[206:207], v28, s[68:69] offset:2048 sc1
    v_add_u32 v28, 4096, v28
    global_load_dwordx2 v[208:209], v28, s[68:69] offset:0 sc1
    global_load_dwordx2 v[210:211], v28, s[68:69] offset:2048 sc1
    v_add_u32 v28, 4096, v28
    global_load_dwordx2 v[212:213], v28, s[68:69] offset:0 sc1
    global_load_dwordx2 v[214:215], v28, s[68:69] offset:2048 sc1
    v_add_u32 v28, 4096, v28
    global_load_dwordx2 v[216:217], v28, s[68:69] offset:0 sc1
    global_load_dwordx2 v[218:219], v28, s[68:69] offset:2048 sc1
K1_csl_24:
    s_branch K1_gr_22
K1_gr_22ok:
    v_mov_b32 v248, v192
    v_mov_b32 v249, v193
    s_cmp_ge_u32 s48, 4
    s_cbranch_scc1 K1_cs2_25
    v_add_f32 v200, v200, v202
    v_add_f32 v200, v200, v204
    v_add_f32 v200, v200, v206
    v_add_f32 v200, v200, v208
    v_add_f32 v200, v200, v210
    v_add_f32 v200, v200, v212
    v_add_f32 v200, v200, v214
    v_add_f32 v200, v200, v216
    v_add_f32 v200, v200, v218
    v_lshlrev_b32 v28, 2, v0
    ds_write_b32 v28, v200 offset:0
K1_cs2_25:
    s_waitcnt lgkmcnt(0)
    s_barrier
    ds_read_b128 v[168:171], v255 offset:0
    ds_read_b128 v[172:175], v255 offset:32
    ds_read_b128 v[176:179], v255 offset:64
    ds_read_b128 v[180:183], v255 offset:96
    ds_read_b128 v[184:187], v255 offset:128
    ds_read_b128 v[188:191], v255 offset:160
    ds_read_b128 v[192:195], v255 offset:192
    ds_read_b128 v[196:199], v255 offset:224
    ds_read_b128 v[200:203], v255 offset:256
    ds_read_b128 v[204:207], v255 offset:288
    ds_read_b128 v[208:211], v255 offset:320
    ds_read_b128 v[212:215], v255 offset:352
    ds_read_b64_tr_b16 v[216:217], v254 offset:0
    ds_read_b64_tr_b16 v[218:219], v254 offset:160
    ds_read_b64_tr_b16 v[220:221], v254 offset:320
    ds_read_b64_tr_b16 v[222:223], v254 offset:480
    ds_read_b64_tr_b16 v[224:225], v254 offset:640
    ds_read_b64_tr_b16 v[226:227], v254 offset:800
    ds_read_b64_tr_b16 v[228:229], v254 offset:32
    ds_read_b64_tr_b16 v[230:231], v254 offset:192
    ds_read_b64_tr_b16 v[232:233], v254 offset:352
    ds_read_b64_tr_b16 v[234:235], v254 offset:512
    ds_read_b64_tr_b16 v[236:237], v254 offset:672
    ds_read_b64_tr_b16 v[238:239], v254 offset:832
    v_mfma_f32_32x32x16_bf16 v[104:119], v[86:89], v[46:49], v[104:119]
    v_mfma_f32_32x32x16_bf16 v[120:135], v[90:93], v[46:49], v[120:135]
    v_mfma_f32_32x32x16_bf16 v[136:151], v[94:97], v[46:49], v[136:151]
    s_waitcnt lgkmcnt(0)
    v_mfma_f32_32x32x16_bf16 v[104:119], v[54:57], v[30:33], v[104:119]
    v_mfma_f32_32x32x16_bf16 v[120:135], v[58:61], v[30:33], v[120:135]
    v_mfma_f32_32x32x16_bf16 v[136:151], v[62:65], v[30:33], v[136:151]
    s_branch K1A1_EXIT
K1A1_EXIT:
K1A_EPI:
    s_nop 7
    s_nop 3
    v_fmac_f32 v112, v176, v248
    v_fmac_f32 v113, v177, v248
    v_fmac_f32 v114, v178, v248
    v_fmac_f32 v115, v179, v248
    v_fmac_f32 v120, v184, v248
    v_fmac_f32 v121, v185, v248
    v_fmac_f32 v122, v186, v248
    v_fmac_f32 v123, v187, v248
    v_fmac_f32 v136, v200, v248
    v_fmac_f32 v137, v201, v248
    v_fmac_f32 v138, v202, v248
    v_fmac_f32 v139, v203, v248
    v_fmac_f32 v124, v188, v248
    v_fmac_f32 v125, v189, v248
    v_fmac_f32 v126, v190, v248
    v_fmac_f32 v127, v191, v248
    v_fmac_f32 v116, v180, v248
    v_fmac_f32 v117, v181, v248
    v_fmac_f32 v118, v182, v248
    v_fmac_f32 v119, v183, v248
    v_cvt_pk_bf16_f32 v30, v112, v113
    v_cvt_pk_bf16_f32 v31, v114, v115
    v_cvt_pk_bf16_f32 v32, v120, v121
    v_cvt_pk_bf16_f32 v33, v122, v123
    v_cvt_pk_bf16_f32 v34, v136, v137
    v_cvt_pk_bf16_f32 v35, v138, v139
    v_cvt_pk_bf16_f32 v36, v124, v125
    v_cvt_pk_bf16_f32 v37, v126, v127
    v_cvt_pk_bf16_f32 v38, v116, v117
    v_cvt_pk_bf16_f32 v39, v118, v119
    v_mov_b32 v40, 0
    v_mov_b32 v41, 0
    v_mul_f32 v250, 0x3fb8aa3b, v249
    s_nop 0
    v_mfma_f32_32x32x16_bf16 v[54:69], v[216:219], v[30:33], 0
    v_mfma_f32_32x32x16_bf16 v[54:69], v[220:223], v[34:37], v[54:69]
    v_mfma_f32_32x32x16_bf16 v[54:69], v[224:227], v[38:41], v[54:69]
    v_mfma_f32_32x32x16_bf16 v[70:85], v[228:231], v[30:33], 0
    v_mfma_f32_32x32x16_bf16 v[70:85], v[232:235], v[34:37], v[70:85]
    v_mfma_f32_32x32x16_bf16 v[70:85], v[236:239], v[38:41], v[70:85]
    ds_read_b128 v[86:89], v255 offset:384
    ds_read_b128 v[90:93], v255 offset:416
    ds_read_b128 v[94:97], v255 offset:448
    ds_read_b128 v[98:101], v255 offset:480
    s_add_u32 s36, s68, 14680064
    s_addc_u32 s37, s69, 0
    s_and_b32 s37, s37, 0xffff
    s_mov_b32 s38, 2621440
    s_mov_b32 s39, 0x00020000
    s_cmp_eq_u32 s51, 0
    s_mov_b32 s40, 2048
    s_cselect_b32 s40, 2560, s40
    v_mul_u32_u24 v25, 1024, v3
    v_add3_u32 v25, v25, v253, s40
    v_fmac_f32 v104, v168, v248
    v_mul_f32 v104, v104, v249
    v_fmac_f32 v105, v169, v248
    v_mul_f32 v105, v105, v249
    v_cvt_pk_bf16_f32 v216, v104, v105
    v_fmac_f32 v106, v170, v248
    v_mul_f32 v106, v106, v249
    v_fmac_f32 v107, v171, v248
    v_mul_f32 v107, v107, v249
    v_cvt_pk_bf16_f32 v217, v106, v107
    v_fmac_f32 v108, v172, v248
    v_mul_f32 v108, v108, v249
    v_fmac_f32 v109, v173, v248
    v_mul_f32 v109, v109, v249
    v_cvt_pk_bf16_f32 v218, v108, v109
    v_fmac_f32 v110, v174, v248
    v_mul_f32 v110, v110, v249
    v_fmac_f32 v111, v175, v248
    v_mul_f32 v111, v111, v249
    v_cvt_pk_bf16_f32 v219, v110, v111
    buffer_store_dwordx4 v[216:219], v25, s[36:39], 0 offen sc1
    s_cmp_lg_u32 s51, 0
    s_cbranch_scc1 K1A_noT3
    v_mul_u32_u24 v25, 512, v3
    v_add_u32 v25, v25, v253
    v_add_u32 v26, 1024, v25
    s_waitcnt lgkmcnt(0)
    v_fmac_f32 v152, v86, v248
    v_mul_f32 v152, v152, v249
    v_fmac_f32 v153, v87, v248
    v_mul_f32 v153, v153, v249
    v_cvt_pk_bf16_f32 v220, v152, v153
    v_fmac_f32 v154, v88, v248
    v_mul_f32 v154, v154, v249
    v_fmac_f32 v155, v89, v248
    v_mul_f32 v155, v155, v249
    v_cvt_pk_bf16_f32 v221, v154, v155
    v_fmac_f32 v156, v90, v248
    v_mul_f32 v156, v156, v249
    v_fmac_f32 v157, v91, v248
    v_mul_f32 v157, v157, v249
    v_cvt_pk_bf16_f32 v222, v156, v157
    v_fmac_f32 v158, v92, v248
    v_mul_f32 v158, v158, v249
    v_fmac_f32 v159, v93, v248
    v_mul_f32 v159, v159, v249
    v_cvt_pk_bf16_f32 v223, v158, v159
    buffer_store_dwordx4 v[220:223], v25, s[36:39], 0 offen sc1
    v_fmac_f32 v160, v94, v248
    v_mul_f32 v160, v160, v249
    v_fmac_f32 v161, v95, v248
    v_mul_f32 v161, v161, v249
    v_cvt_pk_bf16_f32 v224, v160, v161
    v_fmac_f32 v162, v96, v248
    v_mul_f32 v162, v162, v249
    v_fmac_f32 v163, v97, v248
    v_mul_f32 v163, v163, v249
    v_cvt_pk_bf16_f32 v225, v162, v163
    v_fmac_f32 v164, v98, v248
    v_mul_f32 v164, v164, v249
    v_fmac_f32 v165, v99, v248
    v_mul_f32 v165, v165, v249
    v_cvt_pk_bf16_f32 v226, v164, v165
    v_fmac_f32 v166, v100, v248
    v_mul_f32 v166, v166, v249
    v_fmac_f32 v167, v101, v248
    v_mul_f32 v167, v167, v249
    v_cvt_pk_bf16_f32 v227, v166, v167
    buffer_store_dwordx4 v[224:227], v26, s[36:39], 0 offen sc1
K1A_noT3:
    s_barrier
    v_fmac_f32 v140, v204, v248
    v_mul_f32 v140, v140, v249
    v_fmac_f32 v141, v205, v248
    v_mul_f32 v141, v141, v249
    v_cvt_pk_bf16_f32 v42, v140, v141
    v_fmac_f32 v142, v206, v248
    v_mul_f32 v142, v142, v249
    v_fmac_f32 v143, v207, v248
    v_mul_f32 v143, v143, v249
    v_cvt_pk_bf16_f32 v43, v142, v143
    v_fmac_f32 v128, v192, v248
    v_mul_f32 v128, v128, v249
    v_fmac_f32 v129, v193, v248
    v_mul_f32 v129, v129, v249
    v_cvt_pk_bf16_f32 v44, v128, v129
    v_fmac_f32 v130, v194, v248
    v_mul_f32 v130, v130, v249
    v_fmac_f32 v131, v195, v248
    v_mul_f32 v131, v131, v249
    v_cvt_pk_bf16_f32 v45, v130, v131
    v_fmac_f32 v144, v208, v248
    v_mul_f32 v144, v144, v249
    v_fmac_f32 v145, v209, v248
    v_mul_f32 v145, v145, v249
    v_cvt_pk_bf16_f32 v46, v144, v145
    v_fmac_f32 v146, v210, v248
    v_mul_f32 v146, v146, v249
    v_fmac_f32 v147, v211, v248
    v_mul_f32 v147, v147, v249
    v_cvt_pk_bf16_f32 v47, v146, v147
    v_fmac_f32 v132, v196, v248
    v_mul_f32 v132, v132, v249
    v_fmac_f32 v133, v197, v248
    v_mul_f32 v133, v133, v249
    v_cvt_pk_bf16_f32 v48, v132, v133
    v_fmac_f32 v134, v198, v248
    v_mul_f32 v134, v134, v249
    v_fmac_f32 v135, v199, v248
    v_mul_f32 v135, v135, v249
    v_cvt_pk_bf16_f32 v49, v134, v135
    v_fmac_f32 v148, v212, v248
    v_mul_f32 v148, v148, v249
    v_fmac_f32 v149, v213, v248
    v_mul_f32 v149, v149, v249
    v_cvt_pk_bf16_f32 v50, v148, v149
    v_fmac_f32 v150, v214, v248
    v_mul_f32 v150, v150, v249
    v_fmac_f32 v151, v215, v248
    v_mul_f32 v151, v151, v249
    v_cvt_pk_bf16_f32 v51, v150, v151
    v_mov_b32 v52, 0x3f80
    v_mov_b32 v53, 0
    ds_write_b128 v251, v[42:45] offset:0
    ds_write_b128 v251, v[46:49] offset:16
    ds_write_b128 v251, v[50:53] offset:32
    v_max3_f32 v20, v54, v55, v56
    v_min3_f32 v21, v54, v55, v56
    v_max3_f32 v20, v20, v57, v58
    v_min3_f32 v21, v21, v57, v58
    v_max3_f32 v20, v20, v59, v60
    v_min3_f32 v21, v21, v59, v60
    v_max3_f32 v20, v20, v61, v62
    v_min3_f32 v21, v21, v61, v62
    v_max3_f32 v20, v20, v63, v64
    v_min3_f32 v21, v21, v63, v64
    v_max3_f32 v20, v20, v65, v66
    v_min3_f32 v21, v21, v65, v66
    v_max3_f32 v20, v20, v67, v68
    v_min3_f32 v21, v21, v67, v68
    v_max3_f32 v20, v20, v69, v70
    v_min3_f32 v21, v21, v69, v70
    v_max3_f32 v20, v20, v71, v72
    v_min3_f32 v21, v21, v71, v72
    v_max_f32 v20, v20, v73
    v_min_f32 v21, v21, v73
    v_mul_f32 v20, v20, v250
    v_mul_f32 v21, v21, v250
    v_fma_f32 v168, v54, v250, -v20
    v_fma_f32 v188, -v54, v250, v21
    v_fma_f32 v169, v55, v250, -v20
    v_fma_f32 v189, -v55, v250, v21
    v_fma_f32 v170, v56, v250, -v20
    v_fma_f32 v190, -v56, v250, v21
    v_fma_f32 v171, v57, v250, -v20
    v_fma_f32 v191, -v57, v250, v21
    v_fma_f32 v172, v58, v250, -v20
    v_fma_f32 v192, -v58, v250, v21
    v_fma_f32 v173, v59, v250, -v20
    v_fma_f32 v193, -v59, v250, v21
    v_fma_f32 v174, v60, v250, -v20
    v_fma_f32 v194, -v60, v250, v21
    v_fma_f32 v175, v61, v250, -v20
    v_fma_f32 v195, -v61, v250, v21
    v_fma_f32 v176, v62, v250, -v20
    v_fma_f32 v196, -v62, v250, v21
    v_fma_f32 v177, v63, v250, -v20
    v_fma_f32 v197, -v63, v250, v21
    v_fma_f32 v178, v64, v250, -v20
    v_fma_f32 v198, -v64, v250, v21
    v_fma_f32 v179, v65, v250, -v20
    v_fma_f32 v199, -v65, v250, v21
    v_fma_f32 v180, v66, v250, -v20
    v_fma_f32 v200, -v66, v250, v21
    v_fma_f32 v181, v67, v250, -v20
    v_fma_f32 v201, -v67, v250, v21
    v_fma_f32 v182, v68, v250, -v20
    v_fma_f32 v202, -v68, v250, v21
    v_fma_f32 v183, v69, v250, -v20
    v_fma_f32 v203, -v69, v250, v21
    v_fma_f32 v184, v70, v250, -v20
    v_fma_f32 v204, -v70, v250, v21
    v_fma_f32 v185, v71, v250, -v20
    v_fma_f32 v205, -v71, v250, v21
    v_fma_f32 v186, v72, v250, -v20
    v_fma_f32 v206, -v72, v250, v21
    v_fma_f32 v187, v73, v250, -v20
    v_fma_f32 v207, -v73, v250, v21
    v_exp_f32 v168, v168
    v_exp_f32 v188, v188
    v_exp_f32 v169, v169
    v_exp_f32 v189, v189
    v_exp_f32 v170, v170
    v_exp_f32 v190, v190
    v_exp_f32 v171, v171
    v_exp_f32 v191, v191
    v_exp_f32 v172, v172
    v_exp_f32 v192, v192
    v_exp_f32 v173, v173
    v_exp_f32 v193, v193
    v_exp_f32 v174, v174
    v_exp_f32 v194, v194
    v_exp_f32 v175, v175
    v_exp_f32 v195, v195
    v_exp_f32 v176, v176
    v_exp_f32 v196, v196
    v_exp_f32 v177, v177
    v_exp_f32 v197, v197
    v_exp_f32 v178, v178
    v_exp_f32 v198, v198
    v_exp_f32 v179, v179
    v_exp_f32 v199, v199
    v_exp_f32 v180, v180
    v_exp_f32 v200, v200
    v_exp_f32 v181, v181
    v_exp_f32 v201, v201
    v_exp_f32 v182, v182
    v_exp_f32 v202, v202
    v_exp_f32 v183, v183
    v_exp_f32 v203, v203
    v_exp_f32 v184, v184
    v_exp_f32 v204, v204
    v_exp_f32 v185, v185
    v_exp_f32 v205, v205
    v_exp_f32 v186, v186
    v_exp_f32 v206, v206
    v_exp_f32 v187, v187
    v_exp_f32 v207, v207
    v_add_f32 v22, v168, v169
    v_add_f32 v23, v188, v189
    v_add_f32 v22, v22, v170
    v_add_f32 v23, v23, v190
    v_add_f32 v22, v22, v171
    v_add_f32 v23, v23, v191
    v_add_f32 v22, v22, v172
    v_add_f32 v23, v23, v192
    v_add_f32 v22, v22, v173
    v_add_f32 v23, v23, v193
    v_add_f32 v22, v22, v174
    v_add_f32 v23, v23, v194
    v_add_f32 v22, v22, v175
    v_add_f32 v23, v23, v195
    v_add_f32 v22, v22, v176
    v_add_f32 v23, v23, v196
    v_add_f32 v22, v22, v177
    v_add_f32 v23, v23, v197
    v_add_f32 v22, v22, v178
    v_add_f32 v23, v23, v198
    v_add_f32 v22, v22, v179
    v_add_f32 v23, v23, v199
    v_add_f32 v22, v22, v180
    v_add_f32 v23, v23, v200
    v_add_f32 v22, v22, v181
    v_add_f32 v23, v23, v201
    v_add_f32 v22, v22, v182
    v_add_f32 v23, v23, v202
    v_add_f32 v22, v22, v183
    v_add_f32 v23, v23, v203
    v_add_f32 v22, v22, v184
    v_add_f32 v23, v23, v204
    v_add_f32 v22, v22, v185
    v_add_f32 v23, v23, v205
    v_add_f32 v22, v22, v186
    v_add_f32 v23, v23, v206
    v_add_f32 v22, v22, v187
    v_add_f32 v23, v23, v207
    v_rcp_f32 v22, v22
    v_rcp_f32 v23, v23
    s_nop 0
    v_mul_f32 v168, v168, v22
    v_mul_f32 v169, v169, v22
    v_cvt_pk_bf16_f32 v30, v168, v169
    v_mul_f32 v170, v170, v22
    v_mul_f32 v171, v171, v22
    v_cvt_pk_bf16_f32 v31, v170, v171
    v_mul_f32 v172, v172, v22
    v_mul_f32 v173, v173, v22
    v_cvt_pk_bf16_f32 v32, v172, v173
    v_mul_f32 v174, v174, v22
    v_mul_f32 v175, v175, v22
    v_cvt_pk_bf16_f32 v33, v174, v175
    v_mul_f32 v176, v176, v22
    v_mul_f32 v177, v177, v22
    v_cvt_pk_bf16_f32 v34, v176, v177
    v_mul_f32 v178, v178, v22
    v_mul_f32 v179, v179, v22
    v_cvt_pk_bf16_f32 v35, v178, v179
    v_mul_f32 v180, v180, v22
    v_mul_f32 v181, v181, v22
    v_cvt_pk_bf16_f32 v36, v180, v181
    v_mul_f32 v182, v182, v22
    v_mul_f32 v183, v183, v22
    v_cvt_pk_bf16_f32 v37, v182, v183
    v_mul_f32 v184, v184, v22
    v_mul_f32 v185, v185, v22
    v_cvt_pk_bf16_f32 v38, v184, v185
    v_mul_f32 v186, v186, v22
    v_mul_f32 v187, v187, v22
    v_cvt_pk_bf16_f32 v39, v186, v187
    v_mul_f32 v188, v188, v23
    v_mul_f32 v189, v189, v23
    v_cvt_pk_bf16_f32 v40, v188, v189
    v_mul_f32 v190, v190, v23
    v_mul_f32 v191, v191, v23
    v_cvt_pk_bf16_f32 v41, v190, v191
    v_mul_f32 v192, v192, v23
    v_mul_f32 v193, v193, v23
    v_cvt_pk_bf16_f32 v42, v192, v193
    v_mul_f32 v194, v194, v23
    v_mul_f32 v195, v195, v23
    v_cvt_pk_bf16_f32 v43, v194, v195
    v_mul_f32 v196, v196, v23
    v_mul_f32 v197, v197, v23
    v_cvt_pk_bf16_f32 v44, v196, v197
    v_mul_f32 v198, v198, v23
    v_mul_f32 v199, v199, v23
    v_cvt_pk_bf16_f32 v45, v198, v199
    v_mul_f32 v200, v200, v23
    v_mul_f32 v201, v201, v23
    v_cvt_pk_bf16_f32 v46, v200, v201
    v_mul_f32 v202, v202, v23
    v_mul_f32 v203, v203, v23
    v_cvt_pk_bf16_f32 v47, v202, v203
    v_mul_f32 v204, v204, v23
    v_mul_f32 v205, v205, v23
    v_cvt_pk_bf16_f32 v48, v204, v205
    v_mul_f32 v206, v206, v23
    v_mul_f32 v207, v207, v23
    v_cvt_pk_bf16_f32 v49, v206, v207
    ds_write_b128 v252, v[30:33] offset:10240
    ds_write_b128 v252, v[34:37] offset:10256
    ds_write_b128 v252, v[38:41] offset:10272
    ds_write_b128 v252, v[42:45] offset:10288
    ds_write_b128 v252, v[46:49] offset:10304
    v_mov_b32 v24, 0
    global_load_dword v25, v24, s[70:71] offset:128 sc1
    s_lshr_b32 s40, s48, 1
    s_and_b32 s41, s48, 1
    v_bfe_u32 v120, v1, 2, 2
    v_lshl_add_u32 v120, v3, 3, v120
    v_bfe_u32 v121, v1, 4, 1
    v_lshlrev_b32 v121, 2, v121
    v_and_b32 v122, 3, v1
    v_add_u32 v121, v121, v122
    s_mul_i32 s42, s40, 48
    s_add_u32 s42, s42, 51200
    v_mul_u32_u24 v122, 192, v120
    v_lshl_add_u32 v122, v121, 3, v122
    v_add_u32 v122, s42, v122
    s_mul_i32 s42, s40, 80
    s_lshl_b32 s43, s41, 6
    s_add_u32 s42, s42, s43
    v_mul_u32_u24 v123, 320, v120
    v_lshl_add_u32 v123, v121, 3, v123
    v_add_u32 v123, s42, v123
    s_add_u32 s36, s68, 18874368
    s_addc_u32 s37, s69, 0
    s_and_b32 s37, s37, 0xffff
    s_mov_b32 s38, 107520
    s_mov_b32 s39, 0x00020000
    s_lshl_b32 s42, s50, 2
    s_add_u32 s42, s42, s40
    s_mul_i32 s42, s42, 3360
    s_lshl_b32 s43, s41, 7
    s_add_u32 s42, s42, s43
    v_mul_u32_u24 v120, 640, v3
    v_lshl_add_u32 v120, v2, 2, v120
    v_add_u32 v120, s42, v120
    s_waitcnt lgkmcnt(0)
    s_barrier
    ds_read_b64_tr_b16 v[30:31], v122 offset:0
    ds_read_b64_tr_b16 v[62:63], v123 offset:10240
    ds_read_b64_tr_b16 v[32:33], v122 offset:768
    ds_read_b64_tr_b16 v[64:65], v123 offset:11520
    ds_read_b64_tr_b16 v[34:35], v122 offset:3072
    ds_read_b64_tr_b16 v[66:67], v123 offset:15360
    ds_read_b64_tr_b16 v[36:37], v122 offset:3840
    ds_read_b64_tr_b16 v[68:69], v123 offset:16640
    ds_read_b64_tr_b16 v[38:39], v122 offset:6144
    ds_read_b64_tr_b16 v[70:71], v123 offset:20480
    ds_read_b64_tr_b16 v[40:41], v122 offset:6912
    ds_read_b64_tr_b16 v[72:73], v123 offset:21760
    ds_read_b64_tr_b16 v[42:43], v122 offset:9216
    ds_read_b64_tr_b16 v[74:75], v123 offset:25600
    ds_read_b64_tr_b16 v[44:45], v122 offset:9984
    ds_read_b64_tr_b16 v[76:77], v123 offset:26880
    ds_read_b64_tr_b16 v[46:47], v122 offset:12288
    ds_read_b64_tr_b16 v[78:79], v123 offset:30720
    ds_read_b64_tr_b16 v[48:49], v122 offset:13056
    ds_read_b64_tr_b16 v[80:81], v123 offset:32000
    ds_read_b64_tr_b16 v[50:51], v122 offset:15360
    ds_read_b64_tr_b16 v[82:83], v123 offset:35840
    ds_read_b64_tr_b16 v[52:53], v122 offset:16128
    ds_read_b64_tr_b16 v[84:85], v123 offset:37120
    ds_read_b64_tr_b16 v[54:55], v122 offset:18432
    ds_read_b64_tr_b16 v[86:87], v123 offset:40960
    ds_read_b64_tr_b16 v[56:57], v122 offset:19200
    ds_read_b64_tr_b16 v[88:89], v123 offset:42240
    ds_read_b64_tr_b16 v[58:59], v122 offset:21504
    ds_read_b64_tr_b16 v[90:91], v123 offset:46080
    ds_read_b64_tr_b16 v[60:61], v122 offset:22272
    ds_read_b64_tr_b16 v[92:93], v123 offset:47360
    s_waitcnt lgkmcnt(15)
    v_mfma_f32_32x32x16_bf16 v[168:183], v[30:33], v[62:65], 0
    s_waitcnt lgkmcnt(15)
    v_mfma_f32_32x32x16_bf16 v[168:183], v[34:37], v[66:69], v[168:183]
    s_waitcnt lgkmcnt(15)
    v_mfma_f32_32x32x16_bf16 v[168:183], v[38:41], v[70:73], v[168:183]
    s_waitcnt lgkmcnt(15)
    v_mfma_f32_32x32x16_bf16 v[168:183], v[42:45], v[74:77], v[168:183]
    s_waitcnt lgkmcnt(12)
    v_mfma_f32_32x32x16_bf16 v[168:183], v[46:49], v[78:81], v[168:183]
    s_waitcnt lgkmcnt(8)
    v_mfma_f32_32x32x16_bf16 v[168:183], v[50:53], v[82:85], v[168:183]
    s_waitcnt lgkmcnt(4)
    v_mfma_f32_32x32x16_bf16 v[168:183], v[54:57], v[86:89], v[168:183]
    s_waitcnt lgkmcnt(0)
    v_mfma_f32_32x32x16_bf16 v[168:183], v[58:61], v[90:93], v[168:183]
    s_mov_b32 s45, 0
K1A_POLL:
    s_waitcnt vmcnt(0)
    s_add_u32 s45, s45, 1
    s_cmp_gt_u32 s45, 4000
    s_cbranch_scc1 K1A_GO
    v_readfirstlane_b32 s44, v25
    s_cmp_ge_u32 s44, 14
    s_cbranch_scc1 K1A_GO
    s_sleep 2
    global_load_dword v25, v24, s[70:71] offset:128 sc1
    s_branch K1A_POLL
K1A_GO:
    s_cmp_eq_u32 s41, 0
    s_cselect_b32 s44, 32, 8
    v_cmp_gt_u32 vcc, s44, v2
    s_and_b64 exec, exec, vcc
    s_nop 7
    s_nop 3
    buffer_atomic_add_f32 v168, v120, s[36:39], 0 offen offset:0
    buffer_atomic_add_f32 v169, v120, s[36:39], 0 offen offset:160
    buffer_atomic_add_f32 v170, v120, s[36:39], 0 offen offset:320
    buffer_atomic_add_f32 v171, v120, s[36:39], 0 offen offset:480
    buffer_atomic_add_f32 v172, v120, s[36:39], 0 offen offset:1280
    buffer_atomic_add_f32 v173, v120, s[36:39], 0 offen offset:1440
    buffer_atomic_add_f32 v174, v120, s[36:39], 0 offen offset:1600
    buffer_atomic_add_f32 v175, v120, s[36:39], 0 offen offset:1760
    buffer_atomic_add_f32 v176, v120, s[36:39], 0 offen offset:2560
    v_cmp_eq_u32 vcc, 0, v3
    s_and_b64 exec, exec, vcc
    buffer_atomic_add_f32 v177, v120, s[36:39], 0 offen offset:2720
    buffer_atomic_add_f32 v178, v120, s[36:39], 0 offen offset:2880
    buffer_atomic_add_f32 v179, v120, s[36:39], 0 offen offset:3040
    s_mov_b64 exec, -1
    s_branch K1_DONE
K1_B:
    s_and_b32 s51, s48, 3
    s_lshr_b32 s52, s48, 2
    s_lshl_b32 s40, s50, 2
    s_sub_u32 s41, s50, 5
    s_max_i32 s41, s41, 0
    s_sub_u32 s83, s40, s41
    s_cmp_lt_u32 s50, 5
    s_cselect_b32 s84, 4, 3
    s_cmp_lt_u32 0, s84
    s_cselect_b32 s40, 0, 0
    s_add_u32 s40, s40, s83
    s_add_u32 s42, s40, 8
    s_sub_u32 s43, s40, 2
    s_cmp_lt_u32 s40, 2
    s_cselect_b32 s20, s6, s12
    s_cselect_b32 s21, s7, s13
    s_mov_b32 s22, 2211840
    s_cselect_b32 s22, 2457600, s22
    s_mov_b32 s23, 0x00020000
    s_mov_b32 s41, 3456
    s_cselect_b32 s41, 3840, s41
    s_cselect_b32 s42, s42, s43
    s_and_b32 s21, s21, 0xffff
    s_lshl_b32 s60, s41, 6
    s_lshl_b32 s42, s42, 7
    v_mul_lo_u32 v25, v21, s41
    v_lshl_add_u32 v25, v24, 4, v25
    v_add_u32 v5, s42, v25
    s_cmp_lt_u32 1, s84
    s_cselect_b32 s40, 1, 0
    s_add_u32 s40, s40, s83
    s_add_u32 s42, s40, 8
    s_sub_u32 s43, s40, 2
    s_cmp_lt_u32 s40, 2
    s_cselect_b32 s24, s6, s12
    s_cselect_b32 s25, s7, s13
    s_mov_b32 s26, 2211840
    s_cselect_b32 s26, 2457600, s26
    s_mov_b32 s27, 0x00020000
    s_mov_b32 s41, 3456
    s_cselect_b32 s41, 3840, s41
    s_cselect_b32 s42, s42, s43
    s_and_b32 s25, s25, 0xffff
    s_lshl_b32 s61, s41, 6
    s_lshl_b32 s42, s42, 7
    v_mul_lo_u32 v25, v21, s41
    v_lshl_add_u32 v25, v24, 4, v25
    v_add_u32 v6, s42, v25
    s_cmp_lt_u32 2, s84
    s_cselect_b32 s40, 2, 0
    s_add_u32 s40, s40, s83
    s_add_u32 s42, s40, 8
    s_sub_u32 s43, s40, 2
    s_cmp_lt_u32 s40, 2
    s_cselect_b32 s28, s6, s12
    s_cselect_b32 s29, s7, s13
    s_mov_b32 s30, 2211840
    s_cselect_b32 s30, 2457600, s30
    s_mov_b32 s31, 0x00020000
    s_mov_b32 s41, 3456
    s_cselect_b32 s41, 3840, s41
    s_cselect_b32 s42, s42, s43
    s_and_b32 s29, s29, 0xffff
    s_lshl_b32 s62, s41, 6
    s_lshl_b32 s42, s42, 7
    v_mul_lo_u32 v25, v21, s41
    v_lshl_add_u32 v25, v24, 4, v25
    v_add_u32 v7, s42, v25
    s_cmp_lt_u32 3, s84
    s_cselect_b32 s40, 3, 0
    s_add_u32 s40, s40, s83
    s_add_u32 s42, s40, 8
    s_sub_u32 s43, s40, 2
    s_cmp_lt_u32 s40, 2
    s_cselect_b32 s32, s6, s12
    s_cselect_b32 s33, s7, s13
    s_mov_b32 s34, 2211840
    s_cselect_b32 s34, 2457600, s34
    s_mov_b32 s35, 0x00020000
    s_mov_b32 s41, 3456
    s_cselect_b32 s41, 3840, s41
    s_cselect_b32 s42, s42, s43
    s_and_b32 s33, s33, 0xffff
    s_lshl_b32 s63, s41, 6
    s_lshl_b32 s42, s42, 7
    v_mul_lo_u32 v25, v21, s41
    v_lshl_add_u32 v25, v24, 4, v25
    v_add_u32 v8, s42, v25
    s_mul_i32 s56, s67, s60
    s_mul_i32 s57, s67, s61
    s_mul_i32 s58, s67, s62
    s_mul_i32 s59, s67, s63
    s_add_u32 m0, s66, 0
    s_nop 0
    buffer_load_dwordx4 v5, s[20:23], s56 offen lds
    s_add_u32 m0, s66, 8192
    s_nop 0
    buffer_load_dwordx4 v6, s[24:27], s57 offen lds
    s_add_u32 m0, s66, 16384
    s_nop 0
    buffer_load_dwordx4 v7, s[28:31], s58 offen lds
    s_add_u32 m0, s66, 24576
    s_nop 0
    buffer_load_dwordx4 v8, s[32:35], s59 offen lds
    s_add_u32 s55, s55, 128
    s_add_u32 s56, s56, s60
    s_add_u32 s57, s57, s61
    s_add_u32 s58, s58, s62
    s_add_u32 s59, s59, s63
    s_add_u32 s67, s67, 1
    s_cmp_eq_u32 s67, 10
    s_cselect_b32 s67, 0, s67
    s_cselect_b32 s55, 0, s55
    s_cselect_b32 s56, 0, s56
    s_cselect_b32 s57, 0, s57
    s_cselect_b32 s58, 0, s58
    s_cselect_b32 s59, 0, s59
    s_add_u32 s83, s83, s51
    v_bfe_u32 v248, v1, 4, 1
    v_lshlrev_b32 v248, 2, v248
    v_and_b32 v28, 3, v1
    v_add_u32 v248, v248, v28
    v_bfe_u32 v249, v1, 2, 2
    v_bfe_u32 v250, v1, 3, 1
    v_lshlrev_b32 v250, 2, v250
    v_lshl_add_u32 v249, v3, 3, v249
    v_and_b32 v21, 1, v248
    v_bfe_u32 v22, v248, 1, 1
    v_bfe_u32 v23, v248, 2, 1
    v_lshl_add_u32 v21, v23, 1, v21
    s_lshl_b32 s40, s51, 13
    s_add_u32 s40, s40, 59392
    v_add_u32 v24, 0, v21
    v_xor_b32 v24, v24, v250
    v_lshlrev_b32 v24, 4, v24
    v_lshl_add_u32 v24, v22, 3, v24
    v_lshl_add_u32 v24, v249, 7, v24
    v_add_u32 v11, s40, v24
    v_add_u32 v24, 4, v21
    v_xor_b32 v24, v24, v250
    v_lshlrev_b32 v24, 4, v24
    v_lshl_add_u32 v24, v22, 3, v24
    v_lshl_add_u32 v24, v249, 7, v24
    v_add_u32 v12, s40, v24
    v_bfe_u32 v21, v2, 1, 3
    v_lshlrev_b32 v22, 2, v3
    v_xor_b32 v21, v21, v22
    s_lshl_b32 s40, s52, 6
    v_add_u32 v22, s40, v2
    v_lshlrev_b32 v22, 7, v22
    v_lshl_add_u32 v9, v21, 4, v22
    v_add_u32 v22, s40, v2
    v_add_u32 v22, 32, v22
    v_lshlrev_b32 v22, 7, v22
    v_lshl_add_u32 v10, v21, 4, v22
    s_cmp_lt_u32 s49, 10
    s_cselect_b32 s87, s52, 99
    s_cselect_b32 s88, 1, 0
    s_cselect_b32 s89, 1, 0
    s_cmp_lt_u32 s48, 4
    s_cselect_b32 s89, s89, 0
    v_mov_b32 v103, 0
    s_lshl_b32 s85, s49, 3
    s_add_u32 s85, s85, s50
    s_add_u32 m0, s65, 26624
    s_add_u32 s40, s55, 81920
    buffer_load_dwordx4 v4, s[16:19], s55 offen lds
    s_add_u32 m0, m0, 8192
    s_nop 0
    buffer_load_dwordx4 v4, s[16:19], s40 offen lds
    s_add_u32 m0, s66, 32768
    s_nop 0
    buffer_load_dwordx4 v5, s[20:23], s56 offen lds
    s_add_u32 m0, s66, 40960
    s_nop 0
    buffer_load_dwordx4 v6, s[24:27], s57 offen lds
    s_add_u32 m0, s66, 49152
    s_nop 0
    buffer_load_dwordx4 v7, s[28:31], s58 offen lds
    s_add_u32 m0, s66, 57344
    s_nop 0
    buffer_load_dwordx4 v8, s[32:35], s59 offen lds
    s_add_u32 s55, s55, 128
    s_add_u32 s56, s56, s60
    s_add_u32 s57, s57, s61
    s_add_u32 s58, s58, s62
    s_add_u32 s59, s59, s63
    s_add_u32 s67, s67, 1
    s_cmp_eq_u32 s67, 10
    s_cselect_b32 s67, 0, s67
    s_cselect_b32 s55, 0, s55
    s_cselect_b32 s56, 0, s56
    s_cselect_b32 s57, 0, s57
    s_cselect_b32 s58, 0, s58
    s_cselect_b32 s59, 0, s59
    v_mov_b32 v252, 0x3f803f80
    v_mov_b32 v253, 0x3f803f80
    v_mov_b32 v254, 0x3f803f80
    v_mov_b32 v255, 0x3f803f80
    s_waitcnt vmcnt(12)
    v_mov_b32 v24, 0x3f803f80
    v_mov_b32 v22, 0
    v_mov_b32 v23, 0
    v_dot2_f32_bf16 v22, v232, v24, v22
    v_dot2_f32_bf16 v23, v232, v232, v23
    v_dot2_f32_bf16 v22, v233, v24, v22
    v_dot2_f32_bf16 v23, v233, v233, v23
    v_dot2_f32_bf16 v22, v234, v24, v22
    v_dot2_f32_bf16 v23, v234, v234, v23
    v_dot2_f32_bf16 v22, v235, v24, v22
    v_dot2_f32_bf16 v23, v235, v235, v23
    v_dot2_f32_bf16 v22, v236, v24, v22
    v_dot2_f32_bf16 v23, v236, v236, v23
    v_dot2_f32_bf16 v22, v237, v24, v22
    v_dot2_f32_bf16 v23, v237, v237, v23
    v_dot2_f32_bf16 v22, v238, v24, v22
    v_dot2_f32_bf16 v23, v238, v238, v23
    v_dot2_f32_bf16 v22, v239, v24, v22
    v_dot2_f32_bf16 v23, v239, v239, v23
    s_nop 1
    v_add_f32_dpp v22, v22, v22 row_shr:1 row_mask:0xf bank_mask:0xf
    v_add_f32_dpp v23, v23, v23 row_shr:1 row_mask:0xf bank_mask:0xf
    s_nop 1
    v_add_f32_dpp v22, v22, v22 row_shr:2 row_mask:0xf bank_mask:0xf
    v_add_f32_dpp v23, v23, v23 row_shr:2 row_mask:0xf bank_mask:0xf
    s_nop 1
    v_add_f32_dpp v22, v22, v22 row_shr:4 row_mask:0xf bank_mask:0xf
    v_add_f32_dpp v23, v23, v23 row_shr:4 row_mask:0xf bank_mask:0xf
    s_nop 1
    v_add_f32_dpp v22, v22, v22 row_shr:8 row_mask:0xf bank_mask:0xf
    v_add_f32_dpp v23, v23, v23 row_shr:8 row_mask:0xf bank_mask:0xf
    s_nop 1
    v_add_f32_dpp v22, v22, v22 row_bcast:15 row_mask:0xa bank_mask:0xf
    v_add_f32_dpp v23, v23, v23 row_bcast:15 row_mask:0xa bank_mask:0xf
    s_nop 1
    v_add_f32_dpp v22, v22, v22 row_bcast:31 row_mask:0xc bank_mask:0xf
    v_add_f32_dpp v23, v23, v23 row_bcast:31 row_mask:0xc bank_mask:0xf
    v_mul_f32 v240, 0xbacccccd, v22
    v_mul_f32 v23, 0x3acccccd, v23
    v_fma_f32 v23, -v240, v240, v23
    v_max_f32 v23, 0, v23
    v_add_f32 v23, 0x3727c5ac, v23
    v_rsq_f32 v241, v23
    s_lshl_b32 s40, s49, 7
    s_lshl_b32 s41, s86, 3
    s_add_u32 s40, s40, s41
    s_add_u32 s40, s40, s48
    s_lshl_b32 s40, s40, 4
    s_add_u32 s92, s40, 19136512
    s_waitcnt vmcnt(6)
    s_cmp_eq_u32 s90, 0
    s_cbranch_scc1 K1_nm_26
    v_add_u32 v243, 1, v243
    v_max_u32 v243, 1, v243
    v_mov_b32 v27, 0
    v_mov_b32 v28, 19660800
    s_mov_b64 exec, 1
    global_store_dword v27, v243, s[70:71] sc0 sc1
    global_store_dword v28, v243, s[68:69] sc0 sc1
    s_mov_b64 exec, -1
K1_nm_26:
    s_cmp_lt_u32 s85, 14
    s_cselect_b32 s93, 1, 0
    s_cmp_eq_u32 s48, 2
    s_cselect_b32 s91, s93, 0
    s_waitcnt lgkmcnt(0)
    s_barrier
    s_mov_b32 s81, 43008
    s_mov_b32 s82, 65536
    v_add_u32 v15, s54, v11
    v_add_u32 v16, s54, v12
    v_xad_u32 v20, v9, 0, s53
    ds_read_b128 v[30:33], v20
    v_xad_u32 v21, v10, 0, s53
    ds_read_b128 v[34:37], v21
    ds_read_b64_tr_b16 v[54:55], v15 offset:0
    ds_read_b64_tr_b16 v[56:57], v15 offset:512
    ds_read_b64_tr_b16 v[58:59], v16 offset:0
    ds_read_b64_tr_b16 v[60:61], v16 offset:512
    v_xad_u32 v20, v9, 16, s53
    ds_read_b128 v[38:41], v20
    v_xad_u32 v21, v10, 16, s53
    ds_read_b128 v[42:45], v21
    ds_read_b64_tr_b16 v[70:71], v15 offset:2048
    ds_read_b64_tr_b16 v[72:73], v15 offset:2560
    ds_read_b64_tr_b16 v[74:75], v16 offset:2048
    ds_read_b64_tr_b16 v[76:77], v16 offset:2560
    s_waitcnt lgkmcnt(6)
    v_mfma_f32_32x32x16_bf16 v[104:119], v[54:57], v[30:33], 0
    v_xad_u32 v20, v9, 32, s53
    ds_read_b128 v[46:49], v20
    v_xad_u32 v21, v10, 32, s53
    ds_read_b128 v[50:53], v21
    s_add_u32 m0, s65, s81
    s_add_u32 s40, s55, 81920
    buffer_load_dwordx4 v4, s[16:19], s55 offen lds
    v_mfma_f32_32x32x16_bf16 v[120:135], v[54:57], v[34:37], 0
    ds_read_b64_tr_b16 v[86:87], v15 offset:4096
    ds_read_b64_tr_b16 v[88:89], v15 offset:4608
    ds_read_b64_tr_b16 v[90:91], v16 offset:4096
    ds_read_b64_tr_b16 v[92:93], v16 offset:4608
    s_add_u32 m0, s65, s81
    s_add_u32 m0, m0, 8192
    s_add_u32 s40, s55, 81920
    buffer_load_dwordx4 v4, s[16:19], s40 offen lds
    v_mfma_f32_32x32x16_bf16 v[136:151], v[58:61], v[30:33], 0
    s_add_u32 s41, s66, s82
    s_add_u32 m0, s41, 0
    s_nop 0
    buffer_load_dwordx4 v5, s[20:23], s56 offen lds
    v_mfma_f32_32x32x16_bf16 v[152:167], v[58:61], v[34:37], 0
    s_add_u32 s41, s66, s82
    s_add_u32 m0, s41, 8192
    s_nop 0
    buffer_load_dwordx4 v6, s[24:27], s57 offen lds
    s_cmp_lg_u32 s87, 0
    s_cbranch_scc1 K1B_cs_27e
    v_mfma_f32_32x32x16_bf16 v[168:183], v[252:255], v[54:57], 0
    v_mfma_f32_32x32x16_bf16 v[184:199], v[252:255], v[58:61], 0
K1B_cs_27e:
    s_waitcnt lgkmcnt(6)
    v_mfma_f32_32x32x16_bf16 v[104:119], v[70:73], v[38:41], v[104:119]
    v_xad_u32 v20, v9, 48, s53
    ds_read_b128 v[30:33], v20
    v_xad_u32 v21, v10, 48, s53
    ds_read_b128 v[34:37], v21
    s_add_u32 s41, s66, s82
    s_add_u32 m0, s41, 16384
    s_nop 0
    buffer_load_dwordx4 v7, s[28:31], s58 offen lds
    v_mfma_f32_32x32x16_bf16 v[120:135], v[70:73], v[42:45], v[120:135]
    ds_read_b64_tr_b16 v[54:55], v15 offset:6144
    ds_read_b64_tr_b16 v[56:57], v15 offset:6656
    ds_read_b64_tr_b16 v[58:59], v16 offset:6144
    ds_read_b64_tr_b16 v[60:61], v16 offset:6656
    s_add_u32 s41, s66, s82
    s_add_u32 m0, s41, 24576
    s_nop 0
    buffer_load_dwordx4 v8, s[32:35], s59 offen lds
    s_add_u32 s55, s55, 128
    s_add_u32 s56, s56, s60
    s_add_u32 s57, s57, s61
    s_add_u32 s58, s58, s62
    s_add_u32 s59, s59, s63
    s_add_u32 s67, s67, 1
    s_cmp_eq_u32 s67, 10
    s_cselect_b32 s67, 0, s67
    s_cselect_b32 s55, 0, s55
    s_cselect_b32 s56, 0, s56
    s_cselect_b32 s57, 0, s57
    s_cselect_b32 s58, 0, s58
    s_cselect_b32 s59, 0, s59
    v_mfma_f32_32x32x16_bf16 v[136:151], v[74:77], v[38:41], v[136:151]
    buffer_load_dword v102, v103, s[16:19], 0 offen
    v_mfma_f32_32x32x16_bf16 v[152:167], v[74:77], v[42:45], v[152:167]
    s_cmp_lg_u32 s87, 1
    s_cbranch_scc1 K1B_cs_28e
    v_mfma_f32_32x32x16_bf16 v[168:183], v[252:255], v[70:73], 0
    v_mfma_f32_32x32x16_bf16 v[184:199], v[252:255], v[74:77], 0
K1B_cs_28e:
    s_waitcnt lgkmcnt(0)
    s_waitcnt vmcnt(7)
    s_barrier
    s_mov_b32 s81, s53
    s_mov_b32 s82, s54
    s_add_u32 s53, s53, 16384
    s_add_u32 s54, s54, 32768
    s_cmp_eq_u32 s53, 59392
    s_cselect_b32 s53, 10240, s53
    s_cselect_b32 s54, 0, s54
    v_add_u32 v15, s54, v11
    v_add_u32 v16, s54, v12
    v_mfma_f32_32x32x16_bf16 v[104:119], v[86:89], v[46:49], v[104:119]
    v_xad_u32 v20, v9, 0, s53
    ds_read_b128 v[38:41], v20
    v_xad_u32 v21, v10, 0, s53
    ds_read_b128 v[42:45], v21
    v_mfma_f32_32x32x16_bf16 v[120:135], v[86:89], v[50:53], v[120:135]
    ds_read_b64_tr_b16 v[70:71], v15 offset:0
    ds_read_b64_tr_b16 v[72:73], v15 offset:512
    ds_read_b64_tr_b16 v[74:75], v16 offset:0
    ds_read_b64_tr_b16 v[76:77], v16 offset:512
    v_mfma_f32_32x32x16_bf16 v[136:151], v[90:93], v[46:49], v[136:151]
    s_add_u32 m0, s65, s81
    s_add_u32 s40, s55, 81920
    buffer_load_dwordx4 v4, s[16:19], s55 offen lds
    v_mfma_f32_32x32x16_bf16 v[152:167], v[90:93], v[50:53], v[152:167]
    s_add_u32 m0, s65, s81
    s_add_u32 m0, m0, 8192
    s_add_u32 s40, s55, 81920
    buffer_load_dwordx4 v4, s[16:19], s40 offen lds
    s_cmp_lg_u32 s87, 0
    s_cbranch_scc1 K1B_cs_29e
    v_mfma_f32_32x32x16_bf16 v[168:183], v[252:255], v[86:89], v[168:183]
    v_mfma_f32_32x32x16_bf16 v[184:199], v[252:255], v[90:93], v[184:199]
K1B_cs_29e:
    s_waitcnt lgkmcnt(6)
    v_mfma_f32_32x32x16_bf16 v[104:119], v[54:57], v[30:33], v[104:119]
    v_xad_u32 v20, v9, 16, s53
    ds_read_b128 v[46:49], v20
    v_xad_u32 v21, v10, 16, s53
    ds_read_b128 v[50:53], v21
    v_mfma_f32_32x32x16_bf16 v[120:135], v[54:57], v[34:37], v[120:135]
    ds_read_b64_tr_b16 v[86:87], v15 offset:2048
    ds_read_b64_tr_b16 v[88:89], v15 offset:2560
    ds_read_b64_tr_b16 v[90:91], v16 offset:2048
    ds_read_b64_tr_b16 v[92:93], v16 offset:2560
    v_mfma_f32_32x32x16_bf16 v[136:151], v[58:61], v[30:33], v[136:151]
    s_add_u32 s41, s66, s82
    s_add_u32 m0, s41, 0
    s_nop 0
    buffer_load_dwordx4 v5, s[20:23], s56 offen lds
    v_mfma_f32_32x32x16_bf16 v[152:167], v[58:61], v[34:37], v[152:167]
    s_add_u32 s41, s66, s82
    s_add_u32 m0, s41, 8192
    s_nop 0
    buffer_load_dwordx4 v6, s[24:27], s57 offen lds
    s_cmp_lg_u32 s87, 1
    s_cbranch_scc1 K1B_cs_30e
    v_mfma_f32_32x32x16_bf16 v[168:183], v[252:255], v[54:57], v[168:183]
    v_mfma_f32_32x32x16_bf16 v[184:199], v[252:255], v[58:61], v[184:199]
K1B_cs_30e:
    s_waitcnt lgkmcnt(6)
    v_mfma_f32_32x32x16_bf16 v[104:119], v[70:73], v[38:41], v[104:119]
    v_xad_u32 v20, v9, 32, s53
    ds_read_b128 v[30:33], v20
    v_xad_u32 v21, v10, 32, s53
    ds_read_b128 v[34:37], v21
    v_mfma_f32_32x32x16_bf16 v[120:135], v[70:73], v[42:45], v[120:135]
    ds_read_b64_tr_b16 v[54:55], v15 offset:4096
    ds_read_b64_tr_b16 v[56:57], v15 offset:4608
    ds_read_b64_tr_b16 v[58:59], v16 offset:4096
    ds_read_b64_tr_b16 v[60:61], v16 offset:4608
    v_mfma_f32_32x32x16_bf16 v[136:151], v[74:77], v[38:41], v[136:151]
    s_add_u32 s41, s66, s82
    s_add_u32 m0, s41, 16384
    s_nop 0
    buffer_load_dwordx4 v7, s[28:31], s58 offen lds
    v_mfma_f32_32x32x16_bf16 v[152:167], v[74:77], v[42:45], v[152:167]
    s_add_u32 s41, s66, s82
    s_add_u32 m0, s41, 24576
    s_nop 0
    buffer_load_dwordx4 v8, s[32:35], s59 offen lds
    s_add_u32 s55, s55, 128
    s_add_u32 s56, s56, s60
    s_add_u32 s57, s57, s61
    s_add_u32 s58, s58, s62
    s_add_u32 s59, s59, s63
    s_add_u32 s67, s67, 1
    s_cmp_eq_u32 s67, 10
    s_cselect_b32 s67, 0, s67
    s_cselect_b32 s55, 0, s55
    s_cselect_b32 s56, 0, s56
    s_cselect_b32 s57, 0, s57
    s_cselect_b32 s58, 0, s58
    s_cselect_b32 s59, 0, s59
    s_cmp_lg_u32 s88, 1
    s_cbranch_scc1 K1B_cw_31e
    s_mul_i32 s40, s51, 256
    s_lshl_b32 s41, s52, 10
    s_add_u32 s40, s40, s41
    v_lshlrev_b32 v28, 7, v3
    v_lshl_add_u32 v28, v2, 2, v28
    v_add_u32 v28, s40, v28
    v_cmp_eq_u32 vcc, 1, v3
    s_nop 1
    v_cndmask_b32 v29, v168, v184, vcc
    ds_write_b32 v28, v29 offset:6144
K1B_cw_31e:
    s_waitcnt lgkmcnt(6)
    v_mfma_f32_32x32x16_bf16 v[104:119], v[86:89], v[46:49], v[104:119]
    v_xad_u32 v20, v9, 48, s53
    ds_read_b128 v[38:41], v20
    v_xad_u32 v21, v10, 48, s53
    ds_read_b128 v[42:45], v21
    v_mfma_f32_32x32x16_bf16 v[120:135], v[86:89], v[50:53], v[120:135]
    ds_read_b64_tr_b16 v[70:71], v15 offset:6144
    ds_read_b64_tr_b16 v[72:73], v15 offset:6656
    ds_read_b64_tr_b16 v[74:75], v16 offset:6144
    ds_read_b64_tr_b16 v[76:77], v16 offset:6656
    v_mfma_f32_32x32x16_bf16 v[136:151], v[90:93], v[46:49], v[136:151]
    global_load_dword v243, v103, s[70:71] sc1
    v_mfma_f32_32x32x16_bf16 v[152:167], v[90:93], v[50:53], v[152:167]
    s_waitcnt lgkmcnt(0)
    s_waitcnt vmcnt(8)
    s_barrier
    s_mov_b32 s81, s53
    s_mov_b32 s82, s54
    s_add_u32 s53, s53, 16384
    s_add_u32 s54, s54, 32768
    s_cmp_eq_u32 s53, 59392
    s_cselect_b32 s53, 10240, s53
    s_cselect_b32 s54, 0, s54
    v_add_u32 v15, s54, v11
    v_add_u32 v16, s54, v12
    v_mfma_f32_32x32x16_bf16 v[104:119], v[54:57], v[30:33], v[104:119]
    v_xad_u32 v20, v9, 0, s53
    ds_read_b128 v[46:49], v20
    v_xad_u32 v21, v10, 0, s53
    ds_read_b128 v[50:53], v21
    v_mfma_f32_32x32x16_bf16 v[120:135], v[54:57], v[34:37], v[120:135]
    ds_read_b64_tr_b16 v[86:87], v15 offset:0
    ds_read_b64_tr_b16 v[88:89], v15 offset:512
    ds_read_b64_tr_b16 v[90:91], v16 offset:0
    ds_read_b64_tr_b16 v[92:93], v16 offset:512
    v_mfma_f32_32x32x16_bf16 v[136:151], v[58:61], v[30:33], v[136:151]
    s_add_u32 m0, s65, s81
    s_add_u32 s40, s55, 81920
    buffer_load_dwordx4 v4, s[16:19], s55 offen lds
    v_mfma_f32_32x32x16_bf16 v[152:167], v[58:61], v[34:37], v[152:167]
    s_add_u32 m0, s65, s81
    s_add_u32 m0, m0, 8192
    s_add_u32 s40, s55, 81920
    buffer_load_dwordx4 v4, s[16:19], s40 offen lds
    s_waitcnt lgkmcnt(6)
    v_mfma_f32_32x32x16_bf16 v[104:119], v[70:73], v[38:41], v[104:119]
    v_xad_u32 v20, v9, 16, s53
    ds_read_b128 v[30:33], v20
    v_xad_u32 v21, v10, 16, s53
    ds_read_b128 v[34:37], v21
    v_mfma_f32_32x32x16_bf16 v[120:135], v[70:73], v[42:45], v[120:135]
    ds_read_b64_tr_b16 v[54:55], v15 offset:2048
    ds_read_b64_tr_b16 v[56:57], v15 offset:2560
    ds_read_b64_tr_b16 v[58:59], v16 offset:2048
    ds_read_b64_tr_b16 v[60:61], v16 offset:2560
    v_mfma_f32_32x32x16_bf16 v[136:151], v[74:77], v[38:41], v[136:151]
    s_add_u32 s41, s66, s82
    s_add_u32 m0, s41, 0
    s_nop 0
    buffer_load_dwordx4 v5, s[20:23], s56 offen lds
    v_mfma_f32_32x32x16_bf16 v[152:167], v[74:77], v[42:45], v[152:167]
    s_add_u32 s41, s66, s82
    s_add_u32 m0, s41, 8192
    s_nop 0
    buffer_load_dwordx4 v6, s[24:27], s57 offen lds
    s_waitcnt lgkmcnt(6)
    v_mfma_f32_32x32x16_bf16 v[104:119], v[86:89], v[46:49], v[104:119]
    v_xad_u32 v20, v9, 32, s53
    ds_read_b128 v[38:41], v20
    v_xad_u32 v21, v10, 32, s53
    ds_read_b128 v[42:45], v21
    v_mfma_f32_32x32x16_bf16 v[120:135], v[86:89], v[50:53], v[120:135]
    ds_read_b64_tr_b16 v[70:71], v15 offset:4096
    ds_read_b64_tr_b16 v[72:73], v15 offset:4608
    ds_read_b64_tr_b16 v[74:75], v16 offset:4096
    ds_read_b64_tr_b16 v[76:77], v16 offset:4608
    v_mfma_f32_32x32x16_bf16 v[136:151], v[90:93], v[46:49], v[136:151]
    s_add_u32 s41, s66, s82
    s_add_u32 m0, s41, 16384
    s_nop 0
    buffer_load_dwordx4 v7, s[28:31], s58 offen lds
    v_mfma_f32_32x32x16_bf16 v[152:167], v[90:93], v[50:53], v[152:167]
    s_add_u32 s41, s66, s82
    s_add_u32 m0, s41, 24576
    s_nop 0
    buffer_load_dwordx4 v8, s[32:35], s59 offen lds
    s_add_u32 s55, s55, 128
    s_add_u32 s56, s56, s60
    s_add_u32 s57, s57, s61
    s_add_u32 s58, s58, s62
    s_add_u32 s59, s59, s63
    s_add_u32 s67, s67, 1
    s_cmp_eq_u32 s67, 10
    s_cselect_b32 s67, 0, s67
    s_cselect_b32 s55, 0, s55
    s_cselect_b32 s56, 0, s56
    s_cselect_b32 s57, 0, s57
    s_cselect_b32 s58, 0, s58
    s_cselect_b32 s59, 0, s59
    s_waitcnt lgkmcnt(6)
    v_mfma_f32_32x32x16_bf16 v[104:119], v[54:57], v[30:33], v[104:119]
    v_xad_u32 v20, v9, 48, s53
    ds_read_b128 v[46:49], v20
    v_xad_u32 v21, v10, 48, s53
    ds_read_b128 v[50:53], v21
    v_mfma_f32_32x32x16_bf16 v[120:135], v[54:57], v[34:37], v[120:135]
    ds_read_b64_tr_b16 v[86:87], v15 offset:6144
    ds_read_b64_tr_b16 v[88:89], v15 offset:6656
    ds_read_b64_tr_b16 v[90:91], v16 offset:6144
    ds_read_b64_tr_b16 v[92:93], v16 offset:6656
    v_mfma_f32_32x32x16_bf16 v[136:151], v[58:61], v[30:33], v[136:151]
    s_cmp_lg_u32 s93, 1
    s_cbranch_scc1 K1B_zs_32e
    s_add_u32 s36, s68, 18874368
    s_addc_u32 s37, s69, 0
    s_and_b32 s37, s37, 0xffff
    s_mov_b32 s38, 107520
    s_mov_b32 s39, 0x00020000
    s_lshl_b32 s40, s85, 3
    s_add_u32 s40, s40, s48
    s_lshl_b32 s40, s40, 10
    v_lshlrev_b32 v28, 4, v1
    v_mov_b32 v24, 0
    v_mov_b32 v25, 0
    v_mov_b32 v26, 0
    v_mov_b32 v27, 0
    buffer_store_dwordx4 v[24:27], v28, s[36:39], s40 offen sc0 sc1
    s_branch K1B_zs_32x
K1B_zs_32e:
    buffer_load_dword v102, v103, s[16:19], 0 offen
K1B_zs_32x:
    v_mfma_f32_32x32x16_bf16 v[152:167], v[58:61], v[34:37], v[152:167]
    s_waitcnt lgkmcnt(0)
    s_waitcnt vmcnt(8)
    s_barrier
    s_mov_b32 s81, s53
    s_mov_b32 s82, s54
    s_add_u32 s53, s53, 16384
    s_add_u32 s54, s54, 32768
    s_cmp_eq_u32 s53, 59392
    s_cselect_b32 s53, 10240, s53
    s_cselect_b32 s54, 0, s54
    v_add_u32 v15, s54, v11
    v_add_u32 v16, s54, v12
    v_mfma_f32_32x32x16_bf16 v[104:119], v[70:73], v[38:41], v[104:119]
    v_xad_u32 v20, v9, 0, s53
    ds_read_b128 v[30:33], v20
    v_xad_u32 v21, v10, 0, s53
    ds_read_b128 v[34:37], v21
    v_mfma_f32_32x32x16_bf16 v[120:135], v[70:73], v[42:45], v[120:135]
    ds_read_b64_tr_b16 v[54:55], v15 offset:0
    ds_read_b64_tr_b16 v[56:57], v15 offset:512
    ds_read_b64_tr_b16 v[58:59], v16 offset:0
    ds_read_b64_tr_b16 v[60:61], v16 offset:512
    v_mfma_f32_32x32x16_bf16 v[136:151], v[74:77], v[38:41], v[136:151]
    s_add_u32 m0, s65, s81
    s_add_u32 s40, s55, 81920
    buffer_load_dwordx4 v4, s[16:19], s55 offen lds
    v_mfma_f32_32x32x16_bf16 v[152:167], v[74:77], v[42:45], v[152:167]
    s_add_u32 m0, s65, s81
    s_add_u32 m0, m0, 8192
    s_add_u32 s40, s55, 81920
    buffer_load_dwordx4 v4, s[16:19], s40 offen lds
    s_waitcnt lgkmcnt(6)
    v_mfma_f32_32x32x16_bf16 v[104:119], v[86:89], v[46:49], v[104:119]
    v_xad_u32 v20, v9, 16, s53
    ds_read_b128 v[38:41], v20
    v_xad_u32 v21, v10, 16, s53
    ds_read_b128 v[42:45], v21
    v_mfma_f32_32x32x16_bf16 v[120:135], v[86:89], v[50:53], v[120:135]
    ds_read_b64_tr_b16 v[70:71], v15 offset:2048
    ds_read_b64_tr_b16 v[72:73], v15 offset:2560
    ds_read_b64_tr_b16 v[74:75], v16 offset:2048
    ds_read_b64_tr_b16 v[76:77], v16 offset:2560
    v_mfma_f32_32x32x16_bf16 v[136:151], v[90:93], v[46:49], v[136:151]
    s_add_u32 s41, s66, s82
    s_add_u32 m0, s41, 0
    s_nop 0
    buffer_load_dwordx4 v5, s[20:23], s56 offen lds
    v_mfma_f32_32x32x16_bf16 v[152:167], v[90:93], v[50:53], v[152:167]
    s_add_u32 s41, s66, s82
    s_add_u32 m0, s41, 8192
    s_nop 0
    buffer_load_dwordx4 v6, s[24:27], s57 offen lds
    s_waitcnt lgkmcnt(6)
    v_mfma_f32_32x32x16_bf16 v[104:119], v[54:57], v[30:33], v[104:119]
    v_xad_u32 v20, v9, 32, s53
    ds_read_b128 v[46:49], v20
    v_xad_u32 v21, v10, 32, s53
    ds_read_b128 v[50:53], v21
    v_mfma_f32_32x32x16_bf16 v[120:135], v[54:57], v[34:37], v[120:135]
    ds_read_b64_tr_b16 v[86:87], v15 offset:4096
    ds_read_b64_tr_b16 v[88:89], v15 offset:4608
    ds_read_b64_tr_b16 v[90:91], v16 offset:4096
    ds_read_b64_tr_b16 v[92:93], v16 offset:4608
    v_mfma_f32_32x32x16_bf16 v[136:151], v[58:61], v[30:33], v[136:151]
    s_add_u32 s41, s66, s82
    s_add_u32 m0, s41, 16384
    s_nop 0
    buffer_load_dwordx4 v7, s[28:31], s58 offen lds
    v_mfma_f32_32x32x16_bf16 v[152:167], v[58:61], v[34:37], v[152:167]
    s_add_u32 s41, s66, s82
    s_add_u32 m0, s41, 24576
    s_nop 0
    buffer_load_dwordx4 v8, s[32:35], s59 offen lds
    s_add_u32 s55, s55, 128
    s_add_u32 s56, s56, s60
    s_add_u32 s57, s57, s61
    s_add_u32 s58, s58, s62
    s_add_u32 s59, s59, s63
    s_add_u32 s67, s67, 1
    s_cmp_eq_u32 s67, 10
    s_cselect_b32 s67, 0, s67
    s_cselect_b32 s55, 0, s55
    s_cselect_b32 s56, 0, s56
    s_cselect_b32 s57, 0, s57
    s_cselect_b32 s58, 0, s58
    s_cselect_b32 s59, 0, s59
    s_waitcnt lgkmcnt(6)
    v_mfma_f32_32x32x16_bf16 v[104:119], v[70:73], v[38:41], v[104:119]
    v_xad_u32 v20, v9, 48, s53
    ds_read_b128 v[30:33], v20
    v_xad_u32 v21, v10, 48, s53
    ds_read_b128 v[34:37], v21
    v_mfma_f32_32x32x16_bf16 v[120:135], v[70:73], v[42:45], v[120:135]
    ds_read_b64_tr_b16 v[54:55], v15 offset:6144
    ds_read_b64_tr_b16 v[56:57], v15 offset:6656
    ds_read_b64_tr_b16 v[58:59], v16 offset:6144
    ds_read_b64_tr_b16 v[60:61], v16 offset:6656
    v_mfma_f32_32x32x16_bf16 v[136:151], v[74:77], v[38:41], v[136:151]
    buffer_load_dword v102, v103, s[16:19], 0 offen
    v_mfma_f32_32x32x16_bf16 v[152:167], v[74:77], v[42:45], v[152:167]
    s_waitcnt lgkmcnt(0)
    s_waitcnt vmcnt(8)
    s_barrier
    v_readfirstlane_b32 s40, v243
    s_cmp_lg_u32 s40, 0
    s_cbranch_scc1 K1B_nc_33ok
    s_mov_b32 s42, 0
K1B_nc_33:
    s_sleep 4
    global_load_dword v243, v103, s[70:71] sc1
    s_waitcnt vmcnt(0)
    v_readfirstlane_b32 s40, v243
    s_add_u32 s42, s42, 1
    s_cmp_gt_u32 s42, 4000
    s_cbranch_scc1 K1B_nc_33ok
    s_cmp_eq_u32 s40, 0
    s_cbranch_scc1 K1B_nc_33
K1B_nc_33ok:
    s_mov_b32 s100, s40
    s_mov_b32 s81, s53
    s_mov_b32 s82, s54
    s_add_u32 s53, s53, 16384
    s_add_u32 s54, s54, 32768
    s_cmp_eq_u32 s53, 59392
    s_cselect_b32 s53, 10240, s53
    s_cselect_b32 s54, 0, s54
    v_add_u32 v15, s54, v11
    v_add_u32 v16, s54, v12
    v_mfma_f32_32x32x16_bf16 v[104:119], v[86:89], v[46:49], v[104:119]
    v_xad_u32 v20, v9, 0, s53
    ds_read_b128 v[38:41], v20
    v_xad_u32 v21, v10, 0, s53
    ds_read_b128 v[42:45], v21
    v_mfma_f32_32x32x16_bf16 v[120:135], v[86:89], v[50:53], v[120:135]
    ds_read_b64_tr_b16 v[70:71], v15 offset:0
    ds_read_b64_tr_b16 v[72:73], v15 offset:512
    ds_read_b64_tr_b16 v[74:75], v16 offset:0
    ds_read_b64_tr_b16 v[76:77], v16 offset:512
    v_mfma_f32_32x32x16_bf16 v[136:151], v[90:93], v[46:49], v[136:151]
    s_add_u32 m0, s65, s81
    s_add_u32 s40, s55, 81920
    buffer_load_dwordx4 v4, s[16:19], s55 offen lds
    v_mfma_f32_32x32x16_bf16 v[152:167], v[90:93], v[50:53], v[152:167]
    s_add_u32 m0, s65, s81
    s_add_u32 m0, m0, 8192
    s_add_u32 s40, s55, 81920
    buffer_load_dwordx4 v4, s[16:19], s40 offen lds
    s_waitcnt lgkmcnt(6)
    v_mfma_f32_32x32x16_bf16 v[104:119], v[54:57], v[30:33], v[104:119]
    v_xad_u32 v20, v9, 16, s53
    ds_read_b128 v[46:49], v20
    v_xad_u32 v21, v10, 16, s53
    ds_read_b128 v[50:53], v21
    v_mfma_f32_32x32x16_bf16 v[120:135], v[54:57], v[34:37], v[120:135]
    ds_read_b64_tr_b16 v[86:87], v15 offset:2048
    ds_read_b64_tr_b16 v[88:89], v15 offset:2560
    ds_read_b64_tr_b16 v[90:91], v16 offset:2048
    ds_read_b64_tr_b16 v[92:93], v16 offset:2560
    v_mfma_f32_32x32x16_bf16 v[136:151], v[58:61], v[30:33], v[136:151]
    s_add_u32 s41, s66, s82
    s_add_u32 m0, s41, 0
    s_nop 0
    buffer_load_dwordx4 v5, s[20:23], s56 offen lds
    v_mfma_f32_32x32x16_bf16 v[152:167], v[58:61], v[34:37], v[152:167]
    s_add_u32 s41, s66, s82
    s_add_u32 m0, s41, 8192
    s_nop 0
    buffer_load_dwordx4 v6, s[24:27], s57 offen lds
    s_waitcnt lgkmcnt(6)
    v_mfma_f32_32x32x16_bf16 v[104:119], v[70:73], v[38:41], v[104:119]
    v_xad_u32 v20, v9, 32, s53
    ds_read_b128 v[30:33], v20
    v_xad_u32 v21, v10, 32, s53
    ds_read_b128 v[34:37], v21
    v_mfma_f32_32x32x16_bf16 v[120:135], v[70:73], v[42:45], v[120:135]
    ds_read_b64_tr_b16 v[54:55], v15 offset:4096
    ds_read_b64_tr_b16 v[56:57], v15 offset:4608
    ds_read_b64_tr_b16 v[58:59], v16 offset:4096
    ds_read_b64_tr_b16 v[60:61], v16 offset:4608
    v_mfma_f32_32x32x16_bf16 v[136:151], v[74:77], v[38:41], v[136:151]
    s_add_u32 s41, s66, s82
    s_add_u32 m0, s41, 16384
    s_nop 0
    buffer_load_dwordx4 v7, s[28:31], s58 offen lds
    v_mfma_f32_32x32x16_bf16 v[152:167], v[74:77], v[42:45], v[152:167]
    s_add_u32 s41, s66, s82
    s_add_u32 m0, s41, 24576
    s_nop 0
    buffer_load_dwordx4 v8, s[32:35], s59 offen lds
    s_add_u32 s55, s55, 128
    s_add_u32 s56, s56, s60
    s_add_u32 s57, s57, s61
    s_add_u32 s58, s58, s62
    s_add_u32 s59, s59, s63
    s_add_u32 s67, s67, 1
    s_cmp_eq_u32 s67, 10
    s_cselect_b32 s67, 0, s67
    s_cselect_b32 s55, 0, s55
    s_cselect_b32 s56, 0, s56
    s_cselect_b32 s57, 0, s57
    s_cselect_b32 s58, 0, s58
    s_cselect_b32 s59, 0, s59
    s_waitcnt lgkmcnt(6)
    v_mfma_f32_32x32x16_bf16 v[104:119], v[86:89], v[46:49], v[104:119]
    v_xad_u32 v20, v9, 48, s53
    ds_read_b128 v[38:41], v20
    v_xad_u32 v21, v10, 48, s53
    ds_read_b128 v[42:45], v21
    v_mfma_f32_32x32x16_bf16 v[120:135], v[86:89], v[50:53], v[120:135]
    ds_read_b64_tr_b16 v[70:71], v15 offset:6144
    ds_read_b64_tr_b16 v[72:73], v15 offset:6656
    ds_read_b64_tr_b16 v[74:75], v16 offset:6144
    ds_read_b64_tr_b16 v[76:77], v16 offset:6656
    v_mfma_f32_32x32x16_bf16 v[136:151], v[90:93], v[46:49], v[136:151]
    v_mov_b32 v242, v243
    v_mov_b32 v28, s92
    s_mov_b64 s[46:47], exec
    s_mov_b32 exec_lo, 0
    s_mov_b32 exec_hi, 0x80000000
    global_store_dwordx4 v28, v[240:243], s[68:69] sc0 sc1
    s_mov_b64 exec, s[46:47]
    v_mfma_f32_32x32x16_bf16 v[152:167], v[90:93], v[50:53], v[152:167]
    s_waitcnt lgkmcnt(0)
    s_waitcnt vmcnt(8)
    s_barrier
    s_mov_b32 s81, s53
    s_mov_b32 s82, s54
    s_add_u32 s53, s53, 16384
    s_add_u32 s54, s54, 32768
    s_cmp_eq_u32 s53, 59392
    s_cselect_b32 s53, 10240, s53
    s_cselect_b32 s54, 0, s54
    v_add_u32 v15, s54, v11
    v_add_u32 v16, s54, v12
    v_mfma_f32_32x32x16_bf16 v[104:119], v[54:57], v[30:33], v[104:119]
    v_xad_u32 v20, v9, 0, s53
    ds_read_b128 v[46:49], v20
    v_xad_u32 v21, v10, 0, s53
    ds_read_b128 v[50:53], v21
    v_mfma_f32_32x32x16_bf16 v[120:135], v[54:57], v[34:37], v[120:135]
    ds_read_b64_tr_b16 v[86:87], v15 offset:0
    ds_read_b64_tr_b16 v[88:89], v15 offset:512
    ds_read_b64_tr_b16 v[90:91], v16 offset:0
    ds_read_b64_tr_b16 v[92:93], v16 offset:512
    v_mfma_f32_32x32x16_bf16 v[136:151], v[58:61], v[30:33], v[136:151]
    s_add_u32 m0, s65, s81
    s_add_u32 s40, s55, 81920
    buffer_load_dwordx4 v4, s[16:19], s55 offen lds
    v_mfma_f32_32x32x16_bf16 v[152:167], v[58:61], v[34:37], v[152:167]
    s_add_u32 m0, s65, s81
    s_add_u32 m0, m0, 8192
    s_add_u32 s40, s55, 81920
    buffer_load_dwordx4 v4, s[16:19], s40 offen lds
    s_waitcnt lgkmcnt(6)
    v_mfma_f32_32x32x16_bf16 v[104:119], v[70:73], v[38:41], v[104:119]
    v_xad_u32 v20, v9, 16, s53
    ds_read_b128 v[30:33], v20
    v_xad_u32 v21, v10, 16, s53
    ds_read_b128 v[34:37], v21
    v_mfma_f32_32x32x16_bf16 v[120:135], v[70:73], v[42:45], v[120:135]
    ds_read_b64_tr_b16 v[54:55], v15 offset:2048
    ds_read_b64_tr_b16 v[56:57], v15 offset:2560
    ds_read_b64_tr_b16 v[58:59], v16 offset:2048
    ds_read_b64_tr_b16 v[60:61], v16 offset:2560
    v_mfma_f32_32x32x16_bf16 v[136:151], v[74:77], v[38:41], v[136:151]
    s_add_u32 s41, s66, s82
    s_add_u32 m0, s41, 0
    s_nop 0
    buffer_load_dwordx4 v5, s[20:23], s56 offen lds
    v_mfma_f32_32x32x16_bf16 v[152:167], v[74:77], v[42:45], v[152:167]
    s_add_u32 s41, s66, s82
    s_add_u32 m0, s41, 8192
    s_nop 0
    buffer_load_dwordx4 v6, s[24:27], s57 offen lds
    s_waitcnt lgkmcnt(6)
    v_mfma_f32_32x32x16_bf16 v[104:119], v[86:89], v[46:49], v[104:119]
    v_xad_u32 v20, v9, 32, s53
    ds_read_b128 v[38:41], v20
    v_xad_u32 v21, v10, 32, s53
    ds_read_b128 v[42:45], v21
    v_mfma_f32_32x32x16_bf16 v[120:135], v[86:89], v[50:53], v[120:135]
    ds_read_b64_tr_b16 v[70:71], v15 offset:4096
    ds_read_b64_tr_b16 v[72:73], v15 offset:4608
    ds_read_b64_tr_b16 v[74:75], v16 offset:4096
    ds_read_b64_tr_b16 v[76:77], v16 offset:4608
    v_mfma_f32_32x32x16_bf16 v[136:151], v[90:93], v[46:49], v[136:151]
    s_add_u32 s41, s66, s82
    s_add_u32 m0, s41, 16384
    s_nop 0
    buffer_load_dwordx4 v7, s[28:31], s58 offen lds
    v_mfma_f32_32x32x16_bf16 v[152:167], v[90:93], v[50:53], v[152:167]
    s_add_u32 s41, s66, s82
    s_add_u32 m0, s41, 24576
    s_nop 0
    buffer_load_dwordx4 v8, s[32:35], s59 offen lds
    s_add_u32 s55, s55, 128
    s_add_u32 s56, s56, s60
    s_add_u32 s57, s57, s61
    s_add_u32 s58, s58, s62
    s_add_u32 s59, s59, s63
    s_add_u32 s67, s67, 1
    s_cmp_eq_u32 s67, 10
    s_cselect_b32 s67, 0, s67
    s_cselect_b32 s55, 0, s55
    s_cselect_b32 s56, 0, s56
    s_cselect_b32 s57, 0, s57
    s_cselect_b32 s58, 0, s58
    s_cselect_b32 s59, 0, s59
    s_waitcnt lgkmcnt(6)
    v_mfma_f32_32x32x16_bf16 v[104:119], v[54:57], v[30:33], v[104:119]
    v_xad_u32 v20, v9, 48, s53
    ds_read_b128 v[46:49], v20
    v_xad_u32 v21, v10, 48, s53
    ds_read_b128 v[50:53], v21
    v_mfma_f32_32x32x16_bf16 v[120:135], v[54:57], v[34:37], v[120:135]
    ds_read_b64_tr_b16 v[86:87], v15 offset:6144
    ds_read_b64_tr_b16 v[88:89], v15 offset:6656
    ds_read_b64_tr_b16 v[90:91], v16 offset:6144
    ds_read_b64_tr_b16 v[92:93], v16 offset:6656
    v_mfma_f32_32x32x16_bf16 v[136:151], v[58:61], v[30:33], v[136:151]
    s_cmp_lg_u32 s89, 1
    s_cbranch_scc1 K1B_c2_34e
    v_lshlrev_b32 v28, 2, v0
    ds_read_b32 v168, v28 offset:6144
    ds_read_b32 v169, v28 offset:7168
    s_mul_i32 s40, s86, 20480
    s_lshl_b32 s41, s49, 11
    s_add_u32 s40, s40, s41
    s_add_u32 s40, s40, 19202048
    v_lshl_add_u32 v28, v0, 3, s40
    s_waitcnt lgkmcnt(0)
    v_add_f32 v168, v168, v169
    v_mov_b32 v169, v243
    global_store_dwordx2 v28, v[168:169], s[68:69] sc0 sc1
    s_branch K1B_c2_34x
K1B_c2_34e:
    buffer_load_dword v102, v103, s[16:19], 0 offen
K1B_c2_34x:
    v_mfma_f32_32x32x16_bf16 v[152:167], v[58:61], v[34:37], v[152:167]
    s_waitcnt lgkmcnt(0)
    s_waitcnt vmcnt(8)
    s_barrier
    s_mov_b32 s81, s53
    s_mov_b32 s82, s54
    s_add_u32 s53, s53, 16384
    s_add_u32 s54, s54, 32768
    s_cmp_eq_u32 s53, 59392
    s_cselect_b32 s53, 10240, s53
    s_cselect_b32 s54, 0, s54
    v_add_u32 v15, s54, v11
    v_add_u32 v16, s54, v12
    v_mfma_f32_32x32x16_bf16 v[104:119], v[70:73], v[38:41], v[104:119]
    v_xad_u32 v20, v9, 0, s53
    ds_read_b128 v[30:33], v20
    v_xad_u32 v21, v10, 0, s53
    ds_read_b128 v[34:37], v21
    v_mfma_f32_32x32x16_bf16 v[120:135], v[70:73], v[42:45], v[120:135]
    ds_read_b64_tr_b16 v[54:55], v15 offset:0
    ds_read_b64_tr_b16 v[56:57], v15 offset:512
    ds_read_b64_tr_b16 v[58:59], v16 offset:0
    ds_read_b64_tr_b16 v[60:61], v16 offset:512
    v_mfma_f32_32x32x16_bf16 v[136:151], v[74:77], v[38:41], v[136:151]
    s_add_u32 m0, s65, s81
    s_add_u32 s40, s55, 81920
    buffer_load_dwordx4 v4, s[16:19], s55 offen lds
    v_mfma_f32_32x32x16_bf16 v[152:167], v[74:77], v[42:45], v[152:167]
    s_add_u32 m0, s65, s81
    s_add_u32 m0, m0, 8192
    s_add_u32 s40, s55, 81920
    buffer_load_dwordx4 v4, s[16:19], s40 offen lds
    s_waitcnt lgkmcnt(6)
    v_mfma_f32_32x32x16_bf16 v[104:119], v[86:89], v[46:49], v[104:119]
    v_xad_u32 v20, v9, 16, s53
    ds_read_b128 v[38:41], v20
    v_xad_u32 v21, v10, 16, s53
    ds_read_b128 v[42:45], v21
    v_mfma_f32_32x32x16_bf16 v[120:135], v[86:89], v[50:53], v[120:135]
    ds_read_b64_tr_b16 v[70:71], v15 offset:2048
    ds_read_b64_tr_b16 v[72:73], v15 offset:2560
    ds_read_b64_tr_b16 v[74:75], v16 offset:2048
    ds_read_b64_tr_b16 v[76:77], v16 offset:2560
    v_mfma_f32_32x32x16_bf16 v[136:151], v[90:93], v[46:49], v[136:151]
    s_add_u32 s41, s66, s82
    s_add_u32 m0, s41, 0
    s_nop 0
    buffer_load_dwordx4 v5, s[20:23], s56 offen lds
    v_mfma_f32_32x32x16_bf16 v[152:167], v[90:93], v[50:53], v[152:167]
    s_add_u32 s41, s66, s82
    s_add_u32 m0, s41, 8192
    s_nop 0
    buffer_load_dwordx4 v6, s[24:27], s57 offen lds
    s_waitcnt lgkmcnt(6)
    v_mfma_f32_32x32x16_bf16 v[104:119], v[54:57], v[30:33], v[104:119]
    v_xad_u32 v20, v9, 32, s53
    ds_read_b128 v[46:49], v20
    v_xad_u32 v21, v10, 32, s53
    ds_read_b128 v[50:53], v21
    v_mfma_f32_32x32x16_bf16 v[120:135], v[54:57], v[34:37], v[120:135]
    ds_read_b64_tr_b16 v[86:87], v15 offset:4096
    ds_read_b64_tr_b16 v[88:89], v15 offset:4608
    ds_read_b64_tr_b16 v[90:91], v16 offset:4096
    ds_read_b64_tr_b16 v[92:93], v16 offset:4608
    v_mfma_f32_32x32x16_bf16 v[136:151], v[58:61], v[30:33], v[136:151]
    s_add_u32 s41, s66, s82
    s_add_u32 m0, s41, 16384
    s_nop 0
    buffer_load_dwordx4 v7, s[28:31], s58 offen lds
    v_mfma_f32_32x32x16_bf16 v[152:167], v[58:61], v[34:37], v[152:167]
    s_add_u32 s41, s66, s82
    s_add_u32 m0, s41, 24576
    s_nop 0
    buffer_load_dwordx4 v8, s[32:35], s59 offen lds
    s_add_u32 s55, s55, 128
    s_add_u32 s56, s56, s60
    s_add_u32 s57, s57, s61
    s_add_u32 s58, s58, s62
    s_add_u32 s59, s59, s63
    s_add_u32 s67, s67, 1
    s_cmp_eq_u32 s67, 10
    s_cselect_b32 s67, 0, s67
    s_cselect_b32 s55, 0, s55
    s_cselect_b32 s56, 0, s56
    s_cselect_b32 s57, 0, s57
    s_cselect_b32 s58, 0, s58
    s_cselect_b32 s59, 0, s59
    s_waitcnt lgkmcnt(6)
    v_mfma_f32_32x32x16_bf16 v[104:119], v[70:73], v[38:41], v[104:119]
    v_xad_u32 v20, v9, 48, s53
    ds_read_b128 v[30:33], v20
    v_xad_u32 v21, v10, 48, s53
    ds_read_b128 v[34:37], v21
    v_mfma_f32_32x32x16_bf16 v[120:135], v[70:73], v[42:45], v[120:135]
    ds_read_b64_tr_b16 v[54:55], v15 offset:6144
    ds_read_b64_tr_b16 v[56:57], v15 offset:6656
    ds_read_b64_tr_b16 v[58:59], v16 offset:6144
    ds_read_b64_tr_b16 v[60:61], v16 offset:6656
    v_mfma_f32_32x32x16_bf16 v[136:151], v[74:77], v[38:41], v[136:151]
    s_cmp_lg_u32 s91, 1
    s_cbranch_scc1 K1B_zf_35e
    s_mov_b32 s44, 128
    v_mov_b32 v28, s44
    v_mov_b32 v29, 1
    s_mov_b64 s[46:47], exec
    s_mov_b64 exec, 1
    global_atomic_add v28, v29, s[70:71] sc1
    s_mov_b64 exec, s[46:47]
    s_branch K1B_zf_35x
K1B_zf_35e:
    buffer_load_dword v102, v103, s[16:19], 0 offen
K1B_zf_35x:
    v_mfma_f32_32x32x16_bf16 v[152:167], v[74:77], v[42:45], v[152:167]
    s_waitcnt lgkmcnt(0)
    s_waitcnt vmcnt(8)
    s_barrier
    s_mov_b32 s81, s53
    s_mov_b32 s82, s54
    s_add_u32 s53, s53, 16384
    s_add_u32 s54, s54, 32768
    s_cmp_eq_u32 s53, 59392
    s_cselect_b32 s53, 10240, s53
    s_cselect_b32 s54, 0, s54
    v_add_u32 v15, s54, v11
    v_add_u32 v16, s54, v12
    v_mfma_f32_32x32x16_bf16 v[104:119], v[86:89], v[46:49], v[104:119]
    v_xad_u32 v20, v9, 0, s53
    ds_read_b128 v[38:41], v20
    v_xad_u32 v21, v10, 0, s53
    ds_read_b128 v[42:45], v21
    v_mfma_f32_32x32x16_bf16 v[120:135], v[86:89], v[50:53], v[120:135]
    ds_read_b64_tr_b16 v[70:71], v15 offset:0
    ds_read_b64_tr_b16 v[72:73], v15 offset:512
    ds_read_b64_tr_b16 v[74:75], v16 offset:0
    ds_read_b64_tr_b16 v[76:77], v16 offset:512
    v_mfma_f32_32x32x16_bf16 v[136:151], v[90:93], v[46:49], v[136:151]
    s_add_u32 m0, s65, s81
    s_add_u32 s40, s55, 81920
    buffer_load_dwordx4 v4, s[16:19], s55 offen lds
    v_mfma_f32_32x32x16_bf16 v[152:167], v[90:93], v[50:53], v[152:167]
    s_add_u32 m0, s65, s81
    s_add_u32 m0, m0, 8192
    s_add_u32 s40, s55, 81920
    buffer_load_dwordx4 v4, s[16:19], s40 offen lds
    s_waitcnt lgkmcnt(6)
    v_mfma_f32_32x32x16_bf16 v[104:119], v[54:57], v[30:33], v[104:119]
    v_xad_u32 v20, v9, 16, s53
    ds_read_b128 v[46:49], v20
    v_xad_u32 v21, v10, 16, s53
    ds_read_b128 v[50:53], v21
    v_mfma_f32_32x32x16_bf16 v[120:135], v[54:57], v[34:37], v[120:135]
    ds_read_b64_tr_b16 v[86:87], v15 offset:2048
    ds_read_b64_tr_b16 v[88:89], v15 offset:2560
    ds_read_b64_tr_b16 v[90:91], v16 offset:2048
    ds_read_b64_tr_b16 v[92:93], v16 offset:2560
    v_mfma_f32_32x32x16_bf16 v[136:151], v[58:61], v[30:33], v[136:151]
    s_add_u32 s41, s66, s82
    s_add_u32 m0, s41, 0
    s_nop 0
    buffer_load_dwordx4 v5, s[20:23], s56 offen lds
    v_mfma_f32_32x32x16_bf16 v[152:167], v[58:61], v[34:37], v[152:167]
    s_add_u32 s41, s66, s82
    s_add_u32 m0, s41, 8192
    s_nop 0
    buffer_load_dwordx4 v6, s[24:27], s57 offen lds
    s_waitcnt lgkmcnt(6)
    v_mfma_f32_32x32x16_bf16 v[104:119], v[70:73], v[38:41], v[104:119]
    v_xad_u32 v20, v9, 32, s53
    ds_read_b128 v[30:33], v20
    v_xad_u32 v21, v10, 32, s53
    ds_read_b128 v[34:37], v21
    v_mfma_f32_32x32x16_bf16 v[120:135], v[70:73], v[42:45], v[120:135]
    ds_read_b64_tr_b16 v[54:55], v15 offset:4096
    ds_read_b64_tr_b16 v[56:57], v15 offset:4608
    ds_read_b64_tr_b16 v[58:59], v16 offset:4096
    ds_read_b64_tr_b16 v[60:61], v16 offset:4608
    v_mfma_f32_32x32x16_bf16 v[136:151], v[74:77], v[38:41], v[136:151]
    s_add_u32 s41, s66, s82
    s_add_u32 m0, s41, 16384
    s_nop 0
    buffer_load_dwordx4 v7, s[28:31], s58 offen lds
    v_mfma_f32_32x32x16_bf16 v[152:167], v[74:77], v[42:45], v[152:167]
    s_add_u32 s41, s66, s82
    s_add_u32 m0, s41, 24576
    s_nop 0
    buffer_load_dwordx4 v8, s[32:35], s59 offen lds
    s_add_u32 s55, s55, 128
    s_add_u32 s56, s56, s60
    s_add_u32 s57, s57, s61
    s_add_u32 s58, s58, s62
    s_add_u32 s59, s59, s63
    s_add_u32 s67, s67, 1
    s_cmp_eq_u32 s67, 10
    s_cselect_b32 s67, 0, s67
    s_cselect_b32 s55, 0, s55
    s_cselect_b32 s56, 0, s56
    s_cselect_b32 s57, 0, s57
    s_cselect_b32 s58, 0, s58
    s_cselect_b32 s59, 0, s59
    s_waitcnt lgkmcnt(6)
    v_mfma_f32_32x32x16_bf16 v[104:119], v[86:89], v[46:49], v[104:119]
    v_xad_u32 v20, v9, 48, s53
    ds_read_b128 v[38:41], v20
    v_xad_u32 v21, v10, 48, s53
    ds_read_b128 v[42:45], v21
    v_mfma_f32_32x32x16_bf16 v[120:135], v[86:89], v[50:53], v[120:135]
    ds_read_b64_tr_b16 v[70:71], v15 offset:6144
    ds_read_b64_tr_b16 v[72:73], v15 offset:6656
    ds_read_b64_tr_b16 v[74:75], v16 offset:6144
    ds_read_b64_tr_b16 v[76:77], v16 offset:6656
    v_mfma_f32_32x32x16_bf16 v[136:151], v[90:93], v[46:49], v[136:151]
    buffer_load_dword v102, v103, s[16:19], 0 offen
    v_mfma_f32_32x32x16_bf16 v[152:167], v[90:93], v[50:53], v[152:167]
    s_waitcnt lgkmcnt(0)
    s_waitcnt vmcnt(8)
    s_barrier
    s_mov_b32 s81, s53
    s_mov_b32 s82, s54
    s_add_u32 s53, s53, 16384
    s_add_u32 s54, s54, 32768
    s_cmp_eq_u32 s53, 59392
    s_cselect_b32 s53, 10240, s53
    s_cselect_b32 s54, 0, s54
    v_add_u32 v15, s54, v11
    v_add_u32 v16, s54, v12
    v_mfma_f32_32x32x16_bf16 v[104:119], v[54:57], v[30:33], v[104:119]
    v_xad_u32 v20, v9, 0, s53
    ds_read_b128 v[46:49], v20
    v_xad_u32 v21, v10, 0, s53
    ds_read_b128 v[50:53], v21
    v_mfma_f32_32x32x16_bf16 v[120:135], v[54:57], v[34:37], v[120:135]
    ds_read_b64_tr_b16 v[86:87], v15 offset:0
    ds_read_b64_tr_b16 v[88:89], v15 offset:512
    ds_read_b64_tr_b16 v[90:91], v16 offset:0
    ds_read_b64_tr_b16 v[92:93], v16 offset:512
    v_mfma_f32_32x32x16_bf16 v[136:151], v[58:61], v[30:33], v[136:151]
    s_cmp_lt_u32 s85, 54
    s_cselect_b32 s36, s76, s78
    s_cselect_b32 s37, s77, s79
    s_mov_b32 s38, 819200
    s_cselect_b32 s38, 2211840, s38
    s_mov_b32 s39, 0x00020000
    s_cselect_b64 s[46:47], -1, 0
    s_and_b32 s37, s37, 0xffff
    s_cmp_ge_u32 s85, 74
    s_cselect_b32 s38, 0, s38
    s_mul_i32 s45, s48, 5120
    s_add_u32 s44, s82, 59392
    s_add_u32 s44, s44, s45
    s_sub_u32 s45, s45, 30720
    s_add_u32 s45, s45, s81
    s_cmp_lt_u32 s48, 6
    s_cselect_b32 s87, s44, s45
    s_mul_i32 s44, s48, 160
    s_lshl_b32 s40, s85, 2
    v_add_u32 v168, 0, v1
    v_mul_u32_u24 v169, 6554, v168
    v_lshrrev_b32 v169, 16, v169
    v_mul_u32_u24 v170, 10, v169
    v_sub_u32 v170, v168, v170
    v_bfe_u32 v171, v169, 2, 2
    v_and_b32 v172, 3, v169
    v_lshrrev_b32 v175, 4, v169
    v_lshl_add_u32 v172, v175, 2, v172
    v_add_u32 v176, s40, v171
    v_lshl_add_u32 v177, v176, 3, v172
    v_subrev_u32 v178, 216, v176
    v_mul_u32_u24 v179, 13108, v178
    v_lshrrev_b32 v179, 16, v179
    v_mul_u32_u24 v180, 5, v179
    v_sub_u32 v180, v178, v180
    v_and_b32 v181, 1, v180
    v_lshlrev_b32 v181, 3, v181
    v_bfe_u32 v182, v180, 1, 1
    v_mad_u32_u24 v181, v182, 20, v181
    v_lshlrev_b32 v182, 4, v175
    v_add_u32 v182, 16, v182
    v_cmp_eq_u32 vcc, 4, v180
    s_nop 1
    v_cndmask_b32 v181, v181, v182, vcc
    v_mad_u32_u24 v181, v179, 40, v181
    v_add_u32 v181, v181, v172
    v_cndmask_b32 v177, v181, v177, s[46:47]
    v_mul_u32_u24 v177, 1280, v177
    v_lshl_add_u32 v177, v170, 4, v177
    v_add_u32 v184, s44, v177
    v_add_u32 v168, 64, v1
    v_mul_u32_u24 v169, 6554, v168
    v_lshrrev_b32 v169, 16, v169
    v_mul_u32_u24 v170, 10, v169
    v_sub_u32 v170, v168, v170
    v_bfe_u32 v171, v169, 2, 2
    v_and_b32 v172, 3, v169
    v_lshrrev_b32 v175, 4, v169
    v_lshl_add_u32 v172, v175, 2, v172
    v_add_u32 v176, s40, v171
    v_lshl_add_u32 v177, v176, 3, v172
    v_subrev_u32 v178, 216, v176
    v_mul_u32_u24 v179, 13108, v178
    v_lshrrev_b32 v179, 16, v179
    v_mul_u32_u24 v180, 5, v179
    v_sub_u32 v180, v178, v180
    v_and_b32 v181, 1, v180
    v_lshlrev_b32 v181, 3, v181
    v_bfe_u32 v182, v180, 1, 1
    v_mad_u32_u24 v181, v182, 20, v181
    v_lshlrev_b32 v182, 4, v175
    v_add_u32 v182, 16, v182
    v_cmp_eq_u32 vcc, 4, v180
    s_nop 1
    v_cndmask_b32 v181, v181, v182, vcc
    v_mad_u32_u24 v181, v179, 40, v181
    v_add_u32 v181, v181, v172
    v_cndmask_b32 v177, v181, v177, s[46:47]
    v_mul_u32_u24 v177, 1280, v177
    v_lshl_add_u32 v177, v170, 4, v177
    v_add_u32 v185, s44, v177
    v_add_u32 v168, 128, v1
    v_mul_u32_u24 v169, 6554, v168
    v_lshrrev_b32 v169, 16, v169
    v_mul_u32_u24 v170, 10, v169
    v_sub_u32 v170, v168, v170
    v_bfe_u32 v171, v169, 2, 2
    v_and_b32 v172, 3, v169
    v_lshrrev_b32 v175, 4, v169
    v_lshl_add_u32 v172, v175, 2, v172
    v_add_u32 v176, s40, v171
    v_lshl_add_u32 v177, v176, 3, v172
    v_subrev_u32 v178, 216, v176
    v_mul_u32_u24 v179, 13108, v178
    v_lshrrev_b32 v179, 16, v179
    v_mul_u32_u24 v180, 5, v179
    v_sub_u32 v180, v178, v180
    v_and_b32 v181, 1, v180
    v_lshlrev_b32 v181, 3, v181
    v_bfe_u32 v182, v180, 1, 1
    v_mad_u32_u24 v181, v182, 20, v181
    v_lshlrev_b32 v182, 4, v175
    v_add_u32 v182, 16, v182
    v_cmp_eq_u32 vcc, 4, v180
    s_nop 1
    v_cndmask_b32 v181, v181, v182, vcc
    v_mad_u32_u24 v181, v179, 40, v181
    v_add_u32 v181, v181, v172
    v_cndmask_b32 v177, v181, v177, s[46:47]
    v_mul_u32_u24 v177, 1280, v177
    v_lshl_add_u32 v177, v170, 4, v177
    v_add_u32 v186, s44, v177
    v_add_u32 v168, 192, v1
    v_mul_u32_u24 v169, 6554, v168
    v_lshrrev_b32 v169, 16, v169
    v_mul_u32_u24 v170, 10, v169
    v_sub_u32 v170, v168, v170
    v_bfe_u32 v171, v169, 2, 2
    v_and_b32 v172, 3, v169
    v_lshrrev_b32 v175, 4, v169
    v_lshl_add_u32 v172, v175, 2, v172
    v_add_u32 v176, s40, v171
    v_lshl_add_u32 v177, v176, 3, v172
    v_subrev_u32 v178, 216, v176
    v_mul_u32_u24 v179, 13108, v178
    v_lshrrev_b32 v179, 16, v179
    v_mul_u32_u24 v180, 5, v179
    v_sub_u32 v180, v178, v180
    v_and_b32 v181, 1, v180
    v_lshlrev_b32 v181, 3, v181
    v_bfe_u32 v182, v180, 1, 1
    v_mad_u32_u24 v181, v182, 20, v181
    v_lshlrev_b32 v182, 4, v175
    v_add_u32 v182, 16, v182
    v_cmp_eq_u32 vcc, 4, v180
    s_nop 1
    v_cndmask_b32 v181, v181, v182, vcc
    v_mad_u32_u24 v181, v179, 40, v181
    v_add_u32 v181, v181, v172
    v_cndmask_b32 v177, v181, v177, s[46:47]
    v_mul_u32_u24 v177, 1280, v177
    v_lshl_add_u32 v177, v170, 4, v177
    v_add_u32 v187, s44, v177
    v_add_u32 v168, 256, v1
    v_mul_u32_u24 v169, 6554, v168
    v_lshrrev_b32 v169, 16, v169
    v_mul_u32_u24 v170, 10, v169
    v_sub_u32 v170, v168, v170
    v_bfe_u32 v171, v169, 2, 2
    v_and_b32 v172, 3, v169
    v_lshrrev_b32 v175, 4, v169
    v_lshl_add_u32 v172, v175, 2, v172
    v_add_u32 v176, s40, v171
    v_lshl_add_u32 v177, v176, 3, v172
    v_subrev_u32 v178, 216, v176
    v_mul_u32_u24 v179, 13108, v178
    v_lshrrev_b32 v179, 16, v179
    v_mul_u32_u24 v180, 5, v179
    v_sub_u32 v180, v178, v180
    v_and_b32 v181, 1, v180
    v_lshlrev_b32 v181, 3, v181
    v_bfe_u32 v182, v180, 1, 1
    v_mad_u32_u24 v181, v182, 20, v181
    v_lshlrev_b32 v182, 4, v175
    v_add_u32 v182, 16, v182
    v_cmp_eq_u32 vcc, 4, v180
    s_nop 1
    v_cndmask_b32 v181, v181, v182, vcc
    v_mad_u32_u24 v181, v179, 40, v181
    v_add_u32 v181, v181, v172
    v_cndmask_b32 v177, v181, v177, s[46:47]
    v_mul_u32_u24 v177, 1280, v177
    v_lshl_add_u32 v177, v170, 4, v177
    v_add_u32 v188, s44, v177
    s_add_u32 m0, s87, 0
    s_nop 0
    buffer_load_dwordx4 v184, s[36:39], 0 offen lds
    s_add_u32 m0, s87, 1024
    s_nop 0
    buffer_load_dwordx4 v185, s[36:39], 0 offen lds
    s_add_u32 m0, s87, 2048
    s_nop 0
    buffer_load_dwordx4 v186, s[36:39], 0 offen lds
    s_add_u32 m0, s87, 3072
    s_nop 0
    buffer_load_dwordx4 v187, s[36:39], 0 offen lds
    s_add_u32 m0, s87, 4096
    s_nop 0
    buffer_load_dwordx4 v188, s[36:39], 0 offen lds
    v_mfma_f32_32x32x16_bf16 v[152:167], v[58:61], v[34:37], v[152:167]
    s_waitcnt lgkmcnt(6)
    v_mfma_f32_32x32x16_bf16 v[104:119], v[70:73], v[38:41], v[104:119]
    v_xad_u32 v20, v9, 16, s53
    ds_read_b128 v[30:33], v20
    v_xad_u32 v21, v10, 16, s53
    ds_read_b128 v[34:37], v21
    v_mfma_f32_32x32x16_bf16 v[120:135], v[70:73], v[42:45], v[120:135]
    ds_read_b64_tr_b16 v[54:55], v15 offset:2048
    ds_read_b64_tr_b16 v[56:57], v15 offset:2560
    ds_read_b64_tr_b16 v[58:59], v16 offset:2048
    ds_read_b64_tr_b16 v[60:61], v16 offset:2560
    v_mfma_f32_32x32x16_bf16 v[136:151], v[74:77], v[38:41], v[136:151]
    v_mfma_f32_32x32x16_bf16 v[152:167], v[74:77], v[42:45], v[152:167]
    s_waitcnt lgkmcnt(6)
    v_mfma_f32_32x32x16_bf16 v[104:119], v[86:89], v[46:49], v[104:119]
    v_xad_u32 v20, v9, 32, s53
    ds_read_b128 v[38:41], v20
    v_xad_u32 v21, v10, 32, s53
    ds_read_b128 v[42:45], v21
    v_mfma_f32_32x32x16_bf16 v[120:135], v[86:89], v[50:53], v[120:135]
    ds_read_b64_tr_b16 v[70:71], v15 offset:4096
    ds_read_b64_tr_b16 v[72:73], v15 offset:4608
    ds_read_b64_tr_b16 v[74:75], v16 offset:4096
    ds_read_b64_tr_b16 v[76:77], v16 offset:4608
    v_mfma_f32_32x32x16_bf16 v[136:151], v[90:93], v[46:49], v[136:151]
    v_mfma_f32_32x32x16_bf16 v[152:167], v[90:93], v[50:53], v[152:167]
    s_waitcnt lgkmcnt(6)
    v_mfma_f32_32x32x16_bf16 v[104:119], v[54:57], v[30:33], v[104:119]
    v_xad_u32 v20, v9, 48, s53
    ds_read_b128 v[46:49], v20
    v_xad_u32 v21, v10, 48, s53
    ds_read_b128 v[50:53], v21
    v_mfma_f32_32x32x16_bf16 v[120:135], v[54:57], v[34:37], v[120:135]
    ds_read_b64_tr_b16 v[86:87], v15 offset:6144
    ds_read_b64_tr_b16 v[88:89], v15 offset:6656
    ds_read_b64_tr_b16 v[90:91], v16 offset:6144
    ds_read_b64_tr_b16 v[92:93], v16 offset:6656
    v_mfma_f32_32x32x16_bf16 v[136:151], v[58:61], v[30:33], v[136:151]
    v_mfma_f32_32x32x16_bf16 v[152:167], v[58:61], v[34:37], v[152:167]
    s_waitcnt lgkmcnt(0)
    s_waitcnt vmcnt(6)
    s_barrier
    s_mov_b32 s81, s53
    s_mov_b32 s82, s54
    s_add_u32 s53, s53, 16384
    s_add_u32 s54, s54, 32768
    s_cmp_eq_u32 s53, 59392
    s_cselect_b32 s53, 10240, s53
    s_cselect_b32 s54, 0, s54
    v_add_u32 v15, s54, v11
    v_add_u32 v16, s54, v12
    v_mfma_f32_32x32x16_bf16 v[104:119], v[70:73], v[38:41], v[104:119]
    v_xad_u32 v20, v9, 0, s53
    ds_read_b128 v[30:33], v20
    v_xad_u32 v21, v10, 0, s53
    ds_read_b128 v[34:37], v21
    v_mfma_f32_32x32x16_bf16 v[120:135], v[70:73], v[42:45], v[120:135]
    ds_read_b64_tr_b16 v[54:55], v15 offset:0
    ds_read_b64_tr_b16 v[56:57], v15 offset:512
    ds_read_b64_tr_b16 v[58:59], v16 offset:0
    ds_read_b64_tr_b16 v[60:61], v16 offset:512
    v_mfma_f32_32x32x16_bf16 v[136:151], v[74:77], v[38:41], v[136:151]
    v_mfma_f32_32x32x16_bf16 v[152:167], v[74:77], v[42:45], v[152:167]
    v_lshrrev_b32 v28, 7, v9
    s_lshl_b32 s40, s49, 7
    v_add_u32 v28, s40, v28
    v_lshlrev_b32 v28, 4, v28
    v_add_u32 v28, 19136512, v28
    global_load_dwordx4 v[192:195], v28, s[68:69] sc1
    v_lshrrev_b32 v28, 7, v10
    s_lshl_b32 s40, s49, 7
    v_add_u32 v28, s40, v28
    v_lshlrev_b32 v28, 4, v28
    v_add_u32 v28, 19136512, v28
    global_load_dwordx4 v[196:199], v28, s[68:69] sc1
    s_cmp_ge_u32 s48, 4
    s_cbranch_scc1 K1_csl_36
    s_mul_i32 s40, s86, 20480
    s_add_u32 s40, s40, 19202048
    v_lshl_add_u32 v28, v0, 3, s40
    global_load_dwordx2 v[200:201], v28, s[68:69] offset:0 sc1
    global_load_dwordx2 v[202:203], v28, s[68:69] offset:2048 sc1
    v_add_u32 v28, 4096, v28
    global_load_dwordx2 v[204:205], v28, s[68:69] offset:0 sc1
    global_load_dwordx2 v[206:207], v28, s[68:69] offset:2048 sc1
    v_add_u32 v28, 4096, v28
    global_load_dwordx2 v[208:209], v28, s[68:69] offset:0 sc1
    global_load_dwordx2 v[210:211], v28, s[68:69] offset:2048 sc1
    v_add_u32 v28, 4096, v28
    global_load_dwordx2 v[212:213], v28, s[68:69] offset:0 sc1
    global_load_dwordx2 v[214:215], v28, s[68:69] offset:2048 sc1
    v_add_u32 v28, 4096, v28
    global_load_dwordx2 v[216:217], v28, s[68:69] offset:0 sc1
    global_load_dwordx2 v[218:219], v28, s[68:69] offset:2048 sc1
K1_csl_36:
    s_sub_u32 s40, s83, 2
    s_max_i32 s40, s40, 0
    s_min_u32 s40, s40, 26
    s_lshl_b32 s41, s40, 7
    s_add_u32 s36, s74, s41
    s_addc_u32 s37, s75, 0
    s_and_b32 s37, s37, 0xffff
    s_mov_b32 s38, 128
    s_mov_b32 s39, 0x00020000
    v_lshlrev_b32 v28, 4, v3
    buffer_load_dwordx4 v[220:223], v28, s[36:39], 0 offen offset:0
    buffer_load_dwordx4 v[224:227], v28, s[36:39], 0 offen offset:32
    buffer_load_dwordx4 v[228:231], v28, s[36:39], 0 offen offset:64
    buffer_load_dwordx4 v[232:235], v28, s[36:39], 0 offen offset:96
    s_waitcnt lgkmcnt(6)
    v_mfma_f32_32x32x16_bf16 v[104:119], v[86:89], v[46:49], v[104:119]
    v_xad_u32 v20, v9, 16, s53
    ds_read_b128 v[38:41], v20
    v_xad_u32 v21, v10, 16, s53
    ds_read_b128 v[42:45], v21
    v_mfma_f32_32x32x16_bf16 v[120:135], v[86:89], v[50:53], v[120:135]
    ds_read_b64_tr_b16 v[70:71], v15 offset:2048
    ds_read_b64_tr_b16 v[72:73], v15 offset:2560
    ds_read_b64_tr_b16 v[74:75], v16 offset:2048
    ds_read_b64_tr_b16 v[76:77], v16 offset:2560
    v_mfma_f32_32x32x16_bf16 v[136:151], v[90:93], v[46:49], v[136:151]
    v_mfma_f32_32x32x16_bf16 v[152:167], v[90:93], v[50:53], v[152:167]
    s_waitcnt lgkmcnt(6)
    v_mfma_f32_32x32x16_bf16 v[104:119], v[54:57], v[30:33], v[104:119]
    v_xad_u32 v20, v9, 32, s53
    ds_read_b128 v[46:49], v20
    v_xad_u32 v21, v10, 32, s53
    ds_read_b128 v[50:53], v21
    v_mfma_f32_32x32x16_bf16 v[120:135], v[54:57], v[34:37], v[120:135]
    ds_read_b64_tr_b16 v[86:87], v15 offset:4096
    ds_read_b64_tr_b16 v[88:89], v15 offset:4608
    ds_read_b64_tr_b16 v[90:91], v16 offset:4096
    ds_read_b64_tr_b16 v[92:93], v16 offset:4608
    v_mfma_f32_32x32x16_bf16 v[136:151], v[58:61], v[30:33], v[136:151]
    v_mfma_f32_32x32x16_bf16 v[152:167], v[58:61], v[34:37], v[152:167]
    s_waitcnt lgkmcnt(6)
    v_mfma_f32_32x32x16_bf16 v[104:119], v[70:73], v[38:41], v[104:119]
    v_xad_u32 v20, v9, 48, s53
    ds_read_b128 v[30:33], v20
    v_xad_u32 v21, v10, 48, s53
    ds_read_b128 v[34:37], v21
    v_mfma_f32_32x32x16_bf16 v[120:135], v[70:73], v[42:45], v[120:135]
    ds_read_b64_tr_b16 v[54:55], v15 offset:6144
    ds_read_b64_tr_b16 v[56:57], v15 offset:6656
    ds_read_b64_tr_b16 v[58:59], v16 offset:6144
    ds_read_b64_tr_b16 v[60:61], v16 offset:6656
    v_mfma_f32_32x32x16_bf16 v[136:151], v[74:77], v[38:41], v[136:151]
    v_mfma_f32_32x32x16_bf16 v[152:167], v[74:77], v[42:45], v[152:167]
    s_mov_b32 s42, 0
K1_gr_37:
    s_waitcnt vmcnt(0)
    v_cmp_ne_u32 vcc, v194, v243
    v_cmp_ne_u32 s[40:41], v198, v243
    s_or_b64 vcc, vcc, s[40:41]
    s_cmp_ge_u32 s48, 4
    s_cbranch_scc1 K1_grc_38
    v_cmp_ne_u32 s[40:41], v201, v243
    s_or_b64 vcc, vcc, s[40:41]
    v_cmp_ne_u32 s[40:41], v203, v243
    s_or_b64 vcc, vcc, s[40:41]
    v_cmp_ne_u32 s[40:41], v205, v243
    s_or_b64 vcc, vcc, s[40:41]
    v_cmp_ne_u32 s[40:41], v207, v243
    s_or_b64 vcc, vcc, s[40:41]
    v_cmp_ne_u32 s[40:41], v209, v243
    s_or_b64 vcc, vcc, s[40:41]
    v_cmp_ne_u32 s[40:41], v211, v243
    s_or_b64 vcc, vcc, s[40:41]
    v_cmp_ne_u32 s[40:41], v213, v243
    s_or_b64 vcc, vcc, s[40:41]
    v_cmp_ne_u32 s[40:41], v215, v243
    s_or_b64 vcc, vcc, s[40:41]
    v_cmp_ne_u32 s[40:41], v217, v243
    s_or_b64 vcc, vcc, s[40:41]
    v_cmp_ne_u32 s[40:41], v219, v243
    s_or_b64 vcc, vcc, s[40:41]
K1_grc_38:
    s_add_u32 s42, s42, 1
    s_cmp_gt_u32 s42, 4000
    s_cbranch_scc1 K1_gr_37ok
    s_cbranch_vccz K1_gr_37ok
    s_sleep 4
    v_lshrrev_b32 v28, 7, v9
    s_lshl_b32 s40, s49, 7
    v_add_u32 v28, s40, v28
    v_lshlrev_b32 v28, 4, v28
    v_add_u32 v28, 19136512, v28
    global_load_dwordx4 v[192:195], v28, s[68:69] sc1
    v_lshrrev_b32 v28, 7, v10
    s_lshl_b32 s40, s49, 7
    v_add_u32 v28, s40, v28
    v_lshlrev_b32 v28, 4, v28
    v_add_u32 v28, 19136512, v28
    global_load_dwordx4 v[196:199], v28, s[68:69] sc1
    s_cmp_ge_u32 s48, 4
    s_cbranch_scc1 K1_csl_39
    s_mul_i32 s40, s86, 20480
    s_add_u32 s40, s40, 19202048
    v_lshl_add_u32 v28, v0, 3, s40
    global_load_dwordx2 v[200:201], v28, s[68:69] offset:0 sc1
    global_load_dwordx2 v[202:203], v28, s[68:69] offset:2048 sc1
    v_add_u32 v28, 4096, v28
    global_load_dwordx2 v[204:205], v28, s[68:69] offset:0 sc1
    global_load_dwordx2 v[206:207], v28, s[68:69] offset:2048 sc1
    v_add_u32 v28, 4096, v28
    global_load_dwordx2 v[208:209], v28, s[68:69] offset:0 sc1
    global_load_dwordx2 v[210:211], v28, s[68:69] offset:2048 sc1
    v_add_u32 v28, 4096, v28
    global_load_dwordx2 v[212:213], v28, s[68:69] offset:0 sc1
    global_load_dwordx2 v[214:215], v28, s[68:69] offset:2048 sc1
    v_add_u32 v28, 4096, v28
    global_load_dwordx2 v[216:217], v28, s[68:69] offset:0 sc1
    global_load_dwordx2 v[218:219], v28, s[68:69] offset:2048 sc1
K1_csl_39:
    s_branch K1_gr_37
K1_gr_37ok:
    v_mov_b32 v248, v192
    v_mov_b32 v249, v193
    v_mov_b32 v250, v196
    v_mov_b32 v251, v197
    s_cmp_ge_u32 s48, 4
    s_cbranch_scc1 K1_cs2_40
    v_add_f32 v200, v200, v202
    v_add_f32 v200, v200, v204
    v_add_f32 v200, v200, v206
    v_add_f32 v200, v200, v208
    v_add_f32 v200, v200, v210
    v_add_f32 v200, v200, v212
    v_add_f32 v200, v200, v214
    v_add_f32 v200, v200, v216
    v_add_f32 v200, v200, v218
    v_lshlrev_b32 v28, 2, v0
    ds_write_b32 v28, v200 offset:0
K1_cs2_40:
    s_waitcnt lgkmcnt(0)
    s_barrier
    s_mul_i32 s40, s51, 256
    v_lshl_add_u32 v28, v3, 4, s40
    ds_read_b128 v[168:171], v28 offset:0
    ds_read_b128 v[172:175], v28 offset:32
    ds_read_b128 v[176:179], v28 offset:64
    ds_read_b128 v[180:183], v28 offset:96
    ds_read_b128 v[184:187], v28 offset:128
    ds_read_b128 v[188:191], v28 offset:160
    ds_read_b128 v[192:195], v28 offset:192
    ds_read_b128 v[196:199], v28 offset:224
    v_mfma_f32_32x32x16_bf16 v[104:119], v[86:89], v[46:49], v[104:119]
    v_mfma_f32_32x32x16_bf16 v[120:135], v[86:89], v[50:53], v[120:135]
    v_mfma_f32_32x32x16_bf16 v[136:151], v[90:93], v[46:49], v[136:151]
    v_mfma_f32_32x32x16_bf16 v[152:167], v[90:93], v[50:53], v[152:167]
    s_waitcnt lgkmcnt(0)
    v_mfma_f32_32x32x16_bf16 v[104:119], v[54:57], v[30:33], v[104:119]
    v_mfma_f32_32x32x16_bf16 v[120:135], v[54:57], v[34:37], v[120:135]
    v_mfma_f32_32x32x16_bf16 v[136:151], v[58:61], v[30:33], v[136:151]
    v_mfma_f32_32x32x16_bf16 v[152:167], v[58:61], v[34:37], v[152:167]
    s_branch K1B_EXIT
K1B_EXIT:
    s_cmp_ge_u32 s85, 74
    s_cbranch_scc1 K1_pf_41
    v_lshrrev_b32 v20, 2, v1
    v_mul_u32_u24 v20, 160, v20
    v_and_b32 v21, 3, v1
    v_lshl_add_u32 v22, v21, 4, v20
    v_lshl_add_u32 v23, v21, 3, v20
    v_add_u32 v22, s87, v22
    v_add_u32 v23, s87, v23
    ds_read_b64_tr_b16 v[30:31], v22 offset:0
    ds_read_b64_tr_b16 v[32:33], v22 offset:2560
    ds_read_b64_tr_b16 v[34:35], v22 offset:8
    ds_read_b64_tr_b16 v[36:37], v22 offset:2568
    ds_read_b64_tr_b16 v[38:39], v22 offset:64
    ds_read_b64_tr_b16 v[40:41], v22 offset:2624
    ds_read_b64_tr_b16 v[42:43], v22 offset:72
    ds_read_b64_tr_b16 v[44:45], v22 offset:2632
    ds_read_b64_tr_b16 v[46:47], v23 offset:128
    ds_read_b64_tr_b16 v[48:49], v23 offset:2688
    s_add_u32 s36, s68, 10485760
    s_addc_u32 s37, s69, 0
    s_and_b32 s37, s37, 0xffff
    s_mov_b32 s38, 3031040
    s_mov_b32 s39, 0x00020000
    s_mul_i32 s40, s85, 40
    s_mul_i32 s41, s48, 5
    s_add_u32 s40, s40, s41
    s_lshl_b32 s40, s40, 10
    v_lshlrev_b32 v24, 4, v1
    v_add_u32 v24, s40, v24
    v_add_u32 v27, 4096, v24
    s_waitcnt lgkmcnt(0)
    buffer_store_dwordx4 v[30:33], v24, s[36:39], 0 offen offset:0 sc1
    buffer_store_dwordx4 v[34:37], v24, s[36:39], 0 offen offset:1024 sc1
    buffer_store_dwordx4 v[38:41], v24, s[36:39], 0 offen offset:2048 sc1
    buffer_store_dwordx4 v[42:45], v24, s[36:39], 0 offen offset:3072 sc1
    buffer_store_dwordx4 v[46:49], v27, s[36:39], 0 offen sc1
K1_pf_41:
    s_cmp_ge_u32 s51, s84
    s_cbranch_scc1 K1B_EPI_DONE
    s_cmp_lt_u32 s83, 2
    s_cbranch_scc1 K1B_QLINE
    s_sub_u32 s40, s83, 2
    s_lshl_b32 s41, s49, 3
    s_lshl_b32 s42, s52, 2
    s_add_u32 s41, s41, s42
    s_mul_i32 s41, s41, 74
    s_lshl_b32 s42, s40, 1
    s_add_u32 s41, s41, s42
    s_lshl_b32 s41, s41, 10
    v_lshrrev_b32 v25, 4, v2
    v_mul_u32_u24 v25, 75776, v25
    v_and_b32 v26, 15, v2
    v_lshl_add_u32 v26, v3, 4, v26
    v_lshl_add_u32 v25, v26, 4, v25
    v_add_u32 v25, s41, v25
    v_add_u32 v26, 151552, v25
    s_waitcnt lgkmcnt(0)
    v_fmac_f32 v104, v168, v248
    v_fmac_f32 v105, v169, v248
    v_fmac_f32 v106, v170, v248
    v_fmac_f32 v107, v171, v248
    v_fmac_f32 v108, v172, v248
    v_fmac_f32 v109, v173, v248
    v_fmac_f32 v110, v174, v248
    v_fmac_f32 v111, v175, v248
    v_fmac_f32 v112, v176, v248
    v_fmac_f32 v113, v177, v248
    v_fmac_f32 v114, v178, v248
    v_fmac_f32 v115, v179, v248
    v_fmac_f32 v116, v180, v248
    v_fmac_f32 v117, v181, v248
    v_fmac_f32 v118, v182, v248
    v_fmac_f32 v119, v183, v248
    v_fmac_f32 v136, v184, v248
    v_fmac_f32 v137, v185, v248
    v_fmac_f32 v138, v186, v248
    v_fmac_f32 v139, v187, v248
    v_fmac_f32 v140, v188, v248
    v_fmac_f32 v141, v189, v248
    v_fmac_f32 v142, v190, v248
    v_fmac_f32 v143, v191, v248
    v_fmac_f32 v144, v192, v248
    v_fmac_f32 v145, v193, v248
    v_fmac_f32 v146, v194, v248
    v_fmac_f32 v147, v195, v248
    v_fmac_f32 v148, v196, v248
    v_fmac_f32 v149, v197, v248
    v_fmac_f32 v150, v198, v248
    v_fmac_f32 v151, v199, v248
    v_fmac_f32 v120, v168, v250
    v_fmac_f32 v121, v169, v250
    v_fmac_f32 v122, v170, v250
    v_fmac_f32 v123, v171, v250
    v_fmac_f32 v124, v172, v250
    v_fmac_f32 v125, v173, v250
    v_fmac_f32 v126, v174, v250
    v_fmac_f32 v127, v175, v250
    v_fmac_f32 v128, v176, v250
    v_fmac_f32 v129, v177, v250
    v_fmac_f32 v130, v178, v250
    v_fmac_f32 v131, v179, v250
    v_fmac_f32 v132, v180, v250
    v_fmac_f32 v133, v181, v250
    v_fmac_f32 v134, v182, v250
    v_fmac_f32 v135, v183, v250
    v_fmac_f32 v152, v184, v250
    v_fmac_f32 v153, v185, v250
    v_fmac_f32 v154, v186, v250
    v_fmac_f32 v155, v187, v250
    v_fmac_f32 v156, v188, v250
    v_fmac_f32 v157, v189, v250
    v_fmac_f32 v158, v190, v250
    v_fmac_f32 v159, v191, v250
    v_fmac_f32 v160, v192, v250
    v_fmac_f32 v161, v193, v250
    v_fmac_f32 v162, v194, v250
    v_fmac_f32 v163, v195, v250
    v_fmac_f32 v164, v196, v250
    v_fmac_f32 v165, v197, v250
    v_fmac_f32 v166, v198, v250
    v_fmac_f32 v167, v199, v250
    v_lshlrev_b32 v50, 16, v220
    v_and_b32 v51, 0xffff0000, v220
    v_lshlrev_b32 v52, 16, v221
    v_and_b32 v53, 0xffff0000, v221
    v_lshlrev_b32 v54, 16, v222
    v_and_b32 v55, 0xffff0000, v222
    v_lshlrev_b32 v56, 16, v223
    v_and_b32 v57, 0xffff0000, v223
    v_lshlrev_b32 v58, 16, v224
    v_and_b32 v59, 0xffff0000, v224
    v_lshlrev_b32 v60, 16, v225
    v_and_b32 v61, 0xffff0000, v225
    v_lshlrev_b32 v62, 16, v226
    v_and_b32 v63, 0xffff0000, v226
    v_lshlrev_b32 v64, 16, v227
    v_and_b32 v65, 0xffff0000, v227
    v_lshlrev_b32 v66, 16, v228
    v_and_b32 v67, 0xffff0000, v228
    v_lshlrev_b32 v68, 16, v229
    v_and_b32 v69, 0xffff0000, v229
    v_lshlrev_b32 v70, 16, v230
    v_and_b32 v71, 0xffff0000, v230
    v_lshlrev_b32 v72, 16, v231
    v_and_b32 v73, 0xffff0000, v231
    v_lshlrev_b32 v74, 16, v232
    v_and_b32 v75, 0xffff0000, v232
    v_lshlrev_b32 v76, 16, v233
    v_and_b32 v77, 0xffff0000, v233
    v_lshlrev_b32 v78, 16, v234
    v_and_b32 v79, 0xffff0000, v234
    v_lshlrev_b32 v80, 16, v235
    v_and_b32 v81, 0xffff0000, v235
    s_add_u32 s36, s68, 0
    s_addc_u32 s37, s69, 0
    s_and_b32 s37, s37, 0xffff
    s_mov_b32 s38, 9699328
    s_mov_b32 s39, 0x00020000
    v_fma_f32 v104, v104, v249, v50
    v_max_f32 v104, 0, v104
    v_mul_f32 v104, v104, v104
    v_fma_f32 v105, v105, v249, v51
    v_max_f32 v105, 0, v105
    v_mul_f32 v105, v105, v105
    v_fma_f32 v106, v106, v249, v52
    v_max_f32 v106, 0, v106
    v_mul_f32 v106, v106, v106
    v_fma_f32 v107, v107, v249, v53
    v_max_f32 v107, 0, v107
    v_mul_f32 v107, v107, v107
    v_fma_f32 v108, v108, v249, v54
    v_max_f32 v108, 0, v108
    v_mul_f32 v108, v108, v108
    v_fma_f32 v109, v109, v249, v55
    v_max_f32 v109, 0, v109
    v_mul_f32 v109, v109, v109
    v_fma_f32 v110, v110, v249, v56
    v_max_f32 v110, 0, v110
    v_mul_f32 v110, v110, v110
    v_fma_f32 v111, v111, v249, v57
    v_max_f32 v111, 0, v111
    v_mul_f32 v111, v111, v111
    v_fma_f32 v112, v112, v249, v58
    v_max_f32 v112, 0, v112
    v_mul_f32 v112, v112, v112
    v_fma_f32 v113, v113, v249, v59
    v_max_f32 v113, 0, v113
    v_mul_f32 v113, v113, v113
    v_fma_f32 v114, v114, v249, v60
    v_max_f32 v114, 0, v114
    v_mul_f32 v114, v114, v114
    v_fma_f32 v115, v115, v249, v61
    v_max_f32 v115, 0, v115
    v_mul_f32 v115, v115, v115
    v_fma_f32 v116, v116, v249, v62
    v_max_f32 v116, 0, v116
    v_mul_f32 v116, v116, v116
    v_fma_f32 v117, v117, v249, v63
    v_max_f32 v117, 0, v117
    v_mul_f32 v117, v117, v117
    v_fma_f32 v118, v118, v249, v64
    v_max_f32 v118, 0, v118
    v_mul_f32 v118, v118, v118
    v_fma_f32 v119, v119, v249, v65
    v_max_f32 v119, 0, v119
    v_mul_f32 v119, v119, v119
    v_cvt_pk_bf16_f32 v168, v104, v105
    v_cvt_pk_bf16_f32 v169, v106, v107
    v_cvt_pk_bf16_f32 v170, v108, v109
    v_cvt_pk_bf16_f32 v171, v110, v111
    buffer_store_dwordx4 v[168:171], v25, s[36:39], 0 offen offset:0 sc1
    v_cvt_pk_bf16_f32 v172, v112, v113
    v_cvt_pk_bf16_f32 v173, v114, v115
    v_cvt_pk_bf16_f32 v174, v116, v117
    v_cvt_pk_bf16_f32 v175, v118, v119
    buffer_store_dwordx4 v[172:175], v25, s[36:39], 0 offen offset:512 sc1
    v_fma_f32 v136, v136, v249, v66
    v_max_f32 v136, 0, v136
    v_mul_f32 v136, v136, v136
    v_fma_f32 v137, v137, v249, v67
    v_max_f32 v137, 0, v137
    v_mul_f32 v137, v137, v137
    v_fma_f32 v138, v138, v249, v68
    v_max_f32 v138, 0, v138
    v_mul_f32 v138, v138, v138
    v_fma_f32 v139, v139, v249, v69
    v_max_f32 v139, 0, v139
    v_mul_f32 v139, v139, v139
    v_fma_f32 v140, v140, v249, v70
    v_max_f32 v140, 0, v140
    v_mul_f32 v140, v140, v140
    v_fma_f32 v141, v141, v249, v71
    v_max_f32 v141, 0, v141
    v_mul_f32 v141, v141, v141
    v_fma_f32 v142, v142, v249, v72
    v_max_f32 v142, 0, v142
    v_mul_f32 v142, v142, v142
    v_fma_f32 v143, v143, v249, v73
    v_max_f32 v143, 0, v143
    v_mul_f32 v143, v143, v143
    v_fma_f32 v144, v144, v249, v74
    v_max_f32 v144, 0, v144
    v_mul_f32 v144, v144, v144
    v_fma_f32 v145, v145, v249, v75
    v_max_f32 v145, 0, v145
    v_mul_f32 v145, v145, v145
    v_fma_f32 v146, v146, v249, v76
    v_max_f32 v146, 0, v146
    v_mul_f32 v146, v146, v146
    v_fma_f32 v147, v147, v249, v77
    v_max_f32 v147, 0, v147
    v_mul_f32 v147, v147, v147
    v_fma_f32 v148, v148, v249, v78
    v_max_f32 v148, 0, v148
    v_mul_f32 v148, v148, v148
    v_fma_f32 v149, v149, v249, v79
    v_max_f32 v149, 0, v149
    v_mul_f32 v149, v149, v149
    v_fma_f32 v150, v150, v249, v80
    v_max_f32 v150, 0, v150
    v_mul_f32 v150, v150, v150
    v_fma_f32 v151, v151, v249, v81
    v_max_f32 v151, 0, v151
    v_mul_f32 v151, v151, v151
    v_cvt_pk_bf16_f32 v176, v136, v137
    v_cvt_pk_bf16_f32 v177, v138, v139
    v_cvt_pk_bf16_f32 v178, v140, v141
    v_cvt_pk_bf16_f32 v179, v142, v143
    buffer_store_dwordx4 v[176:179], v25, s[36:39], 0 offen offset:1024 sc1
    v_cvt_pk_bf16_f32 v180, v144, v145
    v_cvt_pk_bf16_f32 v181, v146, v147
    v_cvt_pk_bf16_f32 v182, v148, v149
    v_cvt_pk_bf16_f32 v183, v150, v151
    buffer_store_dwordx4 v[180:183], v25, s[36:39], 0 offen offset:1536 sc1
    v_fma_f32 v120, v120, v251, v50
    v_max_f32 v120, 0, v120
    v_mul_f32 v120, v120, v120
    v_fma_f32 v121, v121, v251, v51
    v_max_f32 v121, 0, v121
    v_mul_f32 v121, v121, v121
    v_fma_f32 v122, v122, v251, v52
    v_max_f32 v122, 0, v122
    v_mul_f32 v122, v122, v122
    v_fma_f32 v123, v123, v251, v53
    v_max_f32 v123, 0, v123
    v_mul_f32 v123, v123, v123
    v_fma_f32 v124, v124, v251, v54
    v_max_f32 v124, 0, v124
    v_mul_f32 v124, v124, v124
    v_fma_f32 v125, v125, v251, v55
    v_max_f32 v125, 0, v125
    v_mul_f32 v125, v125, v125
    v_fma_f32 v126, v126, v251, v56
    v_max_f32 v126, 0, v126
    v_mul_f32 v126, v126, v126
    v_fma_f32 v127, v127, v251, v57
    v_max_f32 v127, 0, v127
    v_mul_f32 v127, v127, v127
    v_fma_f32 v128, v128, v251, v58
    v_max_f32 v128, 0, v128
    v_mul_f32 v128, v128, v128
    v_fma_f32 v129, v129, v251, v59
    v_max_f32 v129, 0, v129
    v_mul_f32 v129, v129, v129
    v_fma_f32 v130, v130, v251, v60
    v_max_f32 v130, 0, v130
    v_mul_f32 v130, v130, v130
    v_fma_f32 v131, v131, v251, v61
    v_max_f32 v131, 0, v131
    v_mul_f32 v131, v131, v131
    v_fma_f32 v132, v132, v251, v62
    v_max_f32 v132, 0, v132
    v_mul_f32 v132, v132, v132
    v_fma_f32 v133, v133, v251, v63
    v_max_f32 v133, 0, v133
    v_mul_f32 v133, v133, v133
    v_fma_f32 v134, v134, v251, v64
    v_max_f32 v134, 0, v134
    v_mul_f32 v134, v134, v134
    v_fma_f32 v135, v135, v251, v65
    v_max_f32 v135, 0, v135
    v_mul_f32 v135, v135, v135
    v_cvt_pk_bf16_f32 v184, v120, v121
    v_cvt_pk_bf16_f32 v185, v122, v123
    v_cvt_pk_bf16_f32 v186, v124, v125
    v_cvt_pk_bf16_f32 v187, v126, v127
    buffer_store_dwordx4 v[184:187], v26, s[36:39], 0 offen offset:0 sc1
    v_cvt_pk_bf16_f32 v188, v128, v129
    v_cvt_pk_bf16_f32 v189, v130, v131
    v_cvt_pk_bf16_f32 v190, v132, v133
    v_cvt_pk_bf16_f32 v191, v134, v135
    buffer_store_dwordx4 v[188:191], v26, s[36:39], 0 offen offset:512 sc1
    v_fma_f32 v152, v152, v251, v66
    v_max_f32 v152, 0, v152
    v_mul_f32 v152, v152, v152
    v_fma_f32 v153, v153, v251, v67
    v_max_f32 v153, 0, v153
    v_mul_f32 v153, v153, v153
    v_fma_f32 v154, v154, v251, v68
    v_max_f32 v154, 0, v154
    v_mul_f32 v154, v154, v154
    v_fma_f32 v155, v155, v251, v69
    v_max_f32 v155, 0, v155
    v_mul_f32 v155, v155, v155
    v_fma_f32 v156, v156, v251, v70
    v_max_f32 v156, 0, v156
    v_mul_f32 v156, v156, v156
    v_fma_f32 v157, v157, v251, v71
    v_max_f32 v157, 0, v157
    v_mul_f32 v157, v157, v157
    v_fma_f32 v158, v158, v251, v72
    v_max_f32 v158, 0, v158
    v_mul_f32 v158, v158, v158
    v_fma_f32 v159, v159, v251, v73
    v_max_f32 v159, 0, v159
    v_mul_f32 v159, v159, v159
    v_fma_f32 v160, v160, v251, v74
    v_max_f32 v160, 0, v160
    v_mul_f32 v160, v160, v160
    v_fma_f32 v161, v161, v251, v75
    v_max_f32 v161, 0, v161
    v_mul_f32 v161, v161, v161
    v_fma_f32 v162, v162, v251, v76
    v_max_f32 v162, 0, v162
    v_mul_f32 v162, v162, v162
    v_fma_f32 v163, v163, v251, v77
    v_max_f32 v163, 0, v163
    v_mul_f32 v163, v163, v163
    v_fma_f32 v164, v164, v251, v78
    v_max_f32 v164, 0, v164
    v_mul_f32 v164, v164, v164
    v_fma_f32 v165, v165, v251, v79
    v_max_f32 v165, 0, v165
    v_mul_f32 v165, v165, v165
    v_fma_f32 v166, v166, v251, v80
    v_max_f32 v166, 0, v166
    v_mul_f32 v166, v166, v166
    v_fma_f32 v167, v167, v251, v81
    v_max_f32 v167, 0, v167
    v_mul_f32 v167, v167, v167
    v_cvt_pk_bf16_f32 v192, v152, v153
    v_cvt_pk_bf16_f32 v193, v154, v155
    v_cvt_pk_bf16_f32 v194, v156, v157
    v_cvt_pk_bf16_f32 v195, v158, v159
    buffer_store_dwordx4 v[192:195], v26, s[36:39], 0 offen offset:1024 sc1
    v_cvt_pk_bf16_f32 v196, v160, v161
    v_cvt_pk_bf16_f32 v197, v162, v163
    v_cvt_pk_bf16_f32 v198, v164, v165
    v_cvt_pk_bf16_f32 v199, v166, v167
    buffer_store_dwordx4 v[196:199], v26, s[36:39], 0 offen offset:1536 sc1
    s_branch K1B_EPI_DONE
K1B_QLINE:
    s_add_u32 s36, s68, 14680064
    s_addc_u32 s37, s69, 0
    s_and_b32 s37, s37, 0xffff
    s_mov_b32 s38, 2621440
    s_mov_b32 s39, 0x00020000
    s_lshl_b32 s41, s49, 2
    s_lshl_b32 s42, s52, 1
    s_add_u32 s41, s41, s42
    s_mul_i32 s41, s41, 80
    s_lshl_b32 s42, s83, 3
    s_add_u32 s41, s41, s42
    s_add_u32 s41, s41, 64
    s_lshl_b32 s41, s41, 9
    v_lshlrev_b32 v25, 9, v3
    v_lshl_add_u32 v25, v2, 4, v25
    v_add_u32 v25, s41, v25
    v_add_u32 v26, 40960, v25
    s_waitcnt lgkmcnt(0)
    v_fmac_f32 v104, v168, v248
    v_mul_f32 v104, v104, v249
    v_fmac_f32 v105, v169, v248
    v_mul_f32 v105, v105, v249
    v_fmac_f32 v106, v170, v248
    v_mul_f32 v106, v106, v249
    v_fmac_f32 v107, v171, v248
    v_mul_f32 v107, v107, v249
    v_fmac_f32 v108, v172, v248
    v_mul_f32 v108, v108, v249
    v_fmac_f32 v109, v173, v248
    v_mul_f32 v109, v109, v249
    v_fmac_f32 v110, v174, v248
    v_mul_f32 v110, v110, v249
    v_fmac_f32 v111, v175, v248
    v_mul_f32 v111, v111, v249
    v_fmac_f32 v112, v176, v248
    v_mul_f32 v112, v112, v249
    v_fmac_f32 v113, v177, v248
    v_mul_f32 v113, v113, v249
    v_fmac_f32 v114, v178, v248
    v_mul_f32 v114, v114, v249
    v_fmac_f32 v115, v179, v248
    v_mul_f32 v115, v115, v249
    v_fmac_f32 v116, v180, v248
    v_mul_f32 v116, v116, v249
    v_fmac_f32 v117, v181, v248
    v_mul_f32 v117, v117, v249
    v_fmac_f32 v118, v182, v248
    v_mul_f32 v118, v118, v249
    v_fmac_f32 v119, v183, v248
    v_mul_f32 v119, v119, v249
    v_cvt_pk_bf16_f32 v50, v104, v105
    v_cvt_pk_bf16_f32 v51, v106, v107
    v_cvt_pk_bf16_f32 v52, v108, v109
    v_cvt_pk_bf16_f32 v53, v110, v111
    buffer_store_dwordx4 v[50:53], v25, s[36:39], 0 offen offset:0 sc1
    v_cvt_pk_bf16_f32 v54, v112, v113
    v_cvt_pk_bf16_f32 v55, v114, v115
    v_cvt_pk_bf16_f32 v56, v116, v117
    v_cvt_pk_bf16_f32 v57, v118, v119
    buffer_store_dwordx4 v[54:57], v25, s[36:39], 0 offen offset:1024 sc1
    v_fmac_f32 v136, v184, v248
    v_mul_f32 v136, v136, v249
    v_fmac_f32 v137, v185, v248
    v_mul_f32 v137, v137, v249
    v_fmac_f32 v138, v186, v248
    v_mul_f32 v138, v138, v249
    v_fmac_f32 v139, v187, v248
    v_mul_f32 v139, v139, v249
    v_fmac_f32 v140, v188, v248
    v_mul_f32 v140, v140, v249
    v_fmac_f32 v141, v189, v248
    v_mul_f32 v141, v141, v249
    v_fmac_f32 v142, v190, v248
    v_mul_f32 v142, v142, v249
    v_fmac_f32 v143, v191, v248
    v_mul_f32 v143, v143, v249
    v_fmac_f32 v144, v192, v248
    v_mul_f32 v144, v144, v249
    v_fmac_f32 v145, v193, v248
    v_mul_f32 v145, v145, v249
    v_fmac_f32 v146, v194, v248
    v_mul_f32 v146, v146, v249
    v_fmac_f32 v147, v195, v248
    v_mul_f32 v147, v147, v249
    v_fmac_f32 v148, v196, v248
    v_mul_f32 v148, v148, v249
    v_fmac_f32 v149, v197, v248
    v_mul_f32 v149, v149, v249
    v_fmac_f32 v150, v198, v248
    v_mul_f32 v150, v150, v249
    v_fmac_f32 v151, v199, v248
    v_mul_f32 v151, v151, v249
    v_cvt_pk_bf16_f32 v58, v136, v137
    v_cvt_pk_bf16_f32 v59, v138, v139
    v_cvt_pk_bf16_f32 v60, v140, v141
    v_cvt_pk_bf16_f32 v61, v142, v143
    buffer_store_dwordx4 v[58:61], v25, s[36:39], 0 offen offset:2048 sc1
    v_cvt_pk_bf16_f32 v62, v144, v145
    v_cvt_pk_bf16_f32 v63, v146, v147
    v_cvt_pk_bf16_f32 v64, v148, v149
    v_cvt_pk_bf16_f32 v65, v150, v151
    buffer_store_dwordx4 v[62:65], v25, s[36:39], 0 offen offset:3072 sc1
    v_fmac_f32 v120, v168, v250
    v_mul_f32 v120, v120, v251
    v_fmac_f32 v121, v169, v250
    v_mul_f32 v121, v121, v251
    v_fmac_f32 v122, v170, v250
    v_mul_f32 v122, v122, v251
    v_fmac_f32 v123, v171, v250
    v_mul_f32 v123, v123, v251
    v_fmac_f32 v124, v172, v250
    v_mul_f32 v124, v124, v251
    v_fmac_f32 v125, v173, v250
    v_mul_f32 v125, v125, v251
    v_fmac_f32 v126, v174, v250
    v_mul_f32 v126, v126, v251
    v_fmac_f32 v127, v175, v250
    v_mul_f32 v127, v127, v251
    v_fmac_f32 v128, v176, v250
    v_mul_f32 v128, v128, v251
    v_fmac_f32 v129, v177, v250
    v_mul_f32 v129, v129, v251
    v_fmac_f32 v130, v178, v250
    v_mul_f32 v130, v130, v251
    v_fmac_f32 v131, v179, v250
    v_mul_f32 v131, v131, v251
    v_fmac_f32 v132, v180, v250
    v_mul_f32 v132, v132, v251
    v_fmac_f32 v133, v181, v250
    v_mul_f32 v133, v133, v251
    v_fmac_f32 v134, v182, v250
    v_mul_f32 v134, v134, v251
    v_fmac_f32 v135, v183, v250
    v_mul_f32 v135, v135, v251
    v_cvt_pk_bf16_f32 v66, v120, v121
    v_cvt_pk_bf16_f32 v67, v122, v123
    v_cvt_pk_bf16_f32 v68, v124, v125
    v_cvt_pk_bf16_f32 v69, v126, v127
    buffer_store_dwordx4 v[66:69], v26, s[36:39], 0 offen offset:0 sc1
    v_cvt_pk_bf16_f32 v70, v128, v129
    v_cvt_pk_bf16_f32 v71, v130, v131
    v_cvt_pk_bf16_f32 v72, v132, v133
    v_cvt_pk_bf16_f32 v73, v134, v135
    buffer_store_dwordx4 v[70:73], v26, s[36:39], 0 offen offset:1024 sc1
    v_fmac_f32 v152, v184, v250
    v_mul_f32 v152, v152, v251
    v_fmac_f32 v153, v185, v250
    v_mul_f32 v153, v153, v251
    v_fmac_f32 v154, v186, v250
    v_mul_f32 v154, v154, v251
    v_fmac_f32 v155, v187, v250
    v_mul_f32 v155, v155, v251
    v_fmac_f32 v156, v188, v250
    v_mul_f32 v156, v156, v251
    v_fmac_f32 v157, v189, v250
    v_mul_f32 v157, v157, v251
    v_fmac_f32 v158, v190, v250
    v_mul_f32 v158, v158, v251
    v_fmac_f32 v159, v191, v250
    v_mul_f32 v159, v159, v251
    v_fmac_f32 v160, v192, v250
    v_mul_f32 v160, v160, v251
    v_fmac_f32 v161, v193, v250
    v_mul_f32 v161, v161, v251
    v_fmac_f32 v162, v194, v250
    v_mul_f32 v162, v162, v251
    v_fmac_f32 v163, v195, v250
    v_mul_f32 v163, v163, v251
    v_fmac_f32 v164, v196, v250
    v_mul_f32 v164, v164, v251
    v_fmac_f32 v165, v197, v250
    v_mul_f32 v165, v165, v251
    v_fmac_f32 v166, v198, v250
    v_mul_f32 v166, v166, v251
    v_fmac_f32 v167, v199, v250
    v_mul_f32 v167, v167, v251
    v_cvt_pk_bf16_f32 v74, v152, v153
    v_cvt_pk_bf16_f32 v75, v154, v155
    v_cvt_pk_bf16_f32 v76, v156, v157
    v_cvt_pk_bf16_f32 v77, v158, v159
    buffer_store_dwordx4 v[74:77], v26, s[36:39], 0 offen offset:2048 sc1
    v_cvt_pk_bf16_f32 v78, v160, v161
    v_cvt_pk_bf16_f32 v79, v162, v163
    v_cvt_pk_bf16_f32 v80, v164, v165
    v_cvt_pk_bf16_f32 v81, v166, v167
    buffer_store_dwordx4 v[78:81], v26, s[36:39], 0 offen offset:3072 sc1
K1B_EPI_DONE:
K1_DONE:
K1_END:
    s_endpgm

.globl k2_kernel
.p2align 8
.type k2_kernel,@function
k2_kernel:
    s_cmp_ge_u32 s2, 256
    s_cbranch_scc1 K2_END
    s_load_dwordx2 s[4:5], s[0:1], 0
    s_load_dwordx2 s[6:7], s[0:1], 16
    s_load_dwordx4 s[8:11], s[0:1], 64
    s_load_dwordx4 s[12:15], s[0:1], 80
    v_and_b32 v1, 63, v0
    v_lshrrev_b32 v20, 6, v0
    v_and_b32 v2, 15, v0
    v_readfirstlane_b32 s48, v20
    v_bfe_u32 v3, v0, 4, 2
    v_and_b32 v4, 31, v0
    v_bfe_u32 v5, v0, 5, 1
    s_and_b32 s51, s48, 3
    s_and_b32 s40, s2, 7
    s_lshr_b32 s41, s2, 3
    s_lshr_b32 s42, s40, 1
    s_lshl_b32 s42, s42, 3
    s_lshr_b32 s43, s41, 2
    s_add_u32 s49, s42, s43
    s_and_b32 s40, s40, 1
    s_lshl_b32 s40, s40, 2
    s_and_b32 s41, s41, 3
    s_add_u32 s50, s40, s41
    s_and_b32 s40, s49, 7
    s_mul_i32 s40, s40, 7
    s_and_b32 s41, s50, 3
    s_mul_i32 s41, s41, 14
    s_add_u32 s40, s40, s41
    s_sub_u32 s41, s40, 54
    s_cmp_lt_u32 s40, 54
    s_cselect_b32 s61, s40, s41
    s_mov_b32 s61, 0
    v_lshlrev_b32 v10, 4, v1
    v_add_u32 v11, 4096, v10
    s_waitcnt lgkmcnt(0)
    s_add_u32 s44, s14, 19660800
    s_addc_u32 s45, s15, 0
    s_load_dword s59, s[44:45], 0
    s_cmp_ge_u32 s48, 4
    s_cbranch_scc1 K2_LOADER
    s_lshr_b32 s52, s51, 1
    s_and_b32 s53, s51, 1
    s_mul_i32 s54, s52, 6240
    s_add_u32 s54, s54, 143360
    s_lshl_b32 s40, s49, 2
    s_add_u32 s40, s40, s51
    s_mul_i32 s40, s40, 75776
    s_add_u32 s16, s14, s40
    s_addc_u32 s17, s15, 0
    s_and_b32 s17, s17, 0xffff
    s_mov_b32 s18, 75776
    s_mov_b32 s19, 0x00020000
    s_lshl_b32 s41, s50, 1
    s_add_u32 s41, s41, s52
    s_mul_i32 s42, s41, 1600
    s_add_u32 s36, s6, s42
    s_addc_u32 s37, s7, 0
    s_and_b32 s37, s37, 0xffff
    s_mov_b32 s38, 1600
    s_mov_b32 s39, 0x00020000
    buffer_load_dwordx4 v[112:115], v10, s[36:39], 0 offen
    buffer_load_dwordx4 v[116:119], v10, s[36:39], 0 offen offset:1024
    s_mul_i32 s42, s41, 6720
    s_add_u32 s42, s42, 18874368
    s_nop 3
    s_add_u32 s36, s14, s42
    s_addc_u32 s37, s15, 0
    s_and_b32 s37, s37, 0xffff
    s_mov_b32 s38, 6720
    s_mov_b32 s39, 0x00020000
    buffer_load_dwordx4 v[120:123], v10, s[36:39], 0 offen offset:0
    buffer_load_dwordx4 v[124:127], v10, s[36:39], 0 offen offset:1024
    buffer_load_dwordx4 v[128:131], v10, s[36:39], 0 offen offset:2048
    buffer_load_dwordx4 v[132:135], v10, s[36:39], 0 offen offset:3072
    buffer_load_dwordx4 v[136:139], v11, s[36:39], 0 offen offset:0
    buffer_load_dwordx4 v[140:143], v11, s[36:39], 0 offen offset:1024
    buffer_load_dwordx4 v[144:147], v11, s[36:39], 0 offen offset:2048
    s_lshl_b32 s40, s49, 1
    s_add_u32 s40, s40, s53
    s_mul_i32 s40, s40, 80
    s_mul_i32 s42, s41, 5
    s_add_u32 s40, s40, s42
    s_lshl_b32 s40, s40, 9
    v_lshl_add_u32 v20, v4, 4, s40
    v_mul_u32_u24 v21, 1536, v5
    v_add_u32 v21, v21, v20
    s_nop 3
    s_add_u32 s36, s14, 14680064
    s_addc_u32 s37, s15, 0
    s_and_b32 s37, s37, 0xffff
    s_mov_b32 s38, 2621440
    s_mov_b32 s39, 0x00020000
    buffer_load_dwordx4 v[148:151], v21, s[36:39], 0 offen
    buffer_load_dwordx4 v[152:155], v21, s[36:39], 0 offen offset:512
    buffer_load_dwordx4 v[156:159], v20, s[36:39], 0 offen offset:1024
    s_barrier
    s_add_u32 s41, s61, 0
    s_sub_u32 s42, s41, 54
    s_cmp_lt_u32 s41, 54
    s_cselect_b32 s41, s41, s42
    s_lshl_b32 s41, s41, 10
    buffer_load_dwordx4 v[216:219], v10, s[16:19], s41 offen
    s_add_u32 s41, s61, 1
    s_sub_u32 s42, s41, 54
    s_cmp_lt_u32 s41, 54
    s_cselect_b32 s41, s41, s42
    s_lshl_b32 s41, s41, 10
    buffer_load_dwordx4 v[220:223], v10, s[16:19], s41 offen
    s_add_u32 s41, s61, 2
    s_sub_u32 s42, s41, 54
    s_cmp_lt_u32 s41, 54
    s_cselect_b32 s41, s41, s42
    s_lshl_b32 s41, s41, 10
    buffer_load_dwordx4 v[224:227], v10, s[16:19], s41 offen
    s_add_u32 s41, s61, 3
    s_sub_u32 s42, s41, 54
    s_cmp_lt_u32 s41, 54
    s_cselect_b32 s41, s41, s42
    s_lshl_b32 s41, s41, 10
    buffer_load_dwordx4 v[228:231], v10, s[16:19], s41 offen
    s_add_u32 s41, s61, 4
    s_sub_u32 s42, s41, 54
    s_cmp_lt_u32 s41, 54
    s_cselect_b32 s41, s41, s42
    s_lshl_b32 s41, s41, 10
    buffer_load_dwordx4 v[232:235], v10, s[16:19], s41 offen
    s_add_u32 s41, s61, 5
    s_sub_u32 s42, s41, 54
    s_cmp_lt_u32 s41, 54
    s_cselect_b32 s41, s41, s42
    s_lshl_b32 s41, s41, 10
    buffer_load_dwordx4 v[236:239], v10, s[16:19], s41 offen
    s_add_u32 s41, s61, 6
    s_sub_u32 s42, s41, 54
    s_cmp_lt_u32 s41, 54
    s_cselect_b32 s41, s41, s42
    s_lshl_b32 s41, s41, 10
    buffer_load_dwordx4 v[240:243], v10, s[16:19], s41 offen
    s_add_u32 s41, s61, 7
    s_sub_u32 s42, s41, 54
    s_cmp_lt_u32 s41, 54
    s_cselect_b32 s41, s41, s42
    s_lshl_b32 s41, s41, 10
    buffer_load_dwordx4 v[244:247], v10, s[16:19], s41 offen
    s_add_u32 s41, s61, 8
    s_sub_u32 s42, s41, 54
    s_cmp_lt_u32 s41, 54
    s_cselect_b32 s41, s41, s42
    s_lshl_b32 s41, s41, 10
    buffer_load_dwordx4 v[248:251], v10, s[16:19], s41 offen
    s_add_u32 s41, s61, 9
    s_sub_u32 s42, s41, 54
    s_cmp_lt_u32 s41, 54
    s_cselect_b32 s41, s41, s42
    s_lshl_b32 s41, s41, 10
    buffer_load_dwordx4 v[252:255], v10, s[16:19], s41 offen
    v_mov_b32 v52, 0
    v_mov_b32 v53, 0
    v_mov_b32 v54, 0
    v_mov_b32 v55, 0
    v_mov_b32 v56, 0
    v_mov_b32 v57, 0
    v_mov_b32 v58, 0
    v_mov_b32 v59, 0
    v_mov_b32 v60, 0
    v_mov_b32 v61, 0
    v_mov_b32 v62, 0
    v_mov_b32 v63, 0
    v_mov_b32 v64, 0
    v_mov_b32 v65, 0
    v_mov_b32 v66, 0
    v_mov_b32 v67, 0
    v_mov_b32 v68, 0
    v_mov_b32 v69, 0
    v_mov_b32 v70, 0
    v_mov_b32 v71, 0
    v_add_u32 v50, 0x10000, v10
    v_add_u32 v51, 0x20000, v10
    v_mov_b32 v160, 0
    v_mov_b32 v161, 0
    v_mov_b32 v162, 0
    v_mov_b32 v163, 0
    v_add_u32 v22, s54, v10
    ds_write_b128 v22, v[160:163] offset:1600
    ds_write_b128 v22, v[160:163] offset:1856
    v_bfe_u32 v23, v1, 4, 1
    v_lshlrev_b32 v23, 2, v23
    v_and_b32 v24, 3, v1
    v_add_u32 v23, v23, v24
    v_and_b32 v24, 1, v23
    v_lshrrev_b32 v23, 1, v23
    v_bfe_u32 v25, v1, 2, 2
    v_mul_u32_u24 v25, 40, v25
    v_lshl_add_u32 v25, v23, 3, v25
    v_mul_u32_u24 v26, 960, v24
    v_add3_u32 v25, v25, v26, s54
    s_add_u32 s42, s54, 1600
    v_mov_b32 v167, s42
    v_cmp_eq_u32 vcc, v24, v5
    v_cmp_eq_u32 s[44:45], 0, v24
    v_add_u32 v26, 640, v25
    v_subrev_u32 v27, 160, v25
    v_cndmask_b32 v164, v167, v25, vcc
    s_and_b64 s[46:47], vcc, s[44:45]
    s_andn2_b64 s[44:45], vcc, s[44:45]
    s_nop 1
    v_cndmask_b32 v165, v167, v26, s[46:47]
    v_cndmask_b32 v166, v167, v27, s[44:45]
    v_lshrrev_b32 v23, 3, v4
    v_bfe_u32 v24, v4, 2, 1
    v_and_b32 v25, 3, v4
    v_lshl_add_u32 v26, v23, 2, v25
    v_mul_u32_u24 v26, 80, v26
    v_mul_u32_u24 v27, 1680, v24
    s_add_u32 s42, s54, 2880
    v_add3_u32 v26, v26, v27, s42
    v_cmp_eq_u32 vcc, v24, v5
    s_nop 1
    v_cndmask_b32 v168, v167, v26, vcc
    v_add_u32 v26, 1280, v26
    v_lshl_add_u32 v28, v23, 2, v25
    v_cmp_ge_u32 s[44:45], 4, v28
    s_and_b64 vcc, vcc, s[44:45]
    s_nop 1
    v_cndmask_b32 v169, v167, v26, vcc
    s_waitcnt vmcnt(20)
    ds_write_b128 v22, v[112:115] offset:0
    v_cmp_gt_u32 vcc, 36, v1
    s_and_saveexec_b64 s[44:45], vcc
    ds_write_b128 v22, v[116:119] offset:1024
    s_mov_b64 exec, s[44:45]
    v_lshlrev_b32 v21, 3, v1
    v_add_u32 v21, s54, v21
    s_waitcnt vmcnt(13)
    v_cvt_pk_bf16_f32 v172, v120, v121
    v_cvt_pk_bf16_f32 v173, v122, v123
    v_cvt_pk_bf16_f32 v174, v124, v125
    v_cvt_pk_bf16_f32 v175, v126, v127
    v_cvt_pk_bf16_f32 v176, v128, v129
    v_cvt_pk_bf16_f32 v177, v130, v131
    v_cvt_pk_bf16_f32 v178, v132, v133
    v_cvt_pk_bf16_f32 v179, v134, v135
    v_cvt_pk_bf16_f32 v180, v136, v137
    v_cvt_pk_bf16_f32 v181, v138, v139
    v_cvt_pk_bf16_f32 v182, v140, v141
    v_cvt_pk_bf16_f32 v183, v142, v143
    v_cvt_pk_bf16_f32 v184, v144, v145
    v_cvt_pk_bf16_f32 v185, v146, v147
    ds_write_b64 v21, v[172:173] offset:2880
    ds_write_b64 v21, v[174:175] offset:3392
    ds_write_b64 v21, v[176:177] offset:3904
    ds_write_b64 v21, v[178:179] offset:4416
    ds_write_b64 v21, v[180:181] offset:4928
    ds_write_b64 v21, v[182:183] offset:5440
    v_cmp_gt_u32 vcc, 36, v1
    s_and_saveexec_b64 s[44:45], vcc
    ds_write_b64 v21, v[184:185] offset:5952
    s_mov_b64 exec, s[44:45]
    s_waitcnt lgkmcnt(0)
    ds_read_b64_tr_b16 v[188:189], v164 offset:0
    ds_read_b64_tr_b16 v[190:191], v164 offset:160
    ds_read_b64_tr_b16 v[192:193], v164 offset:320
    ds_read_b64_tr_b16 v[194:195], v164 offset:480
    ds_read_b64_tr_b16 v[196:197], v165 offset:0
    ds_read_b64_tr_b16 v[198:199], v166 offset:0
    ds_read_b64_tr_b16 v[200:201], v164 offset:32
    ds_read_b64_tr_b16 v[202:203], v164 offset:192
    ds_read_b64_tr_b16 v[204:205], v164 offset:352
    ds_read_b64_tr_b16 v[206:207], v164 offset:512
    ds_read_b64_tr_b16 v[208:209], v165 offset:32
    ds_read_b64_tr_b16 v[210:211], v166 offset:32
    s_waitcnt vmcnt(10) lgkmcnt(0)
    v_mfma_f32_32x32x16_bf16 v[112:127], v[188:191], v[148:151], 0
    v_mfma_f32_32x32x16_bf16 v[112:127], v[192:195], v[152:155], v[112:127]
    v_mfma_f32_32x32x16_bf16 v[112:127], v[196:199], v[156:159], v[112:127]
    v_mfma_f32_32x32x16_bf16 v[128:143], v[200:203], v[148:151], 0
    v_mfma_f32_32x32x16_bf16 v[128:143], v[204:207], v[152:155], v[128:143]
    v_mfma_f32_32x32x16_bf16 v[128:143], v[208:211], v[156:159], v[128:143]
    ds_read_b128 v[72:75], v168 offset:0
    ds_read_b128 v[76:79], v168 offset:16
    ds_read_b128 v[80:83], v168 offset:32
    ds_read_b128 v[84:87], v168 offset:48
    ds_read_b128 v[88:91], v168 offset:64
    ds_read_b128 v[92:95], v169 offset:0
    ds_read_b128 v[96:99], v169 offset:16
    ds_read_b128 v[100:103], v169 offset:32
    ds_read_b128 v[104:107], v169 offset:48
    ds_read_b128 v[108:111], v169 offset:64
    v_mov_b32 v29, 0x3fb8aa3b
    s_nop 7
    s_nop 3
    v_max3_f32 v23, v112, v113, v114
    v_min3_f32 v24, v112, v113, v114
    v_max3_f32 v23, v23, v115, v116
    v_min3_f32 v24, v24, v115, v116
    v_max3_f32 v23, v23, v117, v118
    v_min3_f32 v24, v24, v117, v118
    v_max3_f32 v23, v23, v119, v120
    v_min3_f32 v24, v24, v119, v120
    v_max3_f32 v23, v23, v121, v122
    v_min3_f32 v24, v24, v121, v122
    v_max3_f32 v23, v23, v123, v124
    v_min3_f32 v24, v24, v123, v124
    v_max3_f32 v23, v23, v125, v126
    v_min3_f32 v24, v24, v125, v126
    v_max3_f32 v23, v23, v127, v128
    v_min3_f32 v24, v24, v127, v128
    v_max3_f32 v23, v23, v129, v130
    v_min3_f32 v24, v24, v129, v130
    v_max_f32 v23, v23, v131
    v_min_f32 v24, v24, v131
    v_mul_f32 v23, v23, v29
    v_mul_f32 v24, v24, v29
    v_fma_f32 v144, v112, v29, -v23
    v_fma_f32 v164, -v112, v29, v24
    v_fma_f32 v145, v113, v29, -v23
    v_fma_f32 v165, -v113, v29, v24
    v_fma_f32 v146, v114, v29, -v23
    v_fma_f32 v166, -v114, v29, v24
    v_fma_f32 v147, v115, v29, -v23
    v_fma_f32 v167, -v115, v29, v24
    v_fma_f32 v148, v116, v29, -v23
    v_fma_f32 v168, -v116, v29, v24
    v_fma_f32 v149, v117, v29, -v23
    v_fma_f32 v169, -v117, v29, v24
    v_fma_f32 v150, v118, v29, -v23
    v_fma_f32 v170, -v118, v29, v24
    v_fma_f32 v151, v119, v29, -v23
    v_fma_f32 v171, -v119, v29, v24
    v_fma_f32 v152, v120, v29, -v23
    v_fma_f32 v172, -v120, v29, v24
    v_fma_f32 v153, v121, v29, -v23
    v_fma_f32 v173, -v121, v29, v24
    v_fma_f32 v154, v122, v29, -v23
    v_fma_f32 v174, -v122, v29, v24
    v_fma_f32 v155, v123, v29, -v23
    v_fma_f32 v175, -v123, v29, v24
    v_fma_f32 v156, v124, v29, -v23
    v_fma_f32 v176, -v124, v29, v24
    v_fma_f32 v157, v125, v29, -v23
    v_fma_f32 v177, -v125, v29, v24
    v_fma_f32 v158, v126, v29, -v23
    v_fma_f32 v178, -v126, v29, v24
    v_fma_f32 v159, v127, v29, -v23
    v_fma_f32 v179, -v127, v29, v24
    v_fma_f32 v160, v128, v29, -v23
    v_fma_f32 v180, -v128, v29, v24
    v_fma_f32 v161, v129, v29, -v23
    v_fma_f32 v181, -v129, v29, v24
    v_fma_f32 v162, v130, v29, -v23
    v_fma_f32 v182, -v130, v29, v24
    v_fma_f32 v163, v131, v29, -v23
    v_fma_f32 v183, -v131, v29, v24
    v_exp_f32 v144, v144
    v_exp_f32 v164, v164
    v_exp_f32 v145, v145
    v_exp_f32 v165, v165
    v_exp_f32 v146, v146
    v_exp_f32 v166, v166
    v_exp_f32 v147, v147
    v_exp_f32 v167, v167
    v_exp_f32 v148, v148
    v_exp_f32 v168, v168
    v_exp_f32 v149, v149
    v_exp_f32 v169, v169
    v_exp_f32 v150, v150
    v_exp_f32 v170, v170
    v_exp_f32 v151, v151
    v_exp_f32 v171, v171
    v_exp_f32 v152, v152
    v_exp_f32 v172, v172
    v_exp_f32 v153, v153
    v_exp_f32 v173, v173
    v_exp_f32 v154, v154
    v_exp_f32 v174, v174
    v_exp_f32 v155, v155
    v_exp_f32 v175, v175
    v_exp_f32 v156, v156
    v_exp_f32 v176, v176
    v_exp_f32 v157, v157
    v_exp_f32 v177, v177
    v_exp_f32 v158, v158
    v_exp_f32 v178, v178
    v_exp_f32 v159, v159
    v_exp_f32 v179, v179
    v_exp_f32 v160, v160
    v_exp_f32 v180, v180
    v_exp_f32 v161, v161
    v_exp_f32 v181, v181
    v_exp_f32 v162, v162
    v_exp_f32 v182, v182
    v_exp_f32 v163, v163
    v_exp_f32 v183, v183
    v_add_f32 v25, v144, v145
    v_add_f32 v26, v164, v165
    v_add_f32 v25, v25, v146
    v_add_f32 v26, v26, v166
    v_add_f32 v25, v25, v147
    v_add_f32 v26, v26, v167
    v_add_f32 v25, v25, v148
    v_add_f32 v26, v26, v168
    v_add_f32 v25, v25, v149
    v_add_f32 v26, v26, v169
    v_add_f32 v25, v25, v150
    v_add_f32 v26, v26, v170
    v_add_f32 v25, v25, v151
    v_add_f32 v26, v26, v171
    v_add_f32 v25, v25, v152
    v_add_f32 v26, v26, v172
    v_add_f32 v25, v25, v153
    v_add_f32 v26, v26, v173
    v_add_f32 v25, v25, v154
    v_add_f32 v26, v26, v174
    v_add_f32 v25, v25, v155
    v_add_f32 v26, v26, v175
    v_add_f32 v25, v25, v156
    v_add_f32 v26, v26, v176
    v_add_f32 v25, v25, v157
    v_add_f32 v26, v26, v177
    v_add_f32 v25, v25, v158
    v_add_f32 v26, v26, v178
    v_add_f32 v25, v25, v159
    v_add_f32 v26, v26, v179
    v_add_f32 v25, v25, v160
    v_add_f32 v26, v26, v180
    v_add_f32 v25, v25, v161
    v_add_f32 v26, v26, v181
    v_add_f32 v25, v25, v162
    v_add_f32 v26, v26, v182
    v_add_f32 v25, v25, v163
    v_add_f32 v26, v26, v183
    v_rcp_f32 v25, v25
    v_rcp_f32 v26, v26
    s_nop 0
    v_mul_f32 v144, v144, v25
    v_mul_f32 v145, v145, v25
    v_cvt_pk_bf16_f32 v188, v144, v145
    v_mul_f32 v146, v146, v25
    v_mul_f32 v147, v147, v25
    v_cvt_pk_bf16_f32 v189, v146, v147
    v_mul_f32 v148, v148, v25
    v_mul_f32 v149, v149, v25
    v_cvt_pk_bf16_f32 v190, v148, v149
    v_mul_f32 v150, v150, v25
    v_mul_f32 v151, v151, v25
    v_cvt_pk_bf16_f32 v191, v150, v151
    v_mul_f32 v152, v152, v25
    v_mul_f32 v153, v153, v25
    v_cvt_pk_bf16_f32 v192, v152, v153
    v_mul_f32 v154, v154, v25
    v_mul_f32 v155, v155, v25
    v_cvt_pk_bf16_f32 v193, v154, v155
    v_mul_f32 v156, v156, v25
    v_mul_f32 v157, v157, v25
    v_cvt_pk_bf16_f32 v194, v156, v157
    v_mul_f32 v158, v158, v25
    v_mul_f32 v159, v159, v25
    v_cvt_pk_bf16_f32 v195, v158, v159
    v_mul_f32 v160, v160, v25
    v_mul_f32 v161, v161, v25
    v_cvt_pk_bf16_f32 v196, v160, v161
    v_mul_f32 v162, v162, v25
    v_mul_f32 v163, v163, v25
    v_cvt_pk_bf16_f32 v197, v162, v163
    v_mul_f32 v164, v164, v26
    v_mul_f32 v165, v165, v26
    v_cvt_pk_bf16_f32 v198, v164, v165
    v_mul_f32 v166, v166, v26
    v_mul_f32 v167, v167, v26
    v_cvt_pk_bf16_f32 v199, v166, v167
    v_mul_f32 v168, v168, v26
    v_mul_f32 v169, v169, v26
    v_cvt_pk_bf16_f32 v200, v168, v169
    v_mul_f32 v170, v170, v26
    v_mul_f32 v171, v171, v26
    v_cvt_pk_bf16_f32 v201, v170, v171
    v_mul_f32 v172, v172, v26
    v_mul_f32 v173, v173, v26
    v_cvt_pk_bf16_f32 v202, v172, v173
    v_mul_f32 v174, v174, v26
    v_mul_f32 v175, v175, v26
    v_cvt_pk_bf16_f32 v203, v174, v175
    v_mul_f32 v176, v176, v26
    v_mul_f32 v177, v177, v26
    v_cvt_pk_bf16_f32 v204, v176, v177
    v_mul_f32 v178, v178, v26
    v_mul_f32 v179, v179, v26
    v_cvt_pk_bf16_f32 v205, v178, v179
    v_mul_f32 v180, v180, v26
    v_mul_f32 v181, v181, v26
    v_cvt_pk_bf16_f32 v206, v180, v181
    v_mul_f32 v182, v182, v26
    v_mul_f32 v183, v183, v26
    v_cvt_pk_bf16_f32 v207, v182, v183
    s_waitcnt lgkmcnt(0)
    v_mfma_f32_32x32x16_bf16 v[112:127], v[72:75], v[188:191], 0
    v_mfma_f32_32x32x16_bf16 v[112:127], v[76:79], v[192:195], v[112:127]
    v_mfma_f32_32x32x16_bf16 v[112:127], v[80:83], v[196:199], v[112:127]
    v_mfma_f32_32x32x16_bf16 v[112:127], v[84:87], v[200:203], v[112:127]
    v_mfma_f32_32x32x16_bf16 v[112:127], v[88:91], v[204:207], v[112:127]
    v_mfma_f32_32x32x16_bf16 v[128:143], v[92:95], v[188:191], 0
    v_mfma_f32_32x32x16_bf16 v[128:143], v[96:99], v[192:195], v[128:143]
    v_mfma_f32_32x32x16_bf16 v[128:143], v[100:103], v[196:199], v[128:143]
    v_mfma_f32_32x32x16_bf16 v[128:143], v[104:107], v[200:203], v[128:143]
    v_mfma_f32_32x32x16_bf16 v[128:143], v[108:111], v[204:207], v[128:143]
    s_lshl_b32 s41, s50, 1
    s_add_u32 s41, s41, s52
    s_mul_i32 s41, s41, 5
    s_add_u32 s41, s41, 216
    s_lshl_b32 s40, s49, 2
    s_lshl_b32 s42, s53, 1
    s_add_u32 s40, s40, s42
    v_lshrrev_b32 v23, 4, v4
    v_add_u32 v23, s40, v23
    v_mul_u32_u24 v23, 75776, v23
    v_and_b32 v24, 15, v4
    v_lshl_add_u32 v23, v24, 4, v23
    v_lshl_add_u32 v27, v5, 1, s41
    v_lshrrev_b32 v25, 2, v27
    v_and_b32 v26, 3, v27
    v_lshl_add_u32 v144, v25, 10, v23
    v_lshl_add_u32 v144, v26, 8, v144
    v_add_u32 v27, 1, v27
    v_lshrrev_b32 v25, 2, v27
    v_and_b32 v26, 3, v27
    v_lshl_add_u32 v145, v25, 10, v23
    v_lshl_add_u32 v145, v26, 8, v145
    s_add_u32 s41, s41, 4
    v_mov_b32 v27, s41
    v_lshrrev_b32 v25, 2, v27
    v_and_b32 v26, 3, v27
    v_lshl_add_u32 v146, v25, 10, v23
    v_lshl_add_u32 v146, v26, 8, v146
    s_add_u32 s36, s14, 0
    s_addc_u32 s37, s15, 0
    s_and_b32 s37, s37, 0xffff
    s_mov_b32 s38, 9699328
    s_mov_b32 s39, 0x00020000
    s_nop 7
    s_nop 7
    v_add_f32 v23, 0x358637bd, v132
    v_rcp_f32 v23, v23
    s_nop 0
    v_mul_f32 v112, v112, v23
    v_mul_f32 v113, v113, v23
    v_mul_f32 v114, v114, v23
    v_mul_f32 v115, v115, v23
    v_mul_f32 v116, v116, v23
    v_mul_f32 v117, v117, v23
    v_mul_f32 v118, v118, v23
    v_mul_f32 v119, v119, v23
    v_mul_f32 v120, v120, v23
    v_mul_f32 v121, v121, v23
    v_mul_f32 v122, v122, v23
    v_mul_f32 v123, v123, v23
    v_mul_f32 v124, v124, v23
    v_mul_f32 v125, v125, v23
    v_mul_f32 v126, v126, v23
    v_mul_f32 v127, v127, v23
    v_mul_f32 v128, v128, v23
    v_mul_f32 v129, v129, v23
    v_mul_f32 v130, v130, v23
    v_mul_f32 v131, v131, v23
    v_cvt_pk_bf16_f32 v148, v112, v113
    v_cvt_pk_bf16_f32 v149, v114, v115
    v_cvt_pk_bf16_f32 v150, v116, v117
    v_cvt_pk_bf16_f32 v151, v118, v119
    v_cvt_pk_bf16_f32 v152, v120, v121
    v_cvt_pk_bf16_f32 v153, v122, v123
    v_cvt_pk_bf16_f32 v154, v124, v125
    v_cvt_pk_bf16_f32 v155, v126, v127
    v_cvt_pk_bf16_f32 v156, v128, v129
    v_cvt_pk_bf16_f32 v158, v128, v129
    v_cvt_pk_bf16_f32 v157, v130, v131
    v_cvt_pk_bf16_f32 v159, v130, v131
    s_add_u32 s41, s61, 10
    s_sub_u32 s42, s41, 54
    s_cmp_lt_u32 s41, 54
    s_cselect_b32 s41, s41, s42
    s_lshl_b32 s41, s41, 10
    buffer_load_dwordx4 v[176:179], v10, s[16:19], s41 offen
    s_add_u32 s41, s61, 11
    s_sub_u32 s42, s41, 54
    s_cmp_lt_u32 s41, 54
    s_cselect_b32 s41, s41, s42
    s_lshl_b32 s41, s41, 10
    buffer_load_dwordx4 v[180:183], v10, s[16:19], s41 offen
    s_add_u32 s41, s61, 12
    s_sub_u32 s42, s41, 54
    s_cmp_lt_u32 s41, 54
    s_cselect_b32 s41, s41, s42
    s_lshl_b32 s41, s41, 10
    buffer_load_dwordx4 v[184:187], v10, s[16:19], s41 offen
    s_add_u32 s41, s61, 13
    s_sub_u32 s42, s41, 54
    s_cmp_lt_u32 s41, 54
    s_cselect_b32 s41, s41, s42
    s_lshl_b32 s41, s41, 10
    buffer_load_dwordx4 v[188:191], v10, s[16:19], s41 offen
    s_add_u32 s41, s61, 14
    s_sub_u32 s42, s41, 54
    s_cmp_lt_u32 s41, 54
    s_cselect_b32 s41, s41, s42
    s_lshl_b32 s41, s41, 10
    buffer_load_dwordx4 v[192:195], v10, s[16:19], s41 offen
    s_add_u32 s41, s61, 15
    s_sub_u32 s42, s41, 54
    s_cmp_lt_u32 s41, 54
    s_cselect_b32 s41, s41, s42
    s_lshl_b32 s41, s41, 10
    buffer_load_dwordx4 v[196:199], v10, s[16:19], s41 offen
    s_add_u32 s41, s61, 16
    s_sub_u32 s42, s41, 54
    s_cmp_lt_u32 s41, 54
    s_cselect_b32 s41, s41, s42
    s_lshl_b32 s41, s41, 10
    buffer_load_dwordx4 v[200:203], v10, s[16:19], s41 offen
    s_add_u32 s41, s61, 17
    s_sub_u32 s42, s41, 54
    s_cmp_lt_u32 s41, 54
    s_cselect_b32 s41, s41, s42
    s_lshl_b32 s41, s41, 10
    buffer_load_dwordx4 v[204:207], v10, s[16:19], s41 offen
    s_add_u32 s41, s61, 18
    s_sub_u32 s42, s41, 54
    s_cmp_lt_u32 s41, 54
    s_cselect_b32 s41, s41, s42
    s_lshl_b32 s41, s41, 10
    buffer_load_dwordx4 v[208:211], v10, s[16:19], s41 offen
    s_add_u32 s41, s61, 19
    s_sub_u32 s42, s41, 54
    s_cmp_lt_u32 s41, 54
    s_cselect_b32 s41, s41, s42
    s_lshl_b32 s41, s41, 10
    buffer_load_dwordx4 v[212:215], v10, s[16:19], s41 offen
    buffer_store_dwordx4 v[148:151], v144, s[36:39], 0 offen sc0 sc1
    buffer_store_dwordx4 v[152:155], v145, s[36:39], 0 offen sc0 sc1
    v_permlane32_swap_b32 v156, v158
    v_permlane32_swap_b32 v157, v159
    s_mov_b64 s[44:45], exec
    s_mov_b32 exec_hi, 0
    buffer_store_dwordx4 v[156:159], v146, s[36:39], 0 offen sc0 sc1
    s_mov_b64 exec, s[44:45]
    s_mov_b32 s24, s4
    s_and_b32 s25, s5, 0xffff
    s_mov_b32 s26, 2621440
    s_mov_b32 s27, 0x00020000
    s_mov_b32 s28, s10
    s_and_b32 s29, s11, 0xffff
    s_mov_b32 s30, 2621440
    s_mov_b32 s31, 0x00020000
    s_mov_b32 s32, s8
    s_and_b32 s33, s9, 0xffff
    s_mov_b32 s34, 1280
    s_mov_b32 s35, 0x00020000
    s_lshl_b32 s40, s49, 6
    s_lshl_b32 s42, s51, 4
    s_add_u32 s40, s40, s42
    v_add_u32 v20, s40, v2
    v_mul_u32_u24 v12, 1280, v20
    s_mul_i32 s42, s50, 160
    v_lshl_add_u32 v13, v3, 4, s42
    v_add_u32 v12, v12, v13
    v_lshlrev_b32 v20, 3, v3
    v_sub_u32 v14, v12, v20
    v_sub_u32 v15, v13, v20
    buffer_load_dwordx4 v[30:33], v12, s[24:27], 0 offen
    buffer_load_dwordx4 v[34:37], v12, s[24:27], 0 offen offset:64
    buffer_load_dwordx2 v[38:39], v14, s[24:27], 0 offen offset:128
    buffer_load_dwordx4 v[40:43], v13, s[32:35], 0 offen
    buffer_load_dwordx4 v[44:47], v13, s[32:35], 0 offen offset:64
    buffer_load_dwordx2 v[48:49], v15, s[32:35], 0 offen offset:128
    s_waitcnt lgkmcnt(0)
    s_barrier
    ds_read_b128 v[72:75], v10 offset:0
    ds_read_b128 v[76:79], v10 offset:1024
    ds_read_b128 v[80:83], v10 offset:2048
    ds_read_b128 v[84:87], v10 offset:3072
    ds_read_b128 v[88:91], v10 offset:4096
    ds_read_b128 v[92:95], v10 offset:5120
    ds_read_b128 v[96:99], v10 offset:6144
    ds_read_b128 v[100:103], v10 offset:7168
    ds_read_b128 v[104:107], v10 offset:8192
    ds_read_b128 v[108:111], v10 offset:9216
    ds_read_b128 v[112:115], v10 offset:10240
    ds_read_b128 v[116:119], v10 offset:11264
    ds_read_b128 v[120:123], v10 offset:12288
    ds_read_b128 v[124:127], v10 offset:13312
    ds_read_b128 v[128:131], v10 offset:14336
    s_waitcnt lgkmcnt(10)
    s_waitcnt vmcnt(28)
    v_mfma_f32_16x16x32_bf16 v[52:55], v[72:75], v[216:219], v[52:55]
    ds_read_b128 v[132:135], v10 offset:15360
    ds_read_b128 v[136:139], v10 offset:16384
    ds_read_b128 v[140:143], v10 offset:17408
    v_mfma_f32_16x16x32_bf16 v[56:59], v[76:79], v[216:219], v[56:59]
    ds_read_b128 v[144:147], v10 offset:18432
    ds_read_b128 v[148:151], v10 offset:19456
    v_mfma_f32_16x16x32_bf16 v[60:63], v[80:83], v[216:219], v[60:63]
    v_mfma_f32_16x16x32_bf16 v[64:67], v[84:87], v[216:219], v[64:67]
    v_mfma_f32_16x16x32_bf16 v[68:71], v[88:91], v[216:219], v[68:71]
    s_add_u32 s41, s61, 20
    s_sub_u32 s42, s41, 54
    s_cmp_lt_u32 s41, 54
    s_cselect_b32 s41, s41, s42
    s_lshl_b32 s41, s41, 10
    buffer_load_dwordx4 v[216:219], v10, s[16:19], s41 offen
    s_waitcnt lgkmcnt(0)
    s_barrier
    s_waitcnt vmcnt(28)
    v_mfma_f32_16x16x32_bf16 v[52:55], v[92:95], v[220:223], v[52:55]
    ds_read_b128 v[72:75], v10 offset:20480
    ds_read_b128 v[76:79], v10 offset:21504
    ds_read_b128 v[80:83], v10 offset:22528
    v_mfma_f32_16x16x32_bf16 v[56:59], v[96:99], v[220:223], v[56:59]
    ds_read_b128 v[84:87], v10 offset:23552
    ds_read_b128 v[88:91], v10 offset:24576
    v_mfma_f32_16x16x32_bf16 v[60:63], v[100:103], v[220:223], v[60:63]
    v_mfma_f32_16x16x32_bf16 v[64:67], v[104:107], v[220:223], v[64:67]
    v_mfma_f32_16x16x32_bf16 v[68:71], v[108:111], v[220:223], v[68:71]
    s_add_u32 s41, s61, 21
    s_sub_u32 s42, s41, 54
    s_cmp_lt_u32 s41, 54
    s_cselect_b32 s41, s41, s42
    s_lshl_b32 s41, s41, 10
    buffer_load_dwordx4 v[220:223], v10, s[16:19], s41 offen
    s_waitcnt lgkmcnt(10)
    s_waitcnt vmcnt(28)
    v_mfma_f32_16x16x32_bf16 v[52:55], v[112:115], v[224:227], v[52:55]
    ds_read_b128 v[92:95], v10 offset:25600
    ds_read_b128 v[96:99], v10 offset:26624
    ds_read_b128 v[100:103], v10 offset:27648
    v_mfma_f32_16x16x32_bf16 v[56:59], v[116:119], v[224:227], v[56:59]
    ds_read_b128 v[104:107], v10 offset:28672
    ds_read_b128 v[108:111], v10 offset:29696
    v_mfma_f32_16x16x32_bf16 v[60:63], v[120:123], v[224:227], v[60:63]
    v_mfma_f32_16x16x32_bf16 v[64:67], v[124:127], v[224:227], v[64:67]
    v_mfma_f32_16x16x32_bf16 v[68:71], v[128:131], v[224:227], v[68:71]
    s_add_u32 s41, s61, 22
    s_sub_u32 s42, s41, 54
    s_cmp_lt_u32 s41, 54
    s_cselect_b32 s41, s41, s42
    s_lshl_b32 s41, s41, 10
    buffer_load_dwordx4 v[224:227], v10, s[16:19], s41 offen
    s_waitcnt lgkmcnt(10)
    s_waitcnt vmcnt(28)
    v_mfma_f32_16x16x32_bf16 v[52:55], v[132:135], v[228:231], v[52:55]
    ds_read_b128 v[112:115], v10 offset:30720
    ds_read_b128 v[116:119], v10 offset:31744
    ds_read_b128 v[120:123], v10 offset:32768
    v_mfma_f32_16x16x32_bf16 v[56:59], v[136:139], v[228:231], v[56:59]
    ds_read_b128 v[124:127], v10 offset:33792
    ds_read_b128 v[128:131], v10 offset:34816
    v_mfma_f32_16x16x32_bf16 v[60:63], v[140:143], v[228:231], v[60:63]
    v_mfma_f32_16x16x32_bf16 v[64:67], v[144:147], v[228:231], v[64:67]
    v_mfma_f32_16x16x32_bf16 v[68:71], v[148:151], v[228:231], v[68:71]
    s_add_u32 s41, s61, 23
    s_sub_u32 s42, s41, 54
    s_cmp_lt_u32 s41, 54
    s_cselect_b32 s41, s41, s42
    s_lshl_b32 s41, s41, 10
    buffer_load_dwordx4 v[228:231], v10, s[16:19], s41 offen
    s_waitcnt lgkmcnt(10)
    s_waitcnt vmcnt(28)
    v_mfma_f32_16x16x32_bf16 v[52:55], v[72:75], v[232:235], v[52:55]
    ds_read_b128 v[132:135], v10 offset:35840
    ds_read_b128 v[136:139], v10 offset:36864
    ds_read_b128 v[140:143], v10 offset:37888
    v_mfma_f32_16x16x32_bf16 v[56:59], v[76:79], v[232:235], v[56:59]
    ds_read_b128 v[144:147], v10 offset:38912
    ds_read_b128 v[148:151], v10 offset:39936
    v_mfma_f32_16x16x32_bf16 v[60:63], v[80:83], v[232:235], v[60:63]
    v_mfma_f32_16x16x32_bf16 v[64:67], v[84:87], v[232:235], v[64:67]
    v_mfma_f32_16x16x32_bf16 v[68:71], v[88:91], v[232:235], v[68:71]
    s_add_u32 s41, s61, 24
    s_sub_u32 s42, s41, 54
    s_cmp_lt_u32 s41, 54
    s_cselect_b32 s41, s41, s42
    s_lshl_b32 s41, s41, 10
    buffer_load_dwordx4 v[232:235], v10, s[16:19], s41 offen
    s_waitcnt lgkmcnt(0)
    s_barrier
    s_waitcnt vmcnt(28)
    v_mfma_f32_16x16x32_bf16 v[52:55], v[92:95], v[236:239], v[52:55]
    ds_read_b128 v[72:75], v10 offset:40960
    ds_read_b128 v[76:79], v10 offset:41984
    ds_read_b128 v[80:83], v10 offset:43008
    v_mfma_f32_16x16x32_bf16 v[56:59], v[96:99], v[236:239], v[56:59]
    ds_read_b128 v[84:87], v10 offset:44032
    ds_read_b128 v[88:91], v10 offset:45056
    v_mfma_f32_16x16x32_bf16 v[60:63], v[100:103], v[236:239], v[60:63]
    v_mfma_f32_16x16x32_bf16 v[64:67], v[104:107], v[236:239], v[64:67]
    v_mfma_f32_16x16x32_bf16 v[68:71], v[108:111], v[236:239], v[68:71]
    s_add_u32 s41, s61, 25
    s_sub_u32 s42, s41, 54
    s_cmp_lt_u32 s41, 54
    s_cselect_b32 s41, s41, s42
    s_lshl_b32 s41, s41, 10
    buffer_load_dwordx4 v[236:239], v10, s[16:19], s41 offen
    s_waitcnt lgkmcnt(10)
    s_waitcnt vmcnt(28)
    v_mfma_f32_16x16x32_bf16 v[52:55], v[112:115], v[240:243], v[52:55]
    ds_read_b128 v[92:95], v10 offset:46080
    ds_read_b128 v[96:99], v10 offset:47104
    ds_read_b128 v[100:103], v10 offset:48128
    v_mfma_f32_16x16x32_bf16 v[56:59], v[116:119], v[240:243], v[56:59]
    ds_read_b128 v[104:107], v10 offset:49152
    ds_read_b128 v[108:111], v10 offset:50176
    v_mfma_f32_16x16x32_bf16 v[60:63], v[120:123], v[240:243], v[60:63]
    v_mfma_f32_16x16x32_bf16 v[64:67], v[124:127], v[240:243], v[64:67]
    v_mfma_f32_16x16x32_bf16 v[68:71], v[128:131], v[240:243], v[68:71]
    s_add_u32 s41, s61, 26
    s_sub_u32 s42, s41, 54
    s_cmp_lt_u32 s41, 54
    s_cselect_b32 s41, s41, s42
    s_lshl_b32 s41, s41, 10
    buffer_load_dwordx4 v[240:243], v10, s[16:19], s41 offen
    s_waitcnt lgkmcnt(10)
    s_waitcnt vmcnt(28)
    v_mfma_f32_16x16x32_bf16 v[52:55], v[132:135], v[244:247], v[52:55]
    ds_read_b128 v[112:115], v10 offset:51200
    ds_read_b128 v[116:119], v10 offset:52224
    ds_read_b128 v[120:123], v10 offset:53248
    v_mfma_f32_16x16x32_bf16 v[56:59], v[136:139], v[244:247], v[56:59]
    ds_read_b128 v[124:127], v10 offset:54272
    ds_read_b128 v[128:131], v10 offset:55296
    v_mfma_f32_16x16x32_bf16 v[60:63], v[140:143], v[244:247], v[60:63]
    v_mfma_f32_16x16x32_bf16 v[64:67], v[144:147], v[244:247], v[64:67]
    v_mfma_f32_16x16x32_bf16 v[68:71], v[148:151], v[244:247], v[68:71]
    s_add_u32 s41, s61, 27
    s_sub_u32 s42, s41, 54
    s_cmp_lt_u32 s41, 54
    s_cselect_b32 s41, s41, s42
    s_lshl_b32 s41, s41, 10
    buffer_load_dwordx4 v[244:247], v10, s[16:19], s41 offen
    s_waitcnt lgkmcnt(10)
    s_waitcnt vmcnt(28)
    v_mfma_f32_16x16x32_bf16 v[52:55], v[72:75], v[248:251], v[52:55]
    ds_read_b128 v[132:135], v10 offset:56320
    ds_read_b128 v[136:139], v10 offset:57344
    ds_read_b128 v[140:143], v10 offset:58368
    v_mfma_f32_16x16x32_bf16 v[56:59], v[76:79], v[248:251], v[56:59]
    ds_read_b128 v[144:147], v10 offset:59392
    ds_read_b128 v[148:151], v10 offset:60416
    v_mfma_f32_16x16x32_bf16 v[60:63], v[80:83], v[248:251], v[60:63]
    v_mfma_f32_16x16x32_bf16 v[64:67], v[84:87], v[248:251], v[64:67]
    v_mfma_f32_16x16x32_bf16 v[68:71], v[88:91], v[248:251], v[68:71]
    s_add_u32 s41, s61, 28
    s_sub_u32 s42, s41, 54
    s_cmp_lt_u32 s41, 54
    s_cselect_b32 s41, s41, s42
    s_lshl_b32 s41, s41, 10
    buffer_load_dwordx4 v[248:251], v10, s[16:19], s41 offen
    s_waitcnt lgkmcnt(0)
    s_barrier
    s_waitcnt vmcnt(28)
    v_mfma_f32_16x16x32_bf16 v[52:55], v[92:95], v[252:255], v[52:55]
    ds_read_b128 v[72:75], v10 offset:61440
    ds_read_b128 v[76:79], v10 offset:62464
    ds_read_b128 v[80:83], v10 offset:63488
    v_mfma_f32_16x16x32_bf16 v[56:59], v[96:99], v[252:255], v[56:59]
    ds_read_b128 v[84:87], v10 offset:64512
    ds_read_b128 v[88:91], v50 offset:0
    v_mfma_f32_16x16x32_bf16 v[60:63], v[100:103], v[252:255], v[60:63]
    v_mfma_f32_16x16x32_bf16 v[64:67], v[104:107], v[252:255], v[64:67]
    v_mfma_f32_16x16x32_bf16 v[68:71], v[108:111], v[252:255], v[68:71]
    s_add_u32 s41, s61, 29
    s_sub_u32 s42, s41, 54
    s_cmp_lt_u32 s41, 54
    s_cselect_b32 s41, s41, s42
    s_lshl_b32 s41, s41, 10
    buffer_load_dwordx4 v[252:255], v10, s[16:19], s41 offen
    s_waitcnt lgkmcnt(10)
    s_waitcnt vmcnt(28)
    v_mfma_f32_16x16x32_bf16 v[52:55], v[112:115], v[176:179], v[52:55]
    ds_read_b128 v[92:95], v50 offset:1024
    ds_read_b128 v[96:99], v50 offset:2048
    ds_read_b128 v[100:103], v50 offset:3072
    v_mfma_f32_16x16x32_bf16 v[56:59], v[116:119], v[176:179], v[56:59]
    ds_read_b128 v[104:107], v50 offset:4096
    ds_read_b128 v[108:111], v50 offset:5120
    v_mfma_f32_16x16x32_bf16 v[60:63], v[120:123], v[176:179], v[60:63]
    v_mfma_f32_16x16x32_bf16 v[64:67], v[124:127], v[176:179], v[64:67]
    v_mfma_f32_16x16x32_bf16 v[68:71], v[128:131], v[176:179], v[68:71]
    s_add_u32 s41, s61, 30
    s_sub_u32 s42, s41, 54
    s_cmp_lt_u32 s41, 54
    s_cselect_b32 s41, s41, s42
    s_lshl_b32 s41, s41, 10
    buffer_load_dwordx4 v[176:179], v10, s[16:19], s41 offen
    s_waitcnt lgkmcnt(10)
    s_waitcnt vmcnt(28)
    v_mfma_f32_16x16x32_bf16 v[52:55], v[132:135], v[180:183], v[52:55]
    ds_read_b128 v[112:115], v50 offset:6144
    ds_read_b128 v[116:119], v50 offset:7168
    ds_read_b128 v[120:123], v50 offset:8192
    v_mfma_f32_16x16x32_bf16 v[56:59], v[136:139], v[180:183], v[56:59]
    ds_read_b128 v[124:127], v50 offset:9216
    ds_read_b128 v[128:131], v50 offset:10240
    v_mfma_f32_16x16x32_bf16 v[60:63], v[140:143], v[180:183], v[60:63]
    v_mfma_f32_16x16x32_bf16 v[64:67], v[144:147], v[180:183], v[64:67]
    v_mfma_f32_16x16x32_bf16 v[68:71], v[148:151], v[180:183], v[68:71]
    s_add_u32 s41, s61, 31
    s_sub_u32 s42, s41, 54
    s_cmp_lt_u32 s41, 54
    s_cselect_b32 s41, s41, s42
    s_lshl_b32 s41, s41, 10
    buffer_load_dwordx4 v[180:183], v10, s[16:19], s41 offen
    s_waitcnt lgkmcnt(10)
    s_waitcnt vmcnt(28)
    v_mfma_f32_16x16x32_bf16 v[52:55], v[72:75], v[184:187], v[52:55]
    ds_read_b128 v[132:135], v50 offset:11264
    ds_read_b128 v[136:139], v50 offset:12288
    ds_read_b128 v[140:143], v50 offset:13312
    v_mfma_f32_16x16x32_bf16 v[56:59], v[76:79], v[184:187], v[56:59]
    ds_read_b128 v[144:147], v50 offset:14336
    ds_read_b128 v[148:151], v50 offset:15360
    v_mfma_f32_16x16x32_bf16 v[60:63], v[80:83], v[184:187], v[60:63]
    v_mfma_f32_16x16x32_bf16 v[64:67], v[84:87], v[184:187], v[64:67]
    v_mfma_f32_16x16x32_bf16 v[68:71], v[88:91], v[184:187], v[68:71]
    s_add_u32 s41, s61, 32
    s_sub_u32 s42, s41, 54
    s_cmp_lt_u32 s41, 54
    s_cselect_b32 s41, s41, s42
    s_lshl_b32 s41, s41, 10
    buffer_load_dwordx4 v[184:187], v10, s[16:19], s41 offen
    s_waitcnt lgkmcnt(0)
    s_barrier
    s_waitcnt vmcnt(28)
    v_mfma_f32_16x16x32_bf16 v[52:55], v[92:95], v[188:191], v[52:55]
    ds_read_b128 v[72:75], v50 offset:16384
    ds_read_b128 v[76:79], v50 offset:17408
    ds_read_b128 v[80:83], v50 offset:18432
    v_mfma_f32_16x16x32_bf16 v[56:59], v[96:99], v[188:191], v[56:59]
    ds_read_b128 v[84:87], v50 offset:19456
    ds_read_b128 v[88:91], v50 offset:20480
    v_mfma_f32_16x16x32_bf16 v[60:63], v[100:103], v[188:191], v[60:63]
    v_mfma_f32_16x16x32_bf16 v[64:67], v[104:107], v[188:191], v[64:67]
    v_mfma_f32_16x16x32_bf16 v[68:71], v[108:111], v[188:191], v[68:71]
    s_add_u32 s41, s61, 33
    s_sub_u32 s42, s41, 54
    s_cmp_lt_u32 s41, 54
    s_cselect_b32 s41, s41, s42
    s_lshl_b32 s41, s41, 10
    buffer_load_dwordx4 v[188:191], v10, s[16:19], s41 offen
    s_waitcnt lgkmcnt(10)
    s_waitcnt vmcnt(28)
    v_mfma_f32_16x16x32_bf16 v[52:55], v[112:115], v[192:195], v[52:55]
    ds_read_b128 v[92:95], v50 offset:21504
    ds_read_b128 v[96:99], v50 offset:22528
    ds_read_b128 v[100:103], v50 offset:23552
    v_mfma_f32_16x16x32_bf16 v[56:59], v[116:119], v[192:195], v[56:59]
    ds_read_b128 v[104:107], v50 offset:24576
    ds_read_b128 v[108:111], v50 offset:25600
    v_mfma_f32_16x16x32_bf16 v[60:63], v[120:123], v[192:195], v[60:63]
    v_mfma_f32_16x16x32_bf16 v[64:67], v[124:127], v[192:195], v[64:67]
    v_mfma_f32_16x16x32_bf16 v[68:71], v[128:131], v[192:195], v[68:71]
    s_add_u32 s41, s61, 34
    s_sub_u32 s42, s41, 54
    s_cmp_lt_u32 s41, 54
    s_cselect_b32 s41, s41, s42
    s_lshl_b32 s41, s41, 10
    buffer_load_dwordx4 v[192:195], v10, s[16:19], s41 offen
    s_waitcnt lgkmcnt(10)
    s_waitcnt vmcnt(28)
    v_mfma_f32_16x16x32_bf16 v[52:55], v[132:135], v[196:199], v[52:55]
    ds_read_b128 v[112:115], v50 offset:26624
    ds_read_b128 v[116:119], v50 offset:27648
    ds_read_b128 v[120:123], v50 offset:28672
    v_mfma_f32_16x16x32_bf16 v[56:59], v[136:139], v[196:199], v[56:59]
    ds_read_b128 v[124:127], v50 offset:29696
    ds_read_b128 v[128:131], v50 offset:30720
    v_mfma_f32_16x16x32_bf16 v[60:63], v[140:143], v[196:199], v[60:63]
    v_mfma_f32_16x16x32_bf16 v[64:67], v[144:147], v[196:199], v[64:67]
    v_mfma_f32_16x16x32_bf16 v[68:71], v[148:151], v[196:199], v[68:71]
    s_add_u32 s41, s61, 35
    s_sub_u32 s42, s41, 54
    s_cmp_lt_u32 s41, 54
    s_cselect_b32 s41, s41, s42
    s_lshl_b32 s41, s41, 10
    buffer_load_dwordx4 v[196:199], v10, s[16:19], s41 offen
    s_waitcnt lgkmcnt(10)
    s_waitcnt vmcnt(28)
    v_mfma_f32_16x16x32_bf16 v[52:55], v[72:75], v[200:203], v[52:55]
    ds_read_b128 v[132:135], v50 offset:31744
    ds_read_b128 v[136:139], v50 offset:32768
    ds_read_b128 v[140:143], v50 offset:33792
    v_mfma_f32_16x16x32_bf16 v[56:59], v[76:79], v[200:203], v[56:59]
    ds_read_b128 v[144:147], v50 offset:34816
    ds_read_b128 v[148:151], v50 offset:35840
    v_mfma_f32_16x16x32_bf16 v[60:63], v[80:83], v[200:203], v[60:63]
    v_mfma_f32_16x16x32_bf16 v[64:67], v[84:87], v[200:203], v[64:67]
    v_mfma_f32_16x16x32_bf16 v[68:71], v[88:91], v[200:203], v[68:71]
    s_add_u32 s41, s61, 36
    s_sub_u32 s42, s41, 54
    s_cmp_lt_u32 s41, 54
    s_cselect_b32 s41, s41, s42
    s_lshl_b32 s41, s41, 10
    buffer_load_dwordx4 v[200:203], v10, s[16:19], s41 offen
    s_waitcnt lgkmcnt(0)
    s_barrier
    s_waitcnt vmcnt(28)
    v_mfma_f32_16x16x32_bf16 v[52:55], v[92:95], v[204:207], v[52:55]
    ds_read_b128 v[72:75], v50 offset:36864
    ds_read_b128 v[76:79], v50 offset:37888
    ds_read_b128 v[80:83], v50 offset:38912
    v_mfma_f32_16x16x32_bf16 v[56:59], v[96:99], v[204:207], v[56:59]
    ds_read_b128 v[84:87], v50 offset:39936
    ds_read_b128 v[88:91], v50 offset:40960
    v_mfma_f32_16x16x32_bf16 v[60:63], v[100:103], v[204:207], v[60:63]
    v_mfma_f32_16x16x32_bf16 v[64:67], v[104:107], v[204:207], v[64:67]
    v_mfma_f32_16x16x32_bf16 v[68:71], v[108:111], v[204:207], v[68:71]
    s_add_u32 s41, s61, 37
    s_sub_u32 s42, s41, 54
    s_cmp_lt_u32 s41, 54
    s_cselect_b32 s41, s41, s42
    s_lshl_b32 s41, s41, 10
    buffer_load_dwordx4 v[204:207], v10, s[16:19], s41 offen
    s_waitcnt lgkmcnt(10)
    s_waitcnt vmcnt(28)
    v_mfma_f32_16x16x32_bf16 v[52:55], v[112:115], v[208:211], v[52:55]
    ds_read_b128 v[92:95], v50 offset:41984
    ds_read_b128 v[96:99], v50 offset:43008
    ds_read_b128 v[100:103], v50 offset:44032
    v_mfma_f32_16x16x32_bf16 v[56:59], v[116:119], v[208:211], v[56:59]
    ds_read_b128 v[104:107], v50 offset:45056
    ds_read_b128 v[108:111], v50 offset:46080
    v_mfma_f32_16x16x32_bf16 v[60:63], v[120:123], v[208:211], v[60:63]
    v_mfma_f32_16x16x32_bf16 v[64:67], v[124:127], v[208:211], v[64:67]
    v_mfma_f32_16x16x32_bf16 v[68:71], v[128:131], v[208:211], v[68:71]
    s_add_u32 s41, s61, 38
    s_sub_u32 s42, s41, 54
    s_cmp_lt_u32 s41, 54
    s_cselect_b32 s41, s41, s42
    s_lshl_b32 s41, s41, 10
    buffer_load_dwordx4 v[208:211], v10, s[16:19], s41 offen
    s_waitcnt lgkmcnt(10)
    s_waitcnt vmcnt(28)
    v_mfma_f32_16x16x32_bf16 v[52:55], v[132:135], v[212:215], v[52:55]
    ds_read_b128 v[112:115], v50 offset:47104
    ds_read_b128 v[116:119], v50 offset:48128
    ds_read_b128 v[120:123], v50 offset:49152
    v_mfma_f32_16x16x32_bf16 v[56:59], v[136:139], v[212:215], v[56:59]
    ds_read_b128 v[124:127], v50 offset:50176
    ds_read_b128 v[128:131], v50 offset:51200
    v_mfma_f32_16x16x32_bf16 v[60:63], v[140:143], v[212:215], v[60:63]
    v_mfma_f32_16x16x32_bf16 v[64:67], v[144:147], v[212:215], v[64:67]
    v_mfma_f32_16x16x32_bf16 v[68:71], v[148:151], v[212:215], v[68:71]
    s_add_u32 s41, s61, 39
    s_sub_u32 s42, s41, 54
    s_cmp_lt_u32 s41, 54
    s_cselect_b32 s41, s41, s42
    s_lshl_b32 s41, s41, 10
    buffer_load_dwordx4 v[212:215], v10, s[16:19], s41 offen
    s_waitcnt lgkmcnt(10)
    s_waitcnt vmcnt(19)
    v_mfma_f32_16x16x32_bf16 v[52:55], v[72:75], v[216:219], v[52:55]
    ds_read_b128 v[132:135], v50 offset:52224
    ds_read_b128 v[136:139], v50 offset:53248
    ds_read_b128 v[140:143], v50 offset:54272
    v_mfma_f32_16x16x32_bf16 v[56:59], v[76:79], v[216:219], v[56:59]
    ds_read_b128 v[144:147], v50 offset:55296
    ds_read_b128 v[148:151], v50 offset:56320
    v_mfma_f32_16x16x32_bf16 v[60:63], v[80:83], v[216:219], v[60:63]
    v_mfma_f32_16x16x32_bf16 v[64:67], v[84:87], v[216:219], v[64:67]
    v_mfma_f32_16x16x32_bf16 v[68:71], v[88:91], v[216:219], v[68:71]
    s_add_u32 s41, s61, 40
    s_sub_u32 s42, s41, 54
    s_cmp_lt_u32 s41, 54
    s_cselect_b32 s41, s41, s42
    s_lshl_b32 s41, s41, 10
    buffer_load_dwordx4 v[216:219], v10, s[16:19], s41 offen
    s_waitcnt lgkmcnt(0)
    s_barrier
    s_waitcnt vmcnt(19)
    v_mfma_f32_16x16x32_bf16 v[52:55], v[92:95], v[220:223], v[52:55]
    ds_read_b128 v[72:75], v50 offset:57344
    ds_read_b128 v[76:79], v50 offset:58368
    ds_read_b128 v[80:83], v50 offset:59392
    v_mfma_f32_16x16x32_bf16 v[56:59], v[96:99], v[220:223], v[56:59]
    ds_read_b128 v[84:87], v50 offset:60416
    ds_read_b128 v[88:91], v50 offset:61440
    v_mfma_f32_16x16x32_bf16 v[60:63], v[100:103], v[220:223], v[60:63]
    v_mfma_f32_16x16x32_bf16 v[64:67], v[104:107], v[220:223], v[64:67]
    v_mfma_f32_16x16x32_bf16 v[68:71], v[108:111], v[220:223], v[68:71]
    s_add_u32 s41, s61, 41
    s_sub_u32 s42, s41, 54
    s_cmp_lt_u32 s41, 54
    s_cselect_b32 s41, s41, s42
    s_lshl_b32 s41, s41, 10
    buffer_load_dwordx4 v[220:223], v10, s[16:19], s41 offen
    s_waitcnt lgkmcnt(10)
    s_waitcnt vmcnt(19)
    v_mfma_f32_16x16x32_bf16 v[52:55], v[112:115], v[224:227], v[52:55]
    ds_read_b128 v[92:95], v50 offset:62464
    ds_read_b128 v[96:99], v50 offset:63488
    ds_read_b128 v[100:103], v50 offset:64512
    v_mfma_f32_16x16x32_bf16 v[56:59], v[116:119], v[224:227], v[56:59]
    ds_read_b128 v[104:107], v51 offset:0
    ds_read_b128 v[108:111], v51 offset:1024
    v_mfma_f32_16x16x32_bf16 v[60:63], v[120:123], v[224:227], v[60:63]
    v_mfma_f32_16x16x32_bf16 v[64:67], v[124:127], v[224:227], v[64:67]
    v_mfma_f32_16x16x32_bf16 v[68:71], v[128:131], v[224:227], v[68:71]
    s_add_u32 s41, s61, 42
    s_sub_u32 s42, s41, 54
    s_cmp_lt_u32 s41, 54
    s_cselect_b32 s41, s41, s42
    s_lshl_b32 s41, s41, 10
    buffer_load_dwordx4 v[224:227], v10, s[16:19], s41 offen
    s_waitcnt lgkmcnt(10)
    s_waitcnt vmcnt(19)
    v_mfma_f32_16x16x32_bf16 v[52:55], v[132:135], v[228:231], v[52:55]
    ds_read_b128 v[112:115], v51 offset:2048
    ds_read_b128 v[116:119], v51 offset:3072
    ds_read_b128 v[120:123], v51 offset:4096
    v_mfma_f32_16x16x32_bf16 v[56:59], v[136:139], v[228:231], v[56:59]
    ds_read_b128 v[124:127], v51 offset:5120
    ds_read_b128 v[128:131], v51 offset:6144
    v_mfma_f32_16x16x32_bf16 v[60:63], v[140:143], v[228:231], v[60:63]
    v_mfma_f32_16x16x32_bf16 v[64:67], v[144:147], v[228:231], v[64:67]
    v_mfma_f32_16x16x32_bf16 v[68:71], v[148:151], v[228:231], v[68:71]
    s_add_u32 s41, s61, 43
    s_sub_u32 s42, s41, 54
    s_cmp_lt_u32 s41, 54
    s_cselect_b32 s41, s41, s42
    s_lshl_b32 s41, s41, 10
    buffer_load_dwordx4 v[228:231], v10, s[16:19], s41 offen
    s_waitcnt lgkmcnt(10)
    s_waitcnt vmcnt(19)
    v_mfma_f32_16x16x32_bf16 v[52:55], v[72:75], v[232:235], v[52:55]
    ds_read_b128 v[132:135], v51 offset:7168
    ds_read_b128 v[136:139], v51 offset:8192
    ds_read_b128 v[140:143], v51 offset:9216
    v_mfma_f32_16x16x32_bf16 v[56:59], v[76:79], v[232:235], v[56:59]
    ds_read_b128 v[144:147], v51 offset:10240
    ds_read_b128 v[148:151], v51 offset:11264
    v_mfma_f32_16x16x32_bf16 v[60:63], v[80:83], v[232:235], v[60:63]
    v_mfma_f32_16x16x32_bf16 v[64:67], v[84:87], v[232:235], v[64:67]
    v_mfma_f32_16x16x32_bf16 v[68:71], v[88:91], v[232:235], v[68:71]
    s_add_u32 s41, s61, 44
    s_sub_u32 s42, s41, 54
    s_cmp_lt_u32 s41, 54
    s_cselect_b32 s41, s41, s42
    s_lshl_b32 s41, s41, 10
    buffer_load_dwordx4 v[232:235], v10, s[16:19], s41 offen
    s_waitcnt lgkmcnt(0)
    s_barrier
    s_waitcnt vmcnt(19)
    v_mfma_f32_16x16x32_bf16 v[52:55], v[92:95], v[236:239], v[52:55]
    ds_read_b128 v[72:75], v10 offset:0
    ds_read_b128 v[76:79], v10 offset:1024
    ds_read_b128 v[80:83], v10 offset:2048
    v_mfma_f32_16x16x32_bf16 v[56:59], v[96:99], v[236:239], v[56:59]
    ds_read_b128 v[84:87], v10 offset:3072
    ds_read_b128 v[88:91], v10 offset:4096
    v_mfma_f32_16x16x32_bf16 v[60:63], v[100:103], v[236:239], v[60:63]
    v_mfma_f32_16x16x32_bf16 v[64:67], v[104:107], v[236:239], v[64:67]
    v_mfma_f32_16x16x32_bf16 v[68:71], v[108:111], v[236:239], v[68:71]
    s_add_u32 s41, s61, 45
    s_sub_u32 s42, s41, 54
    s_cmp_lt_u32 s41, 54
    s_cselect_b32 s41, s41, s42
    s_lshl_b32 s41, s41, 10
    buffer_load_dwordx4 v[236:239], v10, s[16:19], s41 offen
    s_waitcnt lgkmcnt(10)
    s_waitcnt vmcnt(19)
    v_mfma_f32_16x16x32_bf16 v[52:55], v[112:115], v[240:243], v[52:55]
    ds_read_b128 v[92:95], v10 offset:5120
    ds_read_b128 v[96:99], v10 offset:6144
    ds_read_b128 v[100:103], v10 offset:7168
    v_mfma_f32_16x16x32_bf16 v[56:59], v[116:119], v[240:243], v[56:59]
    ds_read_b128 v[104:107], v10 offset:8192
    ds_read_b128 v[108:111], v10 offset:9216
    v_mfma_f32_16x16x32_bf16 v[60:63], v[120:123], v[240:243], v[60:63]
    v_mfma_f32_16x16x32_bf16 v[64:67], v[124:127], v[240:243], v[64:67]
    v_mfma_f32_16x16x32_bf16 v[68:71], v[128:131], v[240:243], v[68:71]
    s_add_u32 s41, s61, 46
    s_sub_u32 s42, s41, 54
    s_cmp_lt_u32 s41, 54
    s_cselect_b32 s41, s41, s42
    s_lshl_b32 s41, s41, 10
    buffer_load_dwordx4 v[240:243], v10, s[16:19], s41 offen
    s_waitcnt lgkmcnt(10)
    s_waitcnt vmcnt(19)
    v_mfma_f32_16x16x32_bf16 v[52:55], v[132:135], v[244:247], v[52:55]
    ds_read_b128 v[112:115], v10 offset:10240
    ds_read_b128 v[116:119], v10 offset:11264
    ds_read_b128 v[120:123], v10 offset:12288
    v_mfma_f32_16x16x32_bf16 v[56:59], v[136:139], v[244:247], v[56:59]
    ds_read_b128 v[124:127], v10 offset:13312
    ds_read_b128 v[128:131], v10 offset:14336
    v_mfma_f32_16x16x32_bf16 v[60:63], v[140:143], v[244:247], v[60:63]
    v_mfma_f32_16x16x32_bf16 v[64:67], v[144:147], v[244:247], v[64:67]
    v_mfma_f32_16x16x32_bf16 v[68:71], v[148:151], v[244:247], v[68:71]
    s_add_u32 s41, s61, 47
    s_sub_u32 s42, s41, 54
    s_cmp_lt_u32 s41, 54
    s_cselect_b32 s41, s41, s42
    s_lshl_b32 s41, s41, 10
    buffer_load_dwordx4 v[244:247], v10, s[16:19], s41 offen
    s_waitcnt lgkmcnt(10)
    s_waitcnt vmcnt(19)
    v_mfma_f32_16x16x32_bf16 v[52:55], v[72:75], v[248:251], v[52:55]
    ds_read_b128 v[132:135], v10 offset:15360
    ds_read_b128 v[136:139], v10 offset:16384
    ds_read_b128 v[140:143], v10 offset:17408
    v_mfma_f32_16x16x32_bf16 v[56:59], v[76:79], v[248:251], v[56:59]
    ds_read_b128 v[144:147], v10 offset:18432
    ds_read_b128 v[148:151], v10 offset:19456
    v_mfma_f32_16x16x32_bf16 v[60:63], v[80:83], v[248:251], v[60:63]
    v_mfma_f32_16x16x32_bf16 v[64:67], v[84:87], v[248:251], v[64:67]
    v_mfma_f32_16x16x32_bf16 v[68:71], v[88:91], v[248:251], v[68:71]
    s_add_u32 s41, s61, 48
    s_sub_u32 s42, s41, 54
    s_cmp_lt_u32 s41, 54
    s_cselect_b32 s41, s41, s42
    s_lshl_b32 s41, s41, 10
    buffer_load_dwordx4 v[248:251], v10, s[16:19], s41 offen
    s_waitcnt lgkmcnt(0)
    s_barrier
    s_waitcnt vmcnt(19)
    v_mfma_f32_16x16x32_bf16 v[52:55], v[92:95], v[252:255], v[52:55]
    ds_read_b128 v[72:75], v10 offset:20480
    ds_read_b128 v[76:79], v10 offset:21504
    ds_read_b128 v[80:83], v10 offset:22528
    v_mfma_f32_16x16x32_bf16 v[56:59], v[96:99], v[252:255], v[56:59]
    ds_read_b128 v[84:87], v10 offset:23552
    ds_read_b128 v[88:91], v10 offset:24576
    v_mfma_f32_16x16x32_bf16 v[60:63], v[100:103], v[252:255], v[60:63]
    v_mfma_f32_16x16x32_bf16 v[64:67], v[104:107], v[252:255], v[64:67]
    v_mfma_f32_16x16x32_bf16 v[68:71], v[108:111], v[252:255], v[68:71]
    s_add_u32 s41, s61, 49
    s_sub_u32 s42, s41, 54
    s_cmp_lt_u32 s41, 54
    s_cselect_b32 s41, s41, s42
    s_lshl_b32 s41, s41, 10
    buffer_load_dwordx4 v[252:255], v10, s[16:19], s41 offen
    s_waitcnt lgkmcnt(10)
    s_waitcnt vmcnt(19)
    v_mfma_f32_16x16x32_bf16 v[52:55], v[112:115], v[176:179], v[52:55]
    ds_read_b128 v[92:95], v10 offset:25600
    ds_read_b128 v[96:99], v10 offset:26624
    ds_read_b128 v[100:103], v10 offset:27648
    v_mfma_f32_16x16x32_bf16 v[56:59], v[116:119], v[176:179], v[56:59]
    ds_read_b128 v[104:107], v10 offset:28672
    ds_read_b128 v[108:111], v10 offset:29696
    v_mfma_f32_16x16x32_bf16 v[60:63], v[120:123], v[176:179], v[60:63]
    v_mfma_f32_16x16x32_bf16 v[64:67], v[124:127], v[176:179], v[64:67]
    v_mfma_f32_16x16x32_bf16 v[68:71], v[128:131], v[176:179], v[68:71]
    s_add_u32 s41, s61, 50
    s_sub_u32 s42, s41, 54
    s_cmp_lt_u32 s41, 54
    s_cselect_b32 s41, s41, s42
    s_lshl_b32 s41, s41, 10
    buffer_load_dwordx4 v[176:179], v10, s[16:19], s41 offen
    s_waitcnt lgkmcnt(10)
    s_waitcnt vmcnt(19)
    v_mfma_f32_16x16x32_bf16 v[52:55], v[132:135], v[180:183], v[52:55]
    ds_read_b128 v[112:115], v10 offset:30720
    ds_read_b128 v[116:119], v10 offset:31744
    ds_read_b128 v[120:123], v10 offset:32768
    v_mfma_f32_16x16x32_bf16 v[56:59], v[136:139], v[180:183], v[56:59]
    ds_read_b128 v[124:127], v10 offset:33792
    ds_read_b128 v[128:131], v10 offset:34816
    v_mfma_f32_16x16x32_bf16 v[60:63], v[140:143], v[180:183], v[60:63]
    v_mfma_f32_16x16x32_bf16 v[64:67], v[144:147], v[180:183], v[64:67]
    v_mfma_f32_16x16x32_bf16 v[68:71], v[148:151], v[180:183], v[68:71]
    s_add_u32 s41, s61, 51
    s_sub_u32 s42, s41, 54
    s_cmp_lt_u32 s41, 54
    s_cselect_b32 s41, s41, s42
    s_lshl_b32 s41, s41, 10
    buffer_load_dwordx4 v[180:183], v10, s[16:19], s41 offen
    s_waitcnt lgkmcnt(10)
    s_waitcnt vmcnt(19)
    v_mfma_f32_16x16x32_bf16 v[52:55], v[72:75], v[184:187], v[52:55]
    ds_read_b128 v[132:135], v10 offset:35840
    ds_read_b128 v[136:139], v10 offset:36864
    ds_read_b128 v[140:143], v10 offset:37888
    v_mfma_f32_16x16x32_bf16 v[56:59], v[76:79], v[184:187], v[56:59]
    ds_read_b128 v[144:147], v10 offset:38912
    ds_read_b128 v[148:151], v10 offset:39936
    v_mfma_f32_16x16x32_bf16 v[60:63], v[80:83], v[184:187], v[60:63]
    v_mfma_f32_16x16x32_bf16 v[64:67], v[84:87], v[184:187], v[64:67]
    v_mfma_f32_16x16x32_bf16 v[68:71], v[88:91], v[184:187], v[68:71]
    s_add_u32 s41, s61, 52
    s_sub_u32 s42, s41, 54
    s_cmp_lt_u32 s41, 54
    s_cselect_b32 s41, s41, s42
    s_lshl_b32 s41, s41, 10
    buffer_load_dwordx4 v[184:187], v10, s[16:19], s41 offen
    s_waitcnt lgkmcnt(0)
    s_barrier
    s_waitcnt vmcnt(19)
    v_mfma_f32_16x16x32_bf16 v[52:55], v[92:95], v[188:191], v[52:55]
    ds_read_b128 v[72:75], v10 offset:40960
    ds_read_b128 v[76:79], v10 offset:41984
    ds_read_b128 v[80:83], v10 offset:43008
    v_mfma_f32_16x16x32_bf16 v[56:59], v[96:99], v[188:191], v[56:59]
    ds_read_b128 v[84:87], v10 offset:44032
    ds_read_b128 v[88:91], v10 offset:45056
    v_mfma_f32_16x16x32_bf16 v[60:63], v[100:103], v[188:191], v[60:63]
    v_mfma_f32_16x16x32_bf16 v[64:67], v[104:107], v[188:191], v[64:67]
    v_mfma_f32_16x16x32_bf16 v[68:71], v[108:111], v[188:191], v[68:71]
    s_add_u32 s41, s61, 53
    s_sub_u32 s42, s41, 54
    s_cmp_lt_u32 s41, 54
    s_cselect_b32 s41, s41, s42
    s_lshl_b32 s41, s41, 10
    buffer_load_dwordx4 v[188:191], v10, s[16:19], s41 offen
    s_waitcnt lgkmcnt(10)
    s_waitcnt vmcnt(19)
    v_mfma_f32_16x16x32_bf16 v[52:55], v[112:115], v[192:195], v[52:55]
    ds_read_b128 v[92:95], v10 offset:46080
    ds_read_b128 v[96:99], v10 offset:47104
    ds_read_b128 v[100:103], v10 offset:48128
    v_mfma_f32_16x16x32_bf16 v[56:59], v[116:119], v[192:195], v[56:59]
    ds_read_b128 v[104:107], v10 offset:49152
    ds_read_b128 v[108:111], v10 offset:50176
    v_mfma_f32_16x16x32_bf16 v[60:63], v[120:123], v[192:195], v[60:63]
    v_mfma_f32_16x16x32_bf16 v[64:67], v[124:127], v[192:195], v[64:67]
    v_mfma_f32_16x16x32_bf16 v[68:71], v[128:131], v[192:195], v[68:71]
    s_mov_b32 s41, 2130706432
    buffer_load_dwordx4 v[192:195], v10, s[16:19], s41 offen
    s_waitcnt lgkmcnt(10)
    s_waitcnt vmcnt(19)
    v_mfma_f32_16x16x32_bf16 v[52:55], v[132:135], v[196:199], v[52:55]
    ds_read_b128 v[112:115], v10 offset:51200
    ds_read_b128 v[116:119], v10 offset:52224
    ds_read_b128 v[120:123], v10 offset:53248
    v_mfma_f32_16x16x32_bf16 v[56:59], v[136:139], v[196:199], v[56:59]
    ds_read_b128 v[124:127], v10 offset:54272
    ds_read_b128 v[128:131], v10 offset:55296
    v_mfma_f32_16x16x32_bf16 v[60:63], v[140:143], v[196:199], v[60:63]
    v_mfma_f32_16x16x32_bf16 v[64:67], v[144:147], v[196:199], v[64:67]
    v_mfma_f32_16x16x32_bf16 v[68:71], v[148:151], v[196:199], v[68:71]
    s_mov_b32 s41, 2130706432
    buffer_load_dwordx4 v[196:199], v10, s[16:19], s41 offen
    s_waitcnt lgkmcnt(10)
    s_waitcnt vmcnt(19)
    v_mfma_f32_16x16x32_bf16 v[52:55], v[72:75], v[200:203], v[52:55]
    ds_read_b128 v[132:135], v10 offset:56320
    ds_read_b128 v[136:139], v10 offset:57344
    ds_read_b128 v[140:143], v10 offset:58368
    v_mfma_f32_16x16x32_bf16 v[56:59], v[76:79], v[200:203], v[56:59]
    ds_read_b128 v[144:147], v10 offset:59392
    ds_read_b128 v[148:151], v10 offset:60416
    v_mfma_f32_16x16x32_bf16 v[60:63], v[80:83], v[200:203], v[60:63]
    v_mfma_f32_16x16x32_bf16 v[64:67], v[84:87], v[200:203], v[64:67]
    v_mfma_f32_16x16x32_bf16 v[68:71], v[88:91], v[200:203], v[68:71]
    s_waitcnt lgkmcnt(0)
    s_barrier
    s_waitcnt vmcnt(18)
    v_mfma_f32_16x16x32_bf16 v[52:55], v[92:95], v[204:207], v[52:55]
    ds_read_b128 v[72:75], v10 offset:61440
    ds_read_b128 v[76:79], v10 offset:62464
    ds_read_b128 v[80:83], v10 offset:63488
    v_mfma_f32_16x16x32_bf16 v[56:59], v[96:99], v[204:207], v[56:59]
    ds_read_b128 v[84:87], v10 offset:64512
    ds_read_b128 v[88:91], v50 offset:0
    v_mfma_f32_16x16x32_bf16 v[60:63], v[100:103], v[204:207], v[60:63]
    v_mfma_f32_16x16x32_bf16 v[64:67], v[104:107], v[204:207], v[64:67]
    v_mfma_f32_16x16x32_bf16 v[68:71], v[108:111], v[204:207], v[68:71]
    s_waitcnt lgkmcnt(10)
    s_waitcnt vmcnt(17)
    v_mfma_f32_16x16x32_bf16 v[52:55], v[112:115], v[208:211], v[52:55]
    ds_read_b128 v[92:95], v50 offset:1024
    ds_read_b128 v[96:99], v50 offset:2048
    ds_read_b128 v[100:103], v50 offset:3072
    v_mfma_f32_16x16x32_bf16 v[56:59], v[116:119], v[208:211], v[56:59]
    ds_read_b128 v[104:107], v50 offset:4096
    ds_read_b128 v[108:111], v50 offset:5120
    v_mfma_f32_16x16x32_bf16 v[60:63], v[120:123], v[208:211], v[60:63]
    v_mfma_f32_16x16x32_bf16 v[64:67], v[124:127], v[208:211], v[64:67]
    v_mfma_f32_16x16x32_bf16 v[68:71], v[128:131], v[208:211], v[68:71]
    s_waitcnt lgkmcnt(10)
    s_waitcnt vmcnt(16)
    v_mfma_f32_16x16x32_bf16 v[52:55], v[132:135], v[212:215], v[52:55]
    ds_read_b128 v[112:115], v50 offset:6144
    ds_read_b128 v[116:119], v50 offset:7168
    ds_read_b128 v[120:123], v50 offset:8192
    v_mfma_f32_16x16x32_bf16 v[56:59], v[136:139], v[212:215], v[56:59]
    ds_read_b128 v[124:127], v50 offset:9216
    ds_read_b128 v[128:131], v50 offset:10240
    v_mfma_f32_16x16x32_bf16 v[60:63], v[140:143], v[212:215], v[60:63]
    v_mfma_f32_16x16x32_bf16 v[64:67], v[144:147], v[212:215], v[64:67]
    v_mfma_f32_16x16x32_bf16 v[68:71], v[148:151], v[212:215], v[68:71]
    s_waitcnt lgkmcnt(10)
    s_waitcnt vmcnt(15)
    v_mfma_f32_16x16x32_bf16 v[52:55], v[72:75], v[216:219], v[52:55]
    ds_read_b128 v[132:135], v50 offset:11264
    ds_read_b128 v[136:139], v50 offset:12288
    ds_read_b128 v[140:143], v50 offset:13312
    v_mfma_f32_16x16x32_bf16 v[56:59], v[76:79], v[216:219], v[56:59]
    ds_read_b128 v[144:147], v50 offset:14336
    ds_read_b128 v[148:151], v50 offset:15360
    v_mfma_f32_16x16x32_bf16 v[60:63], v[80:83], v[216:219], v[60:63]
    v_mfma_f32_16x16x32_bf16 v[64:67], v[84:87], v[216:219], v[64:67]
    v_mfma_f32_16x16x32_bf16 v[68:71], v[88:91], v[216:219], v[68:71]
    s_waitcnt lgkmcnt(0)
    s_barrier
    s_waitcnt vmcnt(14)
    v_mfma_f32_16x16x32_bf16 v[52:55], v[92:95], v[220:223], v[52:55]
    ds_read_b128 v[72:75], v50 offset:16384
    ds_read_b128 v[76:79], v50 offset:17408
    ds_read_b128 v[80:83], v50 offset:18432
    v_mfma_f32_16x16x32_bf16 v[56:59], v[96:99], v[220:223], v[56:59]
    ds_read_b128 v[84:87], v50 offset:19456
    ds_read_b128 v[88:91], v50 offset:20480
    v_mfma_f32_16x16x32_bf16 v[60:63], v[100:103], v[220:223], v[60:63]
    v_mfma_f32_16x16x32_bf16 v[64:67], v[104:107], v[220:223], v[64:67]
    v_mfma_f32_16x16x32_bf16 v[68:71], v[108:111], v[220:223], v[68:71]
    s_waitcnt lgkmcnt(10)
    s_waitcnt vmcnt(13)
    v_mfma_f32_16x16x32_bf16 v[52:55], v[112:115], v[224:227], v[52:55]
    ds_read_b128 v[92:95], v50 offset:21504
    ds_read_b128 v[96:99], v50 offset:22528
    ds_read_b128 v[100:103], v50 offset:23552
    v_mfma_f32_16x16x32_bf16 v[56:59], v[116:119], v[224:227], v[56:59]
    ds_read_b128 v[104:107], v50 offset:24576
    ds_read_b128 v[108:111], v50 offset:25600
    v_mfma_f32_16x16x32_bf16 v[60:63], v[120:123], v[224:227], v[60:63]
    v_mfma_f32_16x16x32_bf16 v[64:67], v[124:127], v[224:227], v[64:67]
    v_mfma_f32_16x16x32_bf16 v[68:71], v[128:131], v[224:227], v[68:71]
    s_waitcnt lgkmcnt(10)
    s_waitcnt vmcnt(12)
    v_mfma_f32_16x16x32_bf16 v[52:55], v[132:135], v[228:231], v[52:55]
    ds_read_b128 v[112:115], v50 offset:26624
    ds_read_b128 v[116:119], v50 offset:27648
    ds_read_b128 v[120:123], v50 offset:28672
    v_mfma_f32_16x16x32_bf16 v[56:59], v[136:139], v[228:231], v[56:59]
    ds_read_b128 v[124:127], v50 offset:29696
    ds_read_b128 v[128:131], v50 offset:30720
    v_mfma_f32_16x16x32_bf16 v[60:63], v[140:143], v[228:231], v[60:63]
    v_mfma_f32_16x16x32_bf16 v[64:67], v[144:147], v[228:231], v[64:67]
    v_mfma_f32_16x16x32_bf16 v[68:71], v[148:151], v[228:231], v[68:71]
    s_waitcnt lgkmcnt(10)
    s_waitcnt vmcnt(11)
    v_mfma_f32_16x16x32_bf16 v[52:55], v[72:75], v[232:235], v[52:55]
    ds_read_b128 v[132:135], v50 offset:31744
    ds_read_b128 v[136:139], v50 offset:32768
    ds_read_b128 v[140:143], v50 offset:33792
    v_mfma_f32_16x16x32_bf16 v[56:59], v[76:79], v[232:235], v[56:59]
    ds_read_b128 v[144:147], v50 offset:34816
    ds_read_b128 v[148:151], v50 offset:35840
    v_mfma_f32_16x16x32_bf16 v[60:63], v[80:83], v[232:235], v[60:63]
    v_mfma_f32_16x16x32_bf16 v[64:67], v[84:87], v[232:235], v[64:67]
    v_mfma_f32_16x16x32_bf16 v[68:71], v[88:91], v[232:235], v[68:71]
    s_waitcnt lgkmcnt(0)
    s_barrier
    s_waitcnt vmcnt(10)
    v_mfma_f32_16x16x32_bf16 v[52:55], v[92:95], v[236:239], v[52:55]
    ds_read_b128 v[72:75], v50 offset:36864
    ds_read_b128 v[76:79], v50 offset:37888
    ds_read_b128 v[80:83], v50 offset:38912
    v_mfma_f32_16x16x32_bf16 v[56:59], v[96:99], v[236:239], v[56:59]
    ds_read_b128 v[84:87], v50 offset:39936
    ds_read_b128 v[88:91], v50 offset:40960
    v_mfma_f32_16x16x32_bf16 v[60:63], v[100:103], v[236:239], v[60:63]
    v_mfma_f32_16x16x32_bf16 v[64:67], v[104:107], v[236:239], v[64:67]
    v_mfma_f32_16x16x32_bf16 v[68:71], v[108:111], v[236:239], v[68:71]
    s_mov_b32 s41, 55296
    buffer_load_dwordx4 v[200:203], v10, s[16:19], s41 offen sc1
    s_mov_b32 s41, 56320
    buffer_load_dwordx4 v[204:207], v10, s[16:19], s41 offen sc1
    s_mov_b32 s41, 57344
    buffer_load_dwordx4 v[208:211], v10, s[16:19], s41 offen sc1
    s_mov_b32 s41, 58368
    buffer_load_dwordx4 v[212:215], v10, s[16:19], s41 offen sc1
    s_waitcnt lgkmcnt(10)
    s_waitcnt vmcnt(13)
    v_mfma_f32_16x16x32_bf16 v[52:55], v[112:115], v[240:243], v[52:55]
    ds_read_b128 v[92:95], v50 offset:41984
    ds_read_b128 v[96:99], v50 offset:43008
    ds_read_b128 v[100:103], v50 offset:44032
    v_mfma_f32_16x16x32_bf16 v[56:59], v[116:119], v[240:243], v[56:59]
    ds_read_b128 v[104:107], v50 offset:45056
    ds_read_b128 v[108:111], v50 offset:46080
    v_mfma_f32_16x16x32_bf16 v[60:63], v[120:123], v[240:243], v[60:63]
    v_mfma_f32_16x16x32_bf16 v[64:67], v[124:127], v[240:243], v[64:67]
    v_mfma_f32_16x16x32_bf16 v[68:71], v[128:131], v[240:243], v[68:71]
    s_mov_b32 s41, 59392
    buffer_load_dwordx4 v[216:219], v10, s[16:19], s41 offen sc1
    s_mov_b32 s41, 60416
    buffer_load_dwordx4 v[220:223], v10, s[16:19], s41 offen sc1
    s_mov_b32 s41, 61440
    buffer_load_dwordx4 v[224:227], v10, s[16:19], s41 offen sc1
    s_mov_b32 s41, 62464
    buffer_load_dwordx4 v[228:231], v10, s[16:19], s41 offen sc1
    s_waitcnt lgkmcnt(10)
    s_waitcnt vmcnt(16)
    v_mfma_f32_16x16x32_bf16 v[52:55], v[132:135], v[244:247], v[52:55]
    ds_read_b128 v[112:115], v50 offset:47104
    ds_read_b128 v[116:119], v50 offset:48128
    ds_read_b128 v[120:123], v50 offset:49152
    v_mfma_f32_16x16x32_bf16 v[56:59], v[136:139], v[244:247], v[56:59]
    ds_read_b128 v[124:127], v50 offset:50176
    ds_read_b128 v[128:131], v50 offset:51200
    v_mfma_f32_16x16x32_bf16 v[60:63], v[140:143], v[244:247], v[60:63]
    v_mfma_f32_16x16x32_bf16 v[64:67], v[144:147], v[244:247], v[64:67]
    v_mfma_f32_16x16x32_bf16 v[68:71], v[148:151], v[244:247], v[68:71]
    s_mov_b32 s41, 63488
    buffer_load_dwordx4 v[232:235], v10, s[16:19], s41 offen sc1
    s_mov_b32 s41, 64512
    buffer_load_dwordx4 v[236:239], v10, s[16:19], s41 offen sc1
    s_mov_b32 s41, 65536
    buffer_load_dwordx4 v[240:243], v10, s[16:19], s41 offen sc1
    s_mov_b32 s41, 66560
    buffer_load_dwordx4 v[244:247], v10, s[16:19], s41 offen sc1
    s_waitcnt lgkmcnt(10)
    s_waitcnt vmcnt(19)
    v_mfma_f32_16x16x32_bf16 v[52:55], v[72:75], v[248:251], v[52:55]
    ds_read_b128 v[132:135], v50 offset:52224
    ds_read_b128 v[136:139], v50 offset:53248
    ds_read_b128 v[140:143], v50 offset:54272
    v_mfma_f32_16x16x32_bf16 v[56:59], v[76:79], v[248:251], v[56:59]
    ds_read_b128 v[144:147], v50 offset:55296
    ds_read_b128 v[148:151], v50 offset:56320
    v_mfma_f32_16x16x32_bf16 v[60:63], v[80:83], v[248:251], v[60:63]
    v_mfma_f32_16x16x32_bf16 v[64:67], v[84:87], v[248:251], v[64:67]
    v_mfma_f32_16x16x32_bf16 v[68:71], v[88:91], v[248:251], v[68:71]
    s_mov_b32 s41, 67584
    buffer_load_dwordx4 v[248:251], v10, s[16:19], s41 offen sc1
    s_waitcnt lgkmcnt(0)
    s_barrier
    s_waitcnt vmcnt(19)
    v_mfma_f32_16x16x32_bf16 v[52:55], v[92:95], v[252:255], v[52:55]
    ds_read_b128 v[72:75], v50 offset:57344
    ds_read_b128 v[76:79], v50 offset:58368
    ds_read_b128 v[80:83], v50 offset:59392
    v_mfma_f32_16x16x32_bf16 v[56:59], v[96:99], v[252:255], v[56:59]
    ds_read_b128 v[84:87], v50 offset:60416
    ds_read_b128 v[88:91], v50 offset:61440
    v_mfma_f32_16x16x32_bf16 v[60:63], v[100:103], v[252:255], v[60:63]
    v_mfma_f32_16x16x32_bf16 v[64:67], v[104:107], v[252:255], v[64:67]
    v_mfma_f32_16x16x32_bf16 v[68:71], v[108:111], v[252:255], v[68:71]
    s_mov_b32 s41, 68608
    buffer_load_dwordx4 v[252:255], v10, s[16:19], s41 offen sc1
    s_waitcnt lgkmcnt(10)
    s_waitcnt vmcnt(19)
    v_mfma_f32_16x16x32_bf16 v[52:55], v[112:115], v[176:179], v[52:55]
    ds_read_b128 v[92:95], v50 offset:62464
    ds_read_b128 v[96:99], v50 offset:63488
    ds_read_b128 v[100:103], v50 offset:64512
    v_mfma_f32_16x16x32_bf16 v[56:59], v[116:119], v[176:179], v[56:59]
    ds_read_b128 v[104:107], v51 offset:0
    ds_read_b128 v[108:111], v51 offset:1024
    v_mfma_f32_16x16x32_bf16 v[60:63], v[120:123], v[176:179], v[60:63]
    v_mfma_f32_16x16x32_bf16 v[64:67], v[124:127], v[176:179], v[64:67]
    v_mfma_f32_16x16x32_bf16 v[68:71], v[128:131], v[176:179], v[68:71]
    s_mov_b32 s41, 69632
    buffer_load_dwordx4 v[176:179], v10, s[16:19], s41 offen sc1
    s_waitcnt lgkmcnt(10)
    s_waitcnt vmcnt(19)
    v_mfma_f32_16x16x32_bf16 v[52:55], v[132:135], v[180:183], v[52:55]
    ds_read_b128 v[112:115], v51 offset:2048
    ds_read_b128 v[116:119], v51 offset:3072
    ds_read_b128 v[120:123], v51 offset:4096
    v_mfma_f32_16x16x32_bf16 v[56:59], v[136:139], v[180:183], v[56:59]
    ds_read_b128 v[124:127], v51 offset:5120
    ds_read_b128 v[128:131], v51 offset:6144
    v_mfma_f32_16x16x32_bf16 v[60:63], v[140:143], v[180:183], v[60:63]
    v_mfma_f32_16x16x32_bf16 v[64:67], v[144:147], v[180:183], v[64:67]
    v_mfma_f32_16x16x32_bf16 v[68:71], v[148:151], v[180:183], v[68:71]
    s_mov_b32 s41, 70656
    buffer_load_dwordx4 v[180:183], v10, s[16:19], s41 offen sc1
    s_waitcnt lgkmcnt(10)
    s_waitcnt vmcnt(19)
    v_mfma_f32_16x16x32_bf16 v[52:55], v[72:75], v[184:187], v[52:55]
    ds_read_b128 v[132:135], v51 offset:7168
    ds_read_b128 v[136:139], v51 offset:8192
    ds_read_b128 v[140:143], v51 offset:9216
    v_mfma_f32_16x16x32_bf16 v[56:59], v[76:79], v[184:187], v[56:59]
    ds_read_b128 v[144:147], v51 offset:10240
    ds_read_b128 v[148:151], v51 offset:11264
    v_mfma_f32_16x16x32_bf16 v[60:63], v[80:83], v[184:187], v[60:63]
    v_mfma_f32_16x16x32_bf16 v[64:67], v[84:87], v[184:187], v[64:67]
    v_mfma_f32_16x16x32_bf16 v[68:71], v[88:91], v[184:187], v[68:71]
    s_mov_b32 s41, 71680
    buffer_load_dwordx4 v[184:187], v10, s[16:19], s41 offen sc1
    s_waitcnt lgkmcnt(0)
    s_barrier
    s_waitcnt vmcnt(19)
    v_mfma_f32_16x16x32_bf16 v[52:55], v[92:95], v[188:191], v[52:55]
    ds_read_b128 v[72:75], v10 offset:0
    ds_read_b128 v[76:79], v10 offset:1024
    ds_read_b128 v[80:83], v10 offset:2048
    v_mfma_f32_16x16x32_bf16 v[56:59], v[96:99], v[188:191], v[56:59]
    ds_read_b128 v[84:87], v10 offset:3072
    ds_read_b128 v[88:91], v10 offset:4096
    v_mfma_f32_16x16x32_bf16 v[60:63], v[100:103], v[188:191], v[60:63]
    v_mfma_f32_16x16x32_bf16 v[64:67], v[104:107], v[188:191], v[64:67]
    v_mfma_f32_16x16x32_bf16 v[68:71], v[108:111], v[188:191], v[68:71]
    s_mov_b32 s41, 72704
    buffer_load_dwordx4 v[188:191], v10, s[16:19], s41 offen sc1
    s_waitcnt lgkmcnt(10)
    s_waitcnt vmcnt(19)
    v_mfma_f32_16x16x32_bf16 v[52:55], v[112:115], v[192:195], v[52:55]
    ds_read_b128 v[92:95], v10 offset:5120
    ds_read_b128 v[96:99], v10 offset:6144
    ds_read_b128 v[100:103], v10 offset:7168
    v_mfma_f32_16x16x32_bf16 v[56:59], v[116:119], v[192:195], v[56:59]
    ds_read_b128 v[104:107], v10 offset:8192
    ds_read_b128 v[108:111], v10 offset:9216
    v_mfma_f32_16x16x32_bf16 v[60:63], v[120:123], v[192:195], v[60:63]
    v_mfma_f32_16x16x32_bf16 v[64:67], v[124:127], v[192:195], v[64:67]
    v_mfma_f32_16x16x32_bf16 v[68:71], v[128:131], v[192:195], v[68:71]
    s_mov_b32 s41, 73728
    buffer_load_dwordx4 v[192:195], v10, s[16:19], s41 offen sc1
    s_waitcnt lgkmcnt(10)
    s_waitcnt vmcnt(19)
    v_mfma_f32_16x16x32_bf16 v[52:55], v[132:135], v[196:199], v[52:55]
    ds_read_b128 v[112:115], v10 offset:10240
    ds_read_b128 v[116:119], v10 offset:11264
    ds_read_b128 v[120:123], v10 offset:12288
    v_mfma_f32_16x16x32_bf16 v[56:59], v[136:139], v[196:199], v[56:59]
    ds_read_b128 v[124:127], v10 offset:13312
    ds_read_b128 v[128:131], v10 offset:14336
    v_mfma_f32_16x16x32_bf16 v[60:63], v[140:143], v[196:199], v[60:63]
    v_mfma_f32_16x16x32_bf16 v[64:67], v[144:147], v[196:199], v[64:67]
    v_mfma_f32_16x16x32_bf16 v[68:71], v[148:151], v[196:199], v[68:71]
    s_mov_b32 s41, 74752
    buffer_load_dwordx4 v[196:199], v10, s[16:19], s41 offen sc1
    s_waitcnt lgkmcnt(10)
    s_waitcnt vmcnt(19)
    v_mfma_f32_16x16x32_bf16 v[52:55], v[72:75], v[200:203], v[52:55]
    ds_read_b128 v[132:135], v10 offset:15360
    ds_read_b128 v[136:139], v10 offset:16384
    ds_read_b128 v[140:143], v10 offset:17408
    v_mfma_f32_16x16x32_bf16 v[56:59], v[76:79], v[200:203], v[56:59]
    ds_read_b128 v[144:147], v10 offset:18432
    ds_read_b128 v[148:151], v10 offset:19456
    v_mfma_f32_16x16x32_bf16 v[60:63], v[80:83], v[200:203], v[60:63]
    v_mfma_f32_16x16x32_bf16 v[64:67], v[84:87], v[200:203], v[64:67]
    v_mfma_f32_16x16x32_bf16 v[68:71], v[88:91], v[200:203], v[68:71]
    s_waitcnt lgkmcnt(0)
    s_barrier
    s_waitcnt vmcnt(18)
    v_mfma_f32_16x16x32_bf16 v[52:55], v[92:95], v[204:207], v[52:55]
    ds_read_b128 v[72:75], v10 offset:20480
    ds_read_b128 v[76:79], v10 offset:21504
    ds_read_b128 v[80:83], v10 offset:22528
    v_mfma_f32_16x16x32_bf16 v[56:59], v[96:99], v[204:207], v[56:59]
    ds_read_b128 v[84:87], v10 offset:23552
    ds_read_b128 v[88:91], v10 offset:24576
    v_mfma_f32_16x16x32_bf16 v[60:63], v[100:103], v[204:207], v[60:63]
    v_mfma_f32_16x16x32_bf16 v[64:67], v[104:107], v[204:207], v[64:67]
    v_mfma_f32_16x16x32_bf16 v[68:71], v[108:111], v[204:207], v[68:71]
    s_waitcnt lgkmcnt(10)
    s_waitcnt vmcnt(17)
    v_mfma_f32_16x16x32_bf16 v[52:55], v[112:115], v[208:211], v[52:55]
    ds_read_b128 v[92:95], v10 offset:25600
    ds_read_b128 v[96:99], v10 offset:26624
    ds_read_b128 v[100:103], v10 offset:27648
    v_mfma_f32_16x16x32_bf16 v[56:59], v[116:119], v[208:211], v[56:59]
    ds_read_b128 v[104:107], v10 offset:28672
    ds_read_b128 v[108:111], v10 offset:29696
    v_mfma_f32_16x16x32_bf16 v[60:63], v[120:123], v[208:211], v[60:63]
    v_mfma_f32_16x16x32_bf16 v[64:67], v[124:127], v[208:211], v[64:67]
    v_mfma_f32_16x16x32_bf16 v[68:71], v[128:131], v[208:211], v[68:71]
    s_waitcnt lgkmcnt(10)
    s_waitcnt vmcnt(16)
    v_mfma_f32_16x16x32_bf16 v[52:55], v[132:135], v[212:215], v[52:55]
    ds_read_b128 v[112:115], v10 offset:30720
    ds_read_b128 v[116:119], v10 offset:31744
    ds_read_b128 v[120:123], v10 offset:32768
    v_mfma_f32_16x16x32_bf16 v[56:59], v[136:139], v[212:215], v[56:59]
    ds_read_b128 v[124:127], v10 offset:33792
    ds_read_b128 v[128:131], v10 offset:34816
    v_mfma_f32_16x16x32_bf16 v[60:63], v[140:143], v[212:215], v[60:63]
    v_mfma_f32_16x16x32_bf16 v[64:67], v[144:147], v[212:215], v[64:67]
    v_mfma_f32_16x16x32_bf16 v[68:71], v[148:151], v[212:215], v[68:71]
    s_waitcnt lgkmcnt(10)
    s_waitcnt vmcnt(15)
    v_mfma_f32_16x16x32_bf16 v[52:55], v[72:75], v[216:219], v[52:55]
    ds_read_b128 v[132:135], v10 offset:35840
    ds_read_b128 v[136:139], v10 offset:36864
    ds_read_b128 v[140:143], v10 offset:37888
    v_mfma_f32_16x16x32_bf16 v[56:59], v[76:79], v[216:219], v[56:59]
    ds_read_b128 v[144:147], v10 offset:38912
    ds_read_b128 v[148:151], v10 offset:39936
    v_mfma_f32_16x16x32_bf16 v[60:63], v[80:83], v[216:219], v[60:63]
    v_mfma_f32_16x16x32_bf16 v[64:67], v[84:87], v[216:219], v[64:67]
    v_mfma_f32_16x16x32_bf16 v[68:71], v[88:91], v[216:219], v[68:71]
    s_waitcnt lgkmcnt(0)
    s_barrier
    s_waitcnt vmcnt(14)
    v_mfma_f32_16x16x32_bf16 v[52:55], v[92:95], v[220:223], v[52:55]
    ds_read_b128 v[72:75], v10 offset:40960
    ds_read_b128 v[76:79], v10 offset:41984
    ds_read_b128 v[80:83], v10 offset:43008
    v_mfma_f32_16x16x32_bf16 v[56:59], v[96:99], v[220:223], v[56:59]
    ds_read_b128 v[84:87], v10 offset:44032
    ds_read_b128 v[88:91], v10 offset:45056
    v_mfma_f32_16x16x32_bf16 v[60:63], v[100:103], v[220:223], v[60:63]
    v_mfma_f32_16x16x32_bf16 v[64:67], v[104:107], v[220:223], v[64:67]
    v_mfma_f32_16x16x32_bf16 v[68:71], v[108:111], v[220:223], v[68:71]
    s_waitcnt lgkmcnt(10)
    s_waitcnt vmcnt(13)
    v_mfma_f32_16x16x32_bf16 v[52:55], v[112:115], v[224:227], v[52:55]
    ds_read_b128 v[92:95], v10 offset:46080
    ds_read_b128 v[96:99], v10 offset:47104
    ds_read_b128 v[100:103], v10 offset:48128
    v_mfma_f32_16x16x32_bf16 v[56:59], v[116:119], v[224:227], v[56:59]
    ds_read_b128 v[104:107], v10 offset:49152
    ds_read_b128 v[108:111], v10 offset:50176
    v_mfma_f32_16x16x32_bf16 v[60:63], v[120:123], v[224:227], v[60:63]
    v_mfma_f32_16x16x32_bf16 v[64:67], v[124:127], v[224:227], v[64:67]
    v_mfma_f32_16x16x32_bf16 v[68:71], v[128:131], v[224:227], v[68:71]
    s_waitcnt lgkmcnt(10)
    s_waitcnt vmcnt(12)
    v_mfma_f32_16x16x32_bf16 v[52:55], v[132:135], v[228:231], v[52:55]
    ds_read_b128 v[112:115], v10 offset:51200
    ds_read_b128 v[116:119], v10 offset:52224
    ds_read_b128 v[120:123], v10 offset:53248
    v_mfma_f32_16x16x32_bf16 v[56:59], v[136:139], v[228:231], v[56:59]
    ds_read_b128 v[124:127], v10 offset:54272
    ds_read_b128 v[128:131], v10 offset:55296
    v_mfma_f32_16x16x32_bf16 v[60:63], v[140:143], v[228:231], v[60:63]
    v_mfma_f32_16x16x32_bf16 v[64:67], v[144:147], v[228:231], v[64:67]
    v_mfma_f32_16x16x32_bf16 v[68:71], v[148:151], v[228:231], v[68:71]
    s_waitcnt lgkmcnt(10)
    s_waitcnt vmcnt(11)
    v_mfma_f32_16x16x32_bf16 v[52:55], v[72:75], v[232:235], v[52:55]
    ds_read_b128 v[132:135], v10 offset:56320
    ds_read_b128 v[136:139], v10 offset:57344
    ds_read_b128 v[140:143], v10 offset:58368
    v_mfma_f32_16x16x32_bf16 v[56:59], v[76:79], v[232:235], v[56:59]
    ds_read_b128 v[144:147], v10 offset:59392
    ds_read_b128 v[148:151], v10 offset:60416
    v_mfma_f32_16x16x32_bf16 v[60:63], v[80:83], v[232:235], v[60:63]
    v_mfma_f32_16x16x32_bf16 v[64:67], v[84:87], v[232:235], v[64:67]
    v_mfma_f32_16x16x32_bf16 v[68:71], v[88:91], v[232:235], v[68:71]
    s_waitcnt lgkmcnt(0)
    s_barrier
    s_waitcnt vmcnt(10)
    v_mfma_f32_16x16x32_bf16 v[52:55], v[92:95], v[236:239], v[52:55]
    ds_read_b128 v[72:75], v10 offset:61440
    ds_read_b128 v[76:79], v10 offset:62464
    ds_read_b128 v[80:83], v10 offset:63488
    v_mfma_f32_16x16x32_bf16 v[56:59], v[96:99], v[236:239], v[56:59]
    ds_read_b128 v[84:87], v10 offset:64512
    ds_read_b128 v[88:91], v50 offset:0
    v_mfma_f32_16x16x32_bf16 v[60:63], v[100:103], v[236:239], v[60:63]
    v_mfma_f32_16x16x32_bf16 v[64:67], v[104:107], v[236:239], v[64:67]
    v_mfma_f32_16x16x32_bf16 v[68:71], v[108:111], v[236:239], v[68:71]
    s_waitcnt lgkmcnt(10)
    s_waitcnt vmcnt(9)
    v_mfma_f32_16x16x32_bf16 v[52:55], v[112:115], v[240:243], v[52:55]
    ds_read_b128 v[92:95], v50 offset:1024
    ds_read_b128 v[96:99], v50 offset:2048
    ds_read_b128 v[100:103], v50 offset:3072
    v_mfma_f32_16x16x32_bf16 v[56:59], v[116:119], v[240:243], v[56:59]
    ds_read_b128 v[104:107], v50 offset:4096
    ds_read_b128 v[108:111], v50 offset:5120
    v_mfma_f32_16x16x32_bf16 v[60:63], v[120:123], v[240:243], v[60:63]
    v_mfma_f32_16x16x32_bf16 v[64:67], v[124:127], v[240:243], v[64:67]
    v_mfma_f32_16x16x32_bf16 v[68:71], v[128:131], v[240:243], v[68:71]
    s_waitcnt lgkmcnt(10)
    s_waitcnt vmcnt(8)
    v_mfma_f32_16x16x32_bf16 v[52:55], v[132:135], v[244:247], v[52:55]
    ds_read_b128 v[112:115], v50 offset:6144
    ds_read_b128 v[116:119], v50 offset:7168
    ds_read_b128 v[120:123], v50 offset:8192
    v_mfma_f32_16x16x32_bf16 v[56:59], v[136:139], v[244:247], v[56:59]
    ds_read_b128 v[124:127], v50 offset:9216
    ds_read_b128 v[128:131], v50 offset:10240
    v_mfma_f32_16x16x32_bf16 v[60:63], v[140:143], v[244:247], v[60:63]
    v_mfma_f32_16x16x32_bf16 v[64:67], v[144:147], v[244:247], v[64:67]
    v_mfma_f32_16x16x32_bf16 v[68:71], v[148:151], v[244:247], v[68:71]
    s_waitcnt lgkmcnt(10)
    s_waitcnt vmcnt(7)
    v_mfma_f32_16x16x32_bf16 v[52:55], v[72:75], v[248:251], v[52:55]
    ds_read_b128 v[132:135], v50 offset:11264
    ds_read_b128 v[136:139], v50 offset:12288
    ds_read_b128 v[140:143], v50 offset:13312
    v_mfma_f32_16x16x32_bf16 v[56:59], v[76:79], v[248:251], v[56:59]
    ds_read_b128 v[144:147], v50 offset:14336
    ds_read_b128 v[148:151], v50 offset:15360
    v_mfma_f32_16x16x32_bf16 v[60:63], v[80:83], v[248:251], v[60:63]
    v_mfma_f32_16x16x32_bf16 v[64:67], v[84:87], v[248:251], v[64:67]
    v_mfma_f32_16x16x32_bf16 v[68:71], v[88:91], v[248:251], v[68:71]
    s_waitcnt lgkmcnt(0)
    s_barrier
    s_waitcnt vmcnt(6)
    v_mfma_f32_16x16x32_bf16 v[52:55], v[92:95], v[252:255], v[52:55]
    ds_read_b128 v[72:75], v50 offset:16384
    ds_read_b128 v[76:79], v50 offset:17408
    ds_read_b128 v[80:83], v50 offset:18432
    v_mfma_f32_16x16x32_bf16 v[56:59], v[96:99], v[252:255], v[56:59]
    ds_read_b128 v[84:87], v50 offset:19456
    ds_read_b128 v[88:91], v50 offset:20480
    v_mfma_f32_16x16x32_bf16 v[60:63], v[100:103], v[252:255], v[60:63]
    v_mfma_f32_16x16x32_bf16 v[64:67], v[104:107], v[252:255], v[64:67]
    v_mfma_f32_16x16x32_bf16 v[68:71], v[108:111], v[252:255], v[68:71]
    s_waitcnt lgkmcnt(10)
    s_waitcnt vmcnt(5)
    v_mfma_f32_16x16x32_bf16 v[52:55], v[112:115], v[176:179], v[52:55]
    ds_read_b128 v[92:95], v50 offset:21504
    ds_read_b128 v[96:99], v50 offset:22528
    ds_read_b128 v[100:103], v50 offset:23552
    v_mfma_f32_16x16x32_bf16 v[56:59], v[116:119], v[176:179], v[56:59]
    ds_read_b128 v[104:107], v50 offset:24576
    ds_read_b128 v[108:111], v50 offset:25600
    v_mfma_f32_16x16x32_bf16 v[60:63], v[120:123], v[176:179], v[60:63]
    v_mfma_f32_16x16x32_bf16 v[64:67], v[124:127], v[176:179], v[64:67]
    v_mfma_f32_16x16x32_bf16 v[68:71], v[128:131], v[176:179], v[68:71]
    s_waitcnt lgkmcnt(10)
    s_waitcnt vmcnt(4)
    v_mfma_f32_16x16x32_bf16 v[52:55], v[132:135], v[180:183], v[52:55]
    ds_read_b128 v[112:115], v50 offset:26624
    ds_read_b128 v[116:119], v50 offset:27648
    ds_read_b128 v[120:123], v50 offset:28672
    v_mfma_f32_16x16x32_bf16 v[56:59], v[136:139], v[180:183], v[56:59]
    ds_read_b128 v[124:127], v50 offset:29696
    ds_read_b128 v[128:131], v50 offset:30720
    v_mfma_f32_16x16x32_bf16 v[60:63], v[140:143], v[180:183], v[60:63]
    v_mfma_f32_16x16x32_bf16 v[64:67], v[144:147], v[180:183], v[64:67]
    v_mfma_f32_16x16x32_bf16 v[68:71], v[148:151], v[180:183], v[68:71]
    s_waitcnt lgkmcnt(10)
    s_waitcnt vmcnt(3)
    v_mfma_f32_16x16x32_bf16 v[52:55], v[72:75], v[184:187], v[52:55]
    ds_read_b128 v[132:135], v50 offset:31744
    ds_read_b128 v[136:139], v50 offset:32768
    ds_read_b128 v[140:143], v50 offset:33792
    v_mfma_f32_16x16x32_bf16 v[56:59], v[76:79], v[184:187], v[56:59]
    ds_read_b128 v[144:147], v50 offset:34816
    ds_read_b128 v[148:151], v50 offset:35840
    v_mfma_f32_16x16x32_bf16 v[60:63], v[80:83], v[184:187], v[60:63]
    v_mfma_f32_16x16x32_bf16 v[64:67], v[84:87], v[184:187], v[64:67]
    v_mfma_f32_16x16x32_bf16 v[68:71], v[88:91], v[184:187], v[68:71]
    s_waitcnt lgkmcnt(10)
    s_waitcnt vmcnt(2)
    v_mfma_f32_16x16x32_bf16 v[52:55], v[92:95], v[188:191], v[52:55]
    v_mfma_f32_16x16x32_bf16 v[56:59], v[96:99], v[188:191], v[56:59]
    v_mfma_f32_16x16x32_bf16 v[60:63], v[100:103], v[188:191], v[60:63]
    v_mfma_f32_16x16x32_bf16 v[64:67], v[104:107], v[188:191], v[64:67]
    v_mfma_f32_16x16x32_bf16 v[68:71], v[108:111], v[188:191], v[68:71]
    s_waitcnt lgkmcnt(5)
    s_waitcnt vmcnt(1)
    v_mfma_f32_16x16x32_bf16 v[52:55], v[112:115], v[192:195], v[52:55]
    v_mfma_f32_16x16x32_bf16 v[56:59], v[116:119], v[192:195], v[56:59]
    v_mfma_f32_16x16x32_bf16 v[60:63], v[120:123], v[192:195], v[60:63]
    v_mfma_f32_16x16x32_bf16 v[64:67], v[124:127], v[192:195], v[64:67]
    v_mfma_f32_16x16x32_bf16 v[68:71], v[128:131], v[192:195], v[68:71]
    s_waitcnt lgkmcnt(0)
    s_waitcnt vmcnt(0)
    v_mfma_f32_16x16x32_bf16 v[52:55], v[132:135], v[196:199], v[52:55]
    v_mfma_f32_16x16x32_bf16 v[56:59], v[136:139], v[196:199], v[56:59]
    v_mfma_f32_16x16x32_bf16 v[60:63], v[140:143], v[196:199], v[60:63]
    v_mfma_f32_16x16x32_bf16 v[64:67], v[144:147], v[196:199], v[64:67]
    v_mfma_f32_16x16x32_bf16 v[68:71], v[148:151], v[196:199], v[68:71]
    s_waitcnt vmcnt(0)
    v_lshlrev_b32 v20, 16, v30
    v_and_b32 v21, 0xffff0000, v30
    v_lshlrev_b32 v22, 16, v40
    v_and_b32 v23, 0xffff0000, v40
    v_add_f32 v112, v20, v22
    v_add_f32 v113, v21, v23
    v_lshlrev_b32 v20, 16, v31
    v_and_b32 v21, 0xffff0000, v31
    v_lshlrev_b32 v22, 16, v41
    v_and_b32 v23, 0xffff0000, v41
    v_add_f32 v114, v20, v22
    v_add_f32 v115, v21, v23
    v_lshlrev_b32 v20, 16, v32
    v_and_b32 v21, 0xffff0000, v32
    v_lshlrev_b32 v22, 16, v42
    v_and_b32 v23, 0xffff0000, v42
    v_add_f32 v116, v20, v22
    v_add_f32 v117, v21, v23
    v_lshlrev_b32 v20, 16, v33
    v_and_b32 v21, 0xffff0000, v33
    v_lshlrev_b32 v22, 16, v43
    v_and_b32 v23, 0xffff0000, v43
    v_add_f32 v118, v20, v22
    v_add_f32 v119, v21, v23
    v_lshlrev_b32 v20, 16, v34
    v_and_b32 v21, 0xffff0000, v34
    v_lshlrev_b32 v22, 16, v44
    v_and_b32 v23, 0xffff0000, v44
    v_add_f32 v120, v20, v22
    v_add_f32 v121, v21, v23
    v_lshlrev_b32 v20, 16, v35
    v_and_b32 v21, 0xffff0000, v35
    v_lshlrev_b32 v22, 16, v45
    v_and_b32 v23, 0xffff0000, v45
    v_add_f32 v122, v20, v22
    v_add_f32 v123, v21, v23
    v_lshlrev_b32 v20, 16, v36
    v_and_b32 v21, 0xffff0000, v36
    v_lshlrev_b32 v22, 16, v46
    v_and_b32 v23, 0xffff0000, v46
    v_add_f32 v124, v20, v22
    v_add_f32 v125, v21, v23
    v_lshlrev_b32 v20, 16, v37
    v_and_b32 v21, 0xffff0000, v37
    v_lshlrev_b32 v22, 16, v47
    v_and_b32 v23, 0xffff0000, v47
    v_add_f32 v126, v20, v22
    v_add_f32 v127, v21, v23
    v_lshlrev_b32 v20, 16, v38
    v_and_b32 v21, 0xffff0000, v38
    v_lshlrev_b32 v22, 16, v48
    v_and_b32 v23, 0xffff0000, v48
    v_add_f32 v128, v20, v22
    v_add_f32 v129, v21, v23
    v_lshlrev_b32 v20, 16, v39
    v_and_b32 v21, 0xffff0000, v39
    v_lshlrev_b32 v22, 16, v49
    v_and_b32 v23, 0xffff0000, v49
    v_add_f32 v130, v20, v22
    v_add_f32 v131, v21, v23
    v_add_f32 v52, v52, v112
    v_add_f32 v53, v53, v113
    v_add_f32 v54, v54, v114
    v_add_f32 v55, v55, v115
    v_add_f32 v56, v56, v116
    v_add_f32 v57, v57, v117
    v_add_f32 v58, v58, v118
    v_add_f32 v59, v59, v119
    v_add_f32 v60, v60, v120
    v_add_f32 v61, v61, v121
    v_add_f32 v62, v62, v122
    v_add_f32 v63, v63, v123
    v_add_f32 v64, v64, v124
    v_add_f32 v65, v65, v125
    v_add_f32 v66, v66, v126
    v_add_f32 v67, v67, v127
    v_add_f32 v68, v68, v128
    v_add_f32 v69, v69, v129
    v_add_f32 v70, v70, v130
    v_add_f32 v71, v71, v131
    v_cvt_pk_bf16_f32 v136, v52, v53
    v_cvt_pk_bf16_f32 v137, v54, v55
    v_cvt_pk_bf16_f32 v138, v56, v57
    v_cvt_pk_bf16_f32 v139, v58, v59
    v_cvt_pk_bf16_f32 v140, v60, v61
    v_cvt_pk_bf16_f32 v141, v62, v63
    v_cvt_pk_bf16_f32 v142, v64, v65
    v_cvt_pk_bf16_f32 v143, v66, v67
    v_cvt_pk_bf16_f32 v144, v68, v69
    v_cvt_pk_bf16_f32 v145, v70, v71
    buffer_store_dwordx4 v[136:139], v12, s[28:31], 0 offen
    buffer_store_dwordx4 v[140:143], v12, s[28:31], 0 offen offset:64
    buffer_store_dwordx2 v[144:145], v14, s[28:31], 0 offen offset:128
    s_endpgm
K2_LOADER:
    s_waitcnt lgkmcnt(0)
    s_mul_i32 s40, s50, 5120
    s_add_u32 s41, s40, 10485760
    s_add_u32 s20, s14, s41
    s_addc_u32 s21, s15, 0
    s_and_b32 s21, s21, 0xffff
    s_mov_b32 s22, 0
    s_mov_b32 s23, 0x00020000
    s_sub_u32 s22, 3031040, s40
    s_mul_i32 s57, s51, 40960
    s_mul_i32 s58, s51, 5120
    s_barrier
    s_add_u32 s40, s51, 0
    s_add_u32 s41, s40, s61
    s_sub_u32 s42, s41, 54
    s_cmp_lt_u32 s41, 54
    s_cselect_b32 s41, s41, s42
    s_mul_i32 s57, s41, 40960
    s_add_u32 m0, s58, 0
    s_nop 0
    buffer_load_dwordx4 v10, s[20:23], s57 offen offset:0 lds
    buffer_load_dwordx4 v10, s[20:23], s57 offen offset:1024 lds
    buffer_load_dwordx4 v10, s[20:23], s57 offen offset:2048 lds
    buffer_load_dwordx4 v10, s[20:23], s57 offen offset:3072 lds
    s_add_u32 m0, s58, 4096
    s_nop 0
    buffer_load_dwordx4 v11, s[20:23], s57 offen lds
    s_add_u32 s40, s51, 4
    s_add_u32 s41, s40, s61
    s_sub_u32 s42, s41, 54
    s_cmp_lt_u32 s41, 54
    s_cselect_b32 s41, s41, s42
    s_mul_i32 s57, s41, 40960
    s_add_u32 m0, s58, 20480
    s_nop 0
    buffer_load_dwordx4 v10, s[20:23], s57 offen offset:0 lds
    buffer_load_dwordx4 v10, s[20:23], s57 offen offset:1024 lds
    buffer_load_dwordx4 v10, s[20:23], s57 offen offset:2048 lds
    buffer_load_dwordx4 v10, s[20:23], s57 offen offset:3072 lds
    s_add_u32 m0, s58, 24576
    s_nop 0
    buffer_load_dwordx4 v11, s[20:23], s57 offen lds
    s_add_u32 s40, s51, 8
    s_add_u32 s41, s40, s61
    s_sub_u32 s42, s41, 54
    s_cmp_lt_u32 s41, 54
    s_cselect_b32 s41, s41, s42
    s_mul_i32 s57, s41, 40960
    s_add_u32 m0, s58, 40960
    s_nop 0
    buffer_load_dwordx4 v10, s[20:23], s57 offen offset:0 lds
    buffer_load_dwordx4 v10, s[20:23], s57 offen offset:1024 lds
    buffer_load_dwordx4 v10, s[20:23], s57 offen offset:2048 lds
    buffer_load_dwordx4 v10, s[20:23], s57 offen offset:3072 lds
    s_add_u32 m0, s58, 45056
    s_nop 0
    buffer_load_dwordx4 v11, s[20:23], s57 offen lds
    s_waitcnt vmcnt(10)
    s_add_u32 s40, s51, 12
    s_add_u32 s41, s40, s61
    s_sub_u32 s42, s41, 54
    s_cmp_lt_u32 s41, 54
    s_cselect_b32 s41, s41, s42
    s_mul_i32 s57, s41, 40960
    s_add_u32 m0, s58, 61440
    s_nop 0
    buffer_load_dwordx4 v10, s[20:23], s57 offen offset:0 lds
    buffer_load_dwordx4 v10, s[20:23], s57 offen offset:1024 lds
    buffer_load_dwordx4 v10, s[20:23], s57 offen offset:2048 lds
    buffer_load_dwordx4 v10, s[20:23], s57 offen offset:3072 lds
    s_add_u32 m0, s58, 65536
    s_nop 0
    buffer_load_dwordx4 v11, s[20:23], s57 offen lds
    s_waitcnt vmcnt(10)
    s_add_u32 s40, s51, 16
    s_add_u32 s41, s40, s61
    s_sub_u32 s42, s41, 54
    s_cmp_lt_u32 s41, 54
    s_cselect_b32 s41, s41, s42
    s_mul_i32 s57, s41, 40960
    s_add_u32 m0, s58, 81920
    s_nop 0
    buffer_load_dwordx4 v10, s[20:23], s57 offen offset:0 lds
    buffer_load_dwordx4 v10, s[20:23], s57 offen offset:1024 lds
    buffer_load_dwordx4 v10, s[20:23], s57 offen offset:2048 lds
    buffer_load_dwordx4 v10, s[20:23], s57 offen offset:3072 lds
    s_add_u32 m0, s58, 86016
    s_nop 0
    buffer_load_dwordx4 v11, s[20:23], s57 offen lds
    s_waitcnt vmcnt(10)
    s_add_u32 s40, s51, 20
    s_add_u32 s41, s40, s61
    s_sub_u32 s42, s41, 54
    s_cmp_lt_u32 s41, 54
    s_cselect_b32 s41, s41, s42
    s_mul_i32 s57, s41, 40960
    s_add_u32 m0, s58, 102400
    s_nop 0
    buffer_load_dwordx4 v10, s[20:23], s57 offen offset:0 lds
    buffer_load_dwordx4 v10, s[20:23], s57 offen offset:1024 lds
    buffer_load_dwordx4 v10, s[20:23], s57 offen offset:2048 lds
    buffer_load_dwordx4 v10, s[20:23], s57 offen offset:3072 lds
    s_add_u32 m0, s58, 106496
    s_nop 0
    buffer_load_dwordx4 v11, s[20:23], s57 offen lds
    s_waitcnt vmcnt(10)
    s_add_u32 s40, s51, 24
    s_add_u32 s41, s40, s61
    s_sub_u32 s42, s41, 54
    s_cmp_lt_u32 s41, 54
    s_cselect_b32 s41, s41, s42
    s_mul_i32 s57, s41, 40960
    s_add_u32 m0, s58, 122880
    s_nop 0
    buffer_load_dwordx4 v10, s[20:23], s57 offen offset:0 lds
    buffer_load_dwordx4 v10, s[20:23], s57 offen offset:1024 lds
    buffer_load_dwordx4 v10, s[20:23], s57 offen offset:2048 lds
    buffer_load_dwordx4 v10, s[20:23], s57 offen offset:3072 lds
    s_add_u32 m0, s58, 126976
    s_nop 0
    buffer_load_dwordx4 v11, s[20:23], s57 offen lds
    s_barrier
    s_waitcnt vmcnt(25)
    s_barrier
    s_add_u32 s40, s51, 28
    s_add_u32 s41, s40, s61
    s_sub_u32 s42, s41, 54
    s_cmp_lt_u32 s41, 54
    s_cselect_b32 s41, s41, s42
    s_mul_i32 s57, s41, 40960
    s_add_u32 m0, s58, 0
    s_nop 0
    buffer_load_dwordx4 v10, s[20:23], s57 offen offset:0 lds
    buffer_load_dwordx4 v10, s[20:23], s57 offen offset:1024 lds
    buffer_load_dwordx4 v10, s[20:23], s57 offen offset:2048 lds
    buffer_load_dwordx4 v10, s[20:23], s57 offen offset:3072 lds
    s_add_u32 m0, s58, 4096
    s_nop 0
    buffer_load_dwordx4 v11, s[20:23], s57 offen lds
    s_waitcnt vmcnt(25)
    s_barrier
    s_add_u32 s40, s51, 32
    s_add_u32 s41, s40, s61
    s_sub_u32 s42, s41, 54
    s_cmp_lt_u32 s41, 54
    s_cselect_b32 s41, s41, s42
    s_mul_i32 s57, s41, 40960
    s_add_u32 m0, s58, 20480
    s_nop 0
    buffer_load_dwordx4 v10, s[20:23], s57 offen offset:0 lds
    buffer_load_dwordx4 v10, s[20:23], s57 offen offset:1024 lds
    buffer_load_dwordx4 v10, s[20:23], s57 offen offset:2048 lds
    buffer_load_dwordx4 v10, s[20:23], s57 offen offset:3072 lds
    s_add_u32 m0, s58, 24576
    s_nop 0
    buffer_load_dwordx4 v11, s[20:23], s57 offen lds
    s_waitcnt vmcnt(25)
    s_barrier
    s_add_u32 s40, s51, 36
    s_add_u32 s41, s40, s61
    s_sub_u32 s42, s41, 54
    s_cmp_lt_u32 s41, 54
    s_cselect_b32 s41, s41, s42
    s_mul_i32 s57, s41, 40960
    s_add_u32 m0, s58, 40960
    s_nop 0
    buffer_load_dwordx4 v10, s[20:23], s57 offen offset:0 lds
    buffer_load_dwordx4 v10, s[20:23], s57 offen offset:1024 lds
    buffer_load_dwordx4 v10, s[20:23], s57 offen offset:2048 lds
    buffer_load_dwordx4 v10, s[20:23], s57 offen offset:3072 lds
    s_add_u32 m0, s58, 45056
    s_nop 0
    buffer_load_dwordx4 v11, s[20:23], s57 offen lds
    s_waitcnt vmcnt(25)
    s_barrier
    s_add_u32 s40, s51, 40
    s_add_u32 s41, s40, s61
    s_sub_u32 s42, s41, 54
    s_cmp_lt_u32 s41, 54
    s_cselect_b32 s41, s41, s42
    s_mul_i32 s57, s41, 40960
    s_add_u32 m0, s58, 61440
    s_nop 0
    buffer_load_dwordx4 v10, s[20:23], s57 offen offset:0 lds
    buffer_load_dwordx4 v10, s[20:23], s57 offen offset:1024 lds
    buffer_load_dwordx4 v10, s[20:23], s57 offen offset:2048 lds
    buffer_load_dwordx4 v10, s[20:23], s57 offen offset:3072 lds
    s_add_u32 m0, s58, 65536
    s_nop 0
    buffer_load_dwordx4 v11, s[20:23], s57 offen lds
    s_waitcnt vmcnt(25)
    s_barrier
    s_add_u32 s40, s51, 44
    s_add_u32 s41, s40, s61
    s_sub_u32 s42, s41, 54
    s_cmp_lt_u32 s41, 54
    s_cselect_b32 s41, s41, s42
    s_mul_i32 s57, s41, 40960
    s_add_u32 m0, s58, 81920
    s_nop 0
    buffer_load_dwordx4 v10, s[20:23], s57 offen offset:0 lds
    buffer_load_dwordx4 v10, s[20:23], s57 offen offset:1024 lds
    buffer_load_dwordx4 v10, s[20:23], s57 offen offset:2048 lds
    buffer_load_dwordx4 v10, s[20:23], s57 offen offset:3072 lds
    s_add_u32 m0, s58, 86016
    s_nop 0
    buffer_load_dwordx4 v11, s[20:23], s57 offen lds
    s_waitcnt vmcnt(25)
    s_barrier
    s_cmp_lg_u32 s48, 4
    s_cbranch_scc1 K2_NOARR
    s_lshl_b32 s40, s49, 7
    s_lshl_b32 s41, s50, 2
    s_add_u32 s40, s40, s41
    s_add_u32 s40, s40, 19664896
    v_mov_b32 v20, s40
    v_mov_b32 v21, s59
    s_mov_b64 s[44:45], exec
    s_mov_b64 exec, 1
    global_store_dword v20, v21, s[14:15] sc0 sc1
    s_mov_b64 exec, s[44:45]
K2_NOARR:
    s_add_u32 s40, s51, 48
    s_add_u32 s41, s40, s61
    s_sub_u32 s42, s41, 54
    s_cmp_lt_u32 s41, 54
    s_cselect_b32 s41, s41, s42
    s_mul_i32 s57, s41, 40960
    s_add_u32 m0, s58, 102400
    s_nop 0
    buffer_load_dwordx4 v10, s[20:23], s57 offen offset:0 lds
    buffer_load_dwordx4 v10, s[20:23], s57 offen offset:1024 lds
    buffer_load_dwordx4 v10, s[20:23], s57 offen offset:2048 lds
    buffer_load_dwordx4 v10, s[20:23], s57 offen offset:3072 lds
    s_add_u32 m0, s58, 106496
    s_nop 0
    buffer_load_dwordx4 v11, s[20:23], s57 offen lds
    s_waitcnt vmcnt(25)
    s_barrier
    s_add_u32 s40, s51, 52
    s_add_u32 s41, s40, s61
    s_sub_u32 s42, s41, 54
    s_cmp_lt_u32 s41, 54
    s_cselect_b32 s41, s41, s42
    s_mul_i32 s57, s41, 40960
    s_cmp_lt_u32 s40, 54
    s_cselect_b32 s57, s57, 0x7f000000
    s_add_u32 m0, s58, 122880
    s_nop 0
    buffer_load_dwordx4 v10, s[20:23], s57 offen offset:0 lds
    buffer_load_dwordx4 v10, s[20:23], s57 offen offset:1024 lds
    buffer_load_dwordx4 v10, s[20:23], s57 offen offset:2048 lds
    buffer_load_dwordx4 v10, s[20:23], s57 offen offset:3072 lds
    s_add_u32 m0, s58, 126976
    s_nop 0
    buffer_load_dwordx4 v11, s[20:23], s57 offen lds
    s_waitcnt vmcnt(25)
    s_barrier
    s_add_u32 s40, s51, 54
    s_mul_i32 s57, s40, 40960
    s_add_u32 m0, s58, 0
    s_nop 0
    buffer_load_dwordx4 v10, s[20:23], s57 offen offset:0 lds
    buffer_load_dwordx4 v10, s[20:23], s57 offen offset:1024 lds
    buffer_load_dwordx4 v10, s[20:23], s57 offen offset:2048 lds
    buffer_load_dwordx4 v10, s[20:23], s57 offen offset:3072 lds
    s_add_u32 m0, s58, 4096
    s_nop 0
    buffer_load_dwordx4 v11, s[20:23], s57 offen lds
    s_waitcnt vmcnt(25)
    s_barrier
    s_add_u32 s40, s51, 58
    s_mul_i32 s57, s40, 40960
    s_add_u32 m0, s58, 20480
    s_nop 0
    buffer_load_dwordx4 v10, s[20:23], s57 offen offset:0 lds
    buffer_load_dwordx4 v10, s[20:23], s57 offen offset:1024 lds
    buffer_load_dwordx4 v10, s[20:23], s57 offen offset:2048 lds
    buffer_load_dwordx4 v10, s[20:23], s57 offen offset:3072 lds
    s_add_u32 m0, s58, 24576
    s_nop 0
    buffer_load_dwordx4 v11, s[20:23], s57 offen lds
    s_waitcnt vmcnt(25)
    s_barrier
    s_cmp_lg_u32 s48, 4
    s_cbranch_scc1 K2_PI
    s_lshl_b32 s40, s49, 7
    s_add_u32 s40, s40, 19664896
    v_and_b32 v20, 7, v1
    v_lshl_add_u32 v20, v20, 2, s40
    global_load_dword v21, v20, s[14:15] sc1
K2_PI:
    s_add_u32 s40, s51, 62
    s_mul_i32 s57, s40, 40960
    s_add_u32 m0, s58, 40960
    s_nop 0
    buffer_load_dwordx4 v10, s[20:23], s57 offen offset:0 lds
    buffer_load_dwordx4 v10, s[20:23], s57 offen offset:1024 lds
    buffer_load_dwordx4 v10, s[20:23], s57 offen offset:2048 lds
    buffer_load_dwordx4 v10, s[20:23], s57 offen offset:3072 lds
    s_add_u32 m0, s58, 45056
    s_nop 0
    buffer_load_dwordx4 v11, s[20:23], s57 offen lds
    s_waitcnt vmcnt(25)
    s_barrier
    s_add_u32 s40, s51, 66
    s_mul_i32 s57, s40, 40960
    s_add_u32 m0, s58, 61440
    s_nop 0
    buffer_load_dwordx4 v10, s[20:23], s57 offen offset:0 lds
    buffer_load_dwordx4 v10, s[20:23], s57 offen offset:1024 lds
    buffer_load_dwordx4 v10, s[20:23], s57 offen offset:2048 lds
    buffer_load_dwordx4 v10, s[20:23], s57 offen offset:3072 lds
    s_add_u32 m0, s58, 65536
    s_nop 0
    buffer_load_dwordx4 v11, s[20:23], s57 offen lds
    s_waitcnt vmcnt(25)
    s_cmp_lg_u32 s48, 4
    s_cbranch_scc1 K2_POLL_OK
    s_waitcnt vmcnt(10)
    v_cmp_ne_u32 vcc, s59, v21
    s_cbranch_vccz K2_POLL_OK
    s_mov_b32 s42, 0
K2_POLL:
    s_sleep 2
    global_load_dword v21, v20, s[14:15] sc1
    s_waitcnt vmcnt(0)
    v_cmp_ne_u32 vcc, s59, v21
    s_add_u32 s42, s42, 1
    s_cmp_gt_u32 s42, 8000
    s_cbranch_scc1 K2_POLL_OK
    s_cbranch_vccnz K2_POLL
K2_POLL_OK:
    s_barrier
    s_add_u32 s40, s51, 70
    s_mul_i32 s57, s40, 40960
    s_add_u32 m0, s58, 81920
    s_nop 0
    buffer_load_dwordx4 v10, s[20:23], s57 offen offset:0 lds
    buffer_load_dwordx4 v10, s[20:23], s57 offen offset:1024 lds
    buffer_load_dwordx4 v10, s[20:23], s57 offen offset:2048 lds
    buffer_load_dwordx4 v10, s[20:23], s57 offen offset:3072 lds
    s_add_u32 m0, s58, 86016
    s_nop 0
    buffer_load_dwordx4 v11, s[20:23], s57 offen lds
    s_waitcnt vmcnt(25)
    s_barrier
    s_waitcnt vmcnt(20)
    s_barrier
    s_waitcnt vmcnt(15)
    s_barrier
    s_waitcnt vmcnt(10)
    s_barrier
    s_waitcnt vmcnt(5)
    s_barrier
    s_waitcnt vmcnt(0)
    s_barrier
K2_END:
    s_endpgm

.section .rodata,"a"
.p2align 6
.amdhsa_kernel k1_kernel
  .amdhsa_next_free_vgpr 256
  .amdhsa_next_free_sgpr 102
  .amdhsa_accum_offset 256
  .amdhsa_group_segment_fixed_size 0
  .amdhsa_kernarg_size 96
  .amdhsa_user_sgpr_count 2
  .amdhsa_user_sgpr_kernarg_segment_ptr 1
  .amdhsa_system_sgpr_workgroup_id_x 1
.end_amdhsa_kernel
.p2align 6
.amdhsa_kernel k2_kernel
  .amdhsa_next_free_vgpr 256
  .amdhsa_next_free_sgpr 100
  .amdhsa_accum_offset 256
  .amdhsa_group_segment_fixed_size 0
  .amdhsa_kernarg_size 96
  .amdhsa_user_sgpr_count 2
  .amdhsa_user_sgpr_kernarg_segment_ptr 1
  .amdhsa_system_sgpr_workgroup_id_x 1
.end_amdhsa_kernel
```
